```python
import torch

def _softmax(x, axis=-1):
    return torch.softmax(x, dim=axis)
def _gelu(x):
    return torch.nn.functional.gelu(x, approximate="tanh")
def _silu(x):
    return torch.nn.functional.silu(x)
def _sigmoid(x):
    return torch.sigmoid(x)
def _layernorm(x, axis=-1, eps=1e-5):
    m = x.mean(dim=axis, keepdim=True)
    v = x.var(dim=axis, keepdim=True, unbiased=False)
    return (x - m) / torch.sqrt(v + eps)
def _scatter_add(tgt, idx, src, axis=0):
    return tgt.clone().index_add_(axis, idx, src)
def _segment_sum(src, seg, n):
    out = torch.zeros((n,) + src.shape[1:], dtype=src.dtype)
    return out.index_add_(0, seg, src)
def _pad(x, pw):
    flat = tuple(v for pair in reversed(pw) for v in pair)
    return torch.nn.functional.pad(x, flat)

kernel_name = 'concat_heads__gqa_block_cached__gqa_block_cached__near_ridge'

def setup_inputs():

    _w = (lambda a: (lambda t: t.to(torch.bfloat16) if t.is_floating_point() else t)(torch.as_tensor(a)))
    def _A_setup():
        B, Sq, D = 8, 96, 448
        Hq, Hkv, Sk, Dh = 16, 8, 1024, 256
        assert Hq % Hkv == 0, (Hq, Hkv)
        return {
            "x": _w((lambda *s: torch.randn(*s, dtype=torch.bfloat16) * 0.8)(B, Sq, D)),
            "k_cache": _w((lambda *s: torch.randn(*s, dtype=torch.bfloat16) * 0.8)(B, Hkv, Sk, Dh)),
            "v_cache": _w((lambda *s: torch.randn(*s, dtype=torch.bfloat16) * 0.05)(B, Hkv, Sk, Dh)),
            "wq": _w((lambda *s: torch.randn(*s, dtype=torch.bfloat16) * 0.8)(D, Hq * Dh) * (D ** -0.5)),
            "wo": _w((lambda *s: torch.randn(*s, dtype=torch.bfloat16) * 0.05)(Hq * Dh, D) * ((Hq * Dh) ** -0.5)),
        }
    _A_in = _A_setup()

    def _B_setup():
        B, Sq, D = 8, 96, 448
        Hq, Hkv, Sk, Dh = 16, 8, 1024, 256
        assert Hq % Hkv == 0, (Hq, Hkv)
        return {
            "x": _w((lambda *s: torch.randn(*s, dtype=torch.bfloat16) * 0.8)(B, Sq, D)),
            "k_cache": _w((lambda *s: torch.randn(*s, dtype=torch.bfloat16) * 0.8)(B, Hkv, Sk, Dh)),
            "v_cache": _w((lambda *s: torch.randn(*s, dtype=torch.bfloat16) * 0.05)(B, Hkv, Sk, Dh)),
            "wq": _w((lambda *s: torch.randn(*s, dtype=torch.bfloat16) * 0.8)(D, Hq * Dh) * (D ** -0.5)),
            "wo": _w((lambda *s: torch.randn(*s, dtype=torch.bfloat16) * 0.05)(Hq * Dh, D) * ((Hq * Dh) ** -0.5)),
        }
    _B_in = _B_setup()

    return {
        "A_x": _A_in["x"],
        "A_k_cache": _A_in["k_cache"],
        "A_v_cache": _A_in["v_cache"],
        "A_wq": _A_in["wq"],
        "A_wo": _A_in["wo"],
        "B_x": _B_in["x"],
        "B_k_cache": _B_in["k_cache"],
        "B_v_cache": _B_in["v_cache"],
        "B_wq": _B_in["wq"],
        "B_wo": _B_in["wo"],
    }

def reference(A_x, A_k_cache, A_v_cache, A_wq, A_wo, B_x, B_k_cache, B_v_cache, B_wq, B_wo):
    def _A_ref(x, k_cache, v_cache, wq, wo):
        B, Sq, D = x.shape
        Hq, Dh = 16, 256
        Hkv = k_cache.shape[1]
        rep = Hq // Hkv
        q = (lambda x, *d: x.permute(*d))((x @ wq).reshape(B, Sq, Hq, Dh), 0, 2, 1, 3)
        k = (lambda x, n, axis: torch.repeat_interleave(x, n, dim=axis))(k_cache, rep, axis=1)
        v = (lambda x, n, axis: torch.repeat_interleave(x, n, dim=axis))(v_cache, rep, axis=1)
        scores = torch.einsum("bhqd,bhkd->bhqk", q, k) * (Dh ** -0.5)
        p = _softmax(scores, axis=-1)
        o = torch.einsum("bhqk,bhkd->bhqd", p, v)
        return (lambda x, *d: x.permute(*d))(o, 0, 2, 1, 3).reshape(B, Sq, Hq * Dh) @ wo

    def _B_ref(x, k_cache, v_cache, wq, wo):
        B, Sq, D = x.shape
        Hq, Dh = 16, 256
        Hkv = k_cache.shape[1]
        rep = Hq // Hkv
        q = (lambda x, *d: x.permute(*d))((x @ wq).reshape(B, Sq, Hq, Dh), 0, 2, 1, 3)
        k = (lambda x, n, axis: torch.repeat_interleave(x, n, dim=axis))(k_cache, rep, axis=1)
        v = (lambda x, n, axis: torch.repeat_interleave(x, n, dim=axis))(v_cache, rep, axis=1)
        scores = torch.einsum("bhqd,bhkd->bhqk", q, k) * (Dh ** -0.5)
        p = _softmax(scores, axis=-1)
        o = torch.einsum("bhqk,bhkd->bhqd", p, v)
        return (lambda x, *d: x.permute(*d))(o, 0, 2, 1, 3).reshape(B, Sq, Hq * Dh) @ wo

    a = _A_ref(A_x, A_k_cache, A_v_cache, A_wq, A_wo)
    b = _B_ref(B_x, B_k_cache, B_v_cache, B_wq, B_wo)
    return torch.concatenate([a, b], axis=-1)
```

```asm
; @launch kernel=attn_kernel grid=(256,1,1) block=(256,1,1) lds=163840
; @launch kernel=oproj_kernel grid=(224,1,1) block=(256,1,1) lds=131072
.amdgcn_target "amdgcn-amd-amdhsa--gfx950"
.text
.globl attn_kernel
.p2align 8
.type attn_kernel,@function
attn_kernel:
    s_cmp_ge_u32 s2, 256
    s_cbranch_scc1 L_attn_end
    s_lshr_b32 s24, s2, 3
    s_and_b32 s25, s24, 1
    s_lshr_b32 s26, s2, 4
    s_lshl_b32 s26, s26, 3
    s_and_b32 s27, s2, 7
    s_or_b32 s26, s26, s27
    s_lshr_b32 s27, s26, 6
    s_bfe_u32 s28, s26, 0x30003
    s_and_b32 s29, s26, 7
    s_lshl_b32 s30, s29, 1
    s_or_b32 s30, s30, s25
    s_mul_i32 s31, s27, 40
    s_add_u32 s32, s0, s31
    s_addc_u32 s33, s1, 0
    s_load_dwordx2 s[4:5], s[32:33], 0
    s_load_dwordx2 s[12:13], s[32:33], 8
    s_load_dwordx2 s[16:17], s[32:33], 16
    s_load_dwordx2 s[8:9], s[32:33], 24
    s_load_dwordx2 s[20:21], s[0:1], 96
    v_lshrrev_b32 v1, 6, v0
    s_nop 0
    v_readfirstlane_b32 s34, v1
    s_waitcnt lgkmcnt(0)
    s_mul_i32 s35, s28, 86016
    s_add_u32 s4, s4, s35
    s_addc_u32 s5, s5, 0
    s_and_b32 s5, s5, 0xffff
    s_mov_b32 s6, 86016
    s_mov_b32 s7, 0x00020000
    s_lshl_b32 s35, s30, 9
    s_add_u32 s8, s8, s35
    s_addc_u32 s9, s9, 0
    s_and_b32 s9, s9, 0xffff
    s_sub_u32 s10, 3670016, s35
    s_mov_b32 s11, 0x00020000
    s_lshl_b32 s36, s28, 3
    s_add_u32 s36, s36, s29
    s_lshl_b32 s36, s36, 19
    s_add_u32 s12, s12, s36
    s_addc_u32 s13, s13, 0
    s_and_b32 s13, s13, 0xffff
    s_mov_b32 s14, 524288
    s_mov_b32 s15, 0x00020000
    s_add_u32 s16, s16, s36
    s_addc_u32 s17, s17, 0
    s_and_b32 s17, s17, 0xffff
    s_mov_b32 s18, 524288
    s_mov_b32 s19, 0x00020000
    s_mul_i32 s36, s27, 6291456
    s_mul_i32 s37, s28, 786432
    s_add_u32 s36, s36, s37
    s_lshl_b32 s37, s30, 13
    s_add_u32 s36, s36, s37
    s_add_u32 s20, s20, s36
    s_addc_u32 s21, s21, 0
    s_and_b32 s21, s21, 0xffff
    s_mov_b32 s22, 786432
    s_mov_b32 s23, 0x00020000
    s_lshr_b32 s38, s34, 1
    s_and_b32 s39, s34, 1
    v_and_b32 v1, 63, v0
    v_and_b32 v2, 15, v1
    v_lshrrev_b32 v3, 4, v1
    v_lshrrev_b32 v30, 5, v1
    v_and_b32 v31, 31, v1
    v_add_u32 v32, 0, v30
    v_and_b32 v32, 7, v32
    v_lshlrev_b32 v32, 1, v32
    v_xor_b32 v32, v31, v32
    v_lshlrev_b32 v32, 4, v32
    v_lshl_add_u32 v4, v30, 9, v32
    v_add_u32 v32, 2, v30
    v_and_b32 v32, 7, v32
    v_lshlrev_b32 v32, 1, v32
    v_xor_b32 v32, v31, v32
    v_lshlrev_b32 v32, 4, v32
    v_lshl_add_u32 v5, v30, 9, v32
    v_add_u32 v32, 4, v30
    v_and_b32 v32, 7, v32
    v_lshlrev_b32 v32, 1, v32
    v_xor_b32 v32, v31, v32
    v_lshlrev_b32 v32, 4, v32
    v_lshl_add_u32 v6, v30, 9, v32
    v_add_u32 v32, 6, v30
    v_and_b32 v32, 7, v32
    v_lshlrev_b32 v32, 1, v32
    v_xor_b32 v32, v31, v32
    v_lshlrev_b32 v32, 4, v32
    v_lshl_add_u32 v7, v30, 9, v32
    s_lshl_b32 s40, s34, 3
    v_add_u32 v32, 0, v30
    v_add_u32 v32, s40, v32
    v_and_b32 v33, 3, v32
    v_lshrrev_b32 v34, 1, v32
    v_and_b32 v34, 4, v34
    v_or_b32 v33, v33, v34
    v_lshlrev_b32 v33, 1, v33
    v_xor_b32 v33, v31, v33
    v_lshlrev_b32 v33, 4, v33
    v_lshl_add_u32 v8, v30, 13, v33
    v_add_u32 v32, 2, v30
    v_add_u32 v32, s40, v32
    v_and_b32 v33, 3, v32
    v_lshrrev_b32 v34, 1, v32
    v_and_b32 v34, 4, v34
    v_or_b32 v33, v33, v34
    v_lshlrev_b32 v33, 1, v33
    v_xor_b32 v33, v31, v33
    v_lshlrev_b32 v33, 4, v33
    v_lshl_add_u32 v9, v30, 13, v33
    v_add_u32 v32, 4, v30
    v_add_u32 v32, s40, v32
    v_and_b32 v33, 3, v32
    v_lshrrev_b32 v34, 1, v32
    v_and_b32 v34, 4, v34
    v_or_b32 v33, v33, v34
    v_lshlrev_b32 v33, 1, v33
    v_xor_b32 v33, v31, v33
    v_lshlrev_b32 v33, 4, v33
    v_lshl_add_u32 v10, v30, 13, v33
    v_add_u32 v32, 6, v30
    v_add_u32 v32, s40, v32
    v_and_b32 v33, 3, v32
    v_lshrrev_b32 v34, 1, v32
    v_and_b32 v34, 4, v34
    v_or_b32 v33, v33, v34
    v_lshlrev_b32 v33, 1, v33
    v_xor_b32 v33, v31, v33
    v_lshlrev_b32 v33, 4, v33
    v_lshl_add_u32 v11, v30, 13, v33
    v_mul_u32_u24 v12, 896, v2
    v_lshl_add_u32 v12, v3, 4, v12
    s_lshl_b32 s40, s39, 5
    v_add_u32 v32, s40, v2
    v_lshlrev_b32 v32, 9, v32
    v_and_b32 v33, 7, v2
    v_lshlrev_b32 v33, 1, v33
    v_add_u32 v34, 0, v3
    v_xor_b32 v34, v34, v33
    v_lshl_add_u32 v13, v34, 4, v32
    v_add_u32 v34, 4, v3
    v_xor_b32 v34, v34, v33
    v_lshl_add_u32 v14, v34, 4, v32
    v_add_u32 v34, 8, v3
    v_xor_b32 v34, v34, v33
    v_lshl_add_u32 v15, v34, 4, v32
    v_add_u32 v34, 12, v3
    v_xor_b32 v34, v34, v33
    v_lshl_add_u32 v16, v34, 4, v32
    v_lshrrev_b32 v33, 2, v2
    v_lshl_add_u32 v33, v3, 2, v33
    v_and_b32 v34, 7, v33
    v_add_u32 v33, s40, v33
    v_lshlrev_b32 v33, 9, v33
    v_add_u32 v33, 65536, v33
    v_and_b32 v35, 3, v2
    v_lshlrev_b32 v35, 3, v35
    v_add_u32 v33, v33, v35
    v_xor_b32 v36, 0, v34
    v_lshl_add_u32 v17, v36, 5, v33
    v_xor_b32 v36, 1, v34
    v_lshl_add_u32 v18, v36, 5, v33
    v_xor_b32 v36, 2, v34
    v_lshl_add_u32 v19, v36, 5, v33
    v_xor_b32 v36, 3, v34
    v_lshl_add_u32 v20, v36, 5, v33
    v_xor_b32 v36, 4, v34
    v_lshl_add_u32 v21, v36, 5, v33
    v_xor_b32 v36, 5, v34
    v_lshl_add_u32 v22, v36, 5, v33
    v_xor_b32 v36, 6, v34
    v_lshl_add_u32 v23, v36, 5, v33
    v_xor_b32 v36, 7, v34
    v_lshl_add_u32 v24, v36, 5, v33
    v_lshrrev_b32 v33, 2, v2
    v_and_b32 v34, 1, v3
    v_lshl_or_b32 v34, v34, 2, v33
    v_lshl_add_u32 v33, v3, 3, v33
    v_lshlrev_b32 v33, 9, v33
    v_add_u32 v33, 86016, v33
    v_add_u32 v33, v33, v35
    s_lshl_b32 s40, s34, 2
    s_add_u32 s41, s40, 0
    s_and_b32 s42, s41, 7
    v_xor_b32 v36, s42, v34
    v_lshl_add_u32 v25, v36, 5, v33
    s_lshr_b32 s42, s41, 3
    s_lshl_b32 s42, s42, 8
    v_add_u32 v25, s42, v25
    s_add_u32 s41, s40, 1
    s_and_b32 s42, s41, 7
    v_xor_b32 v36, s42, v34
    v_lshl_add_u32 v26, v36, 5, v33
    s_lshr_b32 s42, s41, 3
    s_lshl_b32 s42, s42, 8
    v_add_u32 v26, s42, v26
    s_add_u32 s41, s40, 2
    s_and_b32 s42, s41, 7
    v_xor_b32 v36, s42, v34
    v_lshl_add_u32 v27, v36, 5, v33
    s_lshr_b32 s42, s41, 3
    s_lshl_b32 s42, s42, 8
    v_add_u32 v27, s42, v27
    s_add_u32 s41, s40, 3
    s_and_b32 s42, s41, 7
    v_xor_b32 v36, s42, v34
    v_lshl_add_u32 v28, v36, 5, v33
    s_lshr_b32 s42, s41, 3
    s_lshl_b32 s42, s42, 8
    v_add_u32 v28, s42, v28
    v_lshlrev_b32 v29, 4, v1
    v_add_u32 v37, 0x10000, v29
    s_add_u32 s40, s34, 0
    s_mul_i32 s41, s40, 171
    s_lshr_b32 s41, s41, 10
    s_mul_i32 s42, s41, 6
    s_sub_u32 s42, s40, s42
    s_mul_i32 s42, s42, 14336
    s_lshl_b32 s41, s41, 6
    s_add_u32 s42, s42, s41
    s_lshl_b32 s43, s40, 10
    s_mov_b32 m0, s43
    s_nop 0
    buffer_load_dwordx4 v12, s[4:7], s42 offen lds
    s_add_u32 s40, s34, 4
    s_mul_i32 s41, s40, 171
    s_lshr_b32 s41, s41, 10
    s_mul_i32 s42, s41, 6
    s_sub_u32 s42, s40, s42
    s_mul_i32 s42, s42, 14336
    s_lshl_b32 s41, s41, 6
    s_add_u32 s42, s42, s41
    s_lshl_b32 s43, s40, 10
    s_mov_b32 m0, s43
    s_nop 0
    buffer_load_dwordx4 v12, s[4:7], s42 offen lds
    s_add_u32 s40, s34, 8
    s_mul_i32 s41, s40, 171
    s_lshr_b32 s41, s41, 10
    s_mul_i32 s42, s41, 6
    s_sub_u32 s42, s40, s42
    s_mul_i32 s42, s42, 14336
    s_lshl_b32 s41, s41, 6
    s_add_u32 s42, s42, s41
    s_lshl_b32 s43, s40, 10
    s_mov_b32 m0, s43
    s_nop 0
    buffer_load_dwordx4 v12, s[4:7], s42 offen lds
    s_add_u32 s40, s34, 12
    s_mul_i32 s41, s40, 171
    s_lshr_b32 s41, s41, 10
    s_mul_i32 s42, s41, 6
    s_sub_u32 s42, s40, s42
    s_mul_i32 s42, s42, 14336
    s_lshl_b32 s41, s41, 6
    s_add_u32 s42, s42, s41
    s_lshl_b32 s43, s40, 10
    s_mov_b32 m0, s43
    s_nop 0
    buffer_load_dwordx4 v12, s[4:7], s42 offen lds
    s_add_u32 s40, s34, 16
    s_mul_i32 s41, s40, 171
    s_lshr_b32 s41, s41, 10
    s_mul_i32 s42, s41, 6
    s_sub_u32 s42, s40, s42
    s_mul_i32 s42, s42, 14336
    s_lshl_b32 s41, s41, 6
    s_add_u32 s42, s42, s41
    s_lshl_b32 s43, s40, 10
    s_mov_b32 m0, s43
    s_nop 0
    buffer_load_dwordx4 v12, s[4:7], s42 offen lds
    s_add_u32 s40, s34, 20
    s_mul_i32 s41, s40, 171
    s_lshr_b32 s41, s41, 10
    s_mul_i32 s42, s41, 6
    s_sub_u32 s42, s40, s42
    s_mul_i32 s42, s42, 14336
    s_lshl_b32 s41, s41, 6
    s_add_u32 s42, s42, s41
    s_lshl_b32 s43, s40, 10
    s_mov_b32 m0, s43
    s_nop 0
    buffer_load_dwordx4 v12, s[4:7], s42 offen lds
    s_add_u32 s40, s34, 24
    s_mul_i32 s41, s40, 171
    s_lshr_b32 s41, s41, 10
    s_mul_i32 s42, s41, 6
    s_sub_u32 s42, s40, s42
    s_mul_i32 s42, s42, 14336
    s_lshl_b32 s41, s41, 6
    s_add_u32 s42, s42, s41
    s_lshl_b32 s43, s40, 10
    s_mov_b32 m0, s43
    s_nop 0
    buffer_load_dwordx4 v12, s[4:7], s42 offen lds
    s_add_u32 s40, s34, 28
    s_mul_i32 s41, s40, 171
    s_lshr_b32 s41, s41, 10
    s_mul_i32 s42, s41, 6
    s_sub_u32 s42, s40, s42
    s_mul_i32 s42, s42, 14336
    s_lshl_b32 s41, s41, 6
    s_add_u32 s42, s42, s41
    s_lshl_b32 s43, s40, 10
    s_mov_b32 m0, s43
    s_nop 0
    buffer_load_dwordx4 v12, s[4:7], s42 offen lds
    s_add_u32 s40, s34, 32
    s_mul_i32 s41, s40, 171
    s_lshr_b32 s41, s41, 10
    s_mul_i32 s42, s41, 6
    s_sub_u32 s42, s40, s42
    s_mul_i32 s42, s42, 14336
    s_lshl_b32 s41, s41, 6
    s_add_u32 s42, s42, s41
    s_lshl_b32 s43, s40, 10
    s_mov_b32 m0, s43
    s_nop 0
    buffer_load_dwordx4 v12, s[4:7], s42 offen lds
    s_add_u32 s40, s34, 36
    s_mul_i32 s41, s40, 171
    s_lshr_b32 s41, s41, 10
    s_mul_i32 s42, s41, 6
    s_sub_u32 s42, s40, s42
    s_mul_i32 s42, s42, 14336
    s_lshl_b32 s41, s41, 6
    s_add_u32 s42, s42, s41
    s_lshl_b32 s43, s40, 10
    s_mov_b32 m0, s43
    s_nop 0
    buffer_load_dwordx4 v12, s[4:7], s42 offen lds
    s_add_u32 s40, s34, 40
    s_mul_i32 s41, s40, 171
    s_lshr_b32 s41, s41, 10
    s_mul_i32 s42, s41, 6
    s_sub_u32 s42, s40, s42
    s_mul_i32 s42, s42, 14336
    s_lshl_b32 s41, s41, 6
    s_add_u32 s42, s42, s41
    s_lshl_b32 s43, s40, 10
    s_mov_b32 m0, s43
    s_nop 0
    buffer_load_dwordx4 v12, s[4:7], s42 offen lds
    s_add_u32 s40, s34, 44
    s_mul_i32 s41, s40, 171
    s_lshr_b32 s41, s41, 10
    s_mul_i32 s42, s41, 6
    s_sub_u32 s42, s40, s42
    s_mul_i32 s42, s42, 14336
    s_lshl_b32 s41, s41, 6
    s_add_u32 s42, s42, s41
    s_lshl_b32 s43, s40, 10
    s_mov_b32 m0, s43
    s_nop 0
    buffer_load_dwordx4 v12, s[4:7], s42 offen lds
    s_add_u32 s40, s34, 48
    s_mul_i32 s41, s40, 171
    s_lshr_b32 s41, s41, 10
    s_mul_i32 s42, s41, 6
    s_sub_u32 s42, s40, s42
    s_mul_i32 s42, s42, 14336
    s_lshl_b32 s41, s41, 6
    s_add_u32 s42, s42, s41
    s_lshl_b32 s43, s40, 10
    s_mov_b32 m0, s43
    s_nop 0
    buffer_load_dwordx4 v12, s[4:7], s42 offen lds
    s_add_u32 s40, s34, 52
    s_mul_i32 s41, s40, 171
    s_lshr_b32 s41, s41, 10
    s_mul_i32 s42, s41, 6
    s_sub_u32 s42, s40, s42
    s_mul_i32 s42, s42, 14336
    s_lshl_b32 s41, s41, 6
    s_add_u32 s42, s42, s41
    s_lshl_b32 s43, s40, 10
    s_mov_b32 m0, s43
    s_nop 0
    buffer_load_dwordx4 v12, s[4:7], s42 offen lds
    s_add_u32 s40, s34, 56
    s_mul_i32 s41, s40, 171
    s_lshr_b32 s41, s41, 10
    s_mul_i32 s42, s41, 6
    s_sub_u32 s42, s40, s42
    s_mul_i32 s42, s42, 14336
    s_lshl_b32 s41, s41, 6
    s_add_u32 s42, s42, s41
    s_lshl_b32 s43, s40, 10
    s_mov_b32 m0, s43
    s_nop 0
    buffer_load_dwordx4 v12, s[4:7], s42 offen lds
    s_add_u32 s40, s34, 60
    s_mul_i32 s41, s40, 171
    s_lshr_b32 s41, s41, 10
    s_mul_i32 s42, s41, 6
    s_sub_u32 s42, s40, s42
    s_mul_i32 s42, s42, 14336
    s_lshl_b32 s41, s41, 6
    s_add_u32 s42, s42, s41
    s_lshl_b32 s43, s40, 10
    s_mov_b32 m0, s43
    s_nop 0
    buffer_load_dwordx4 v12, s[4:7], s42 offen lds
    s_add_u32 s40, s34, 64
    s_mul_i32 s41, s40, 171
    s_lshr_b32 s41, s41, 10
    s_mul_i32 s42, s41, 6
    s_sub_u32 s42, s40, s42
    s_mul_i32 s42, s42, 14336
    s_lshl_b32 s41, s41, 6
    s_add_u32 s42, s42, s41
    s_lshl_b32 s43, s40, 10
    s_mov_b32 m0, s43
    s_nop 0
    buffer_load_dwordx4 v12, s[4:7], s42 offen lds
    s_add_u32 s40, s34, 68
    s_mul_i32 s41, s40, 171
    s_lshr_b32 s41, s41, 10
    s_mul_i32 s42, s41, 6
    s_sub_u32 s42, s40, s42
    s_mul_i32 s42, s42, 14336
    s_lshl_b32 s41, s41, 6
    s_add_u32 s42, s42, s41
    s_lshl_b32 s43, s40, 10
    s_mov_b32 m0, s43
    s_nop 0
    buffer_load_dwordx4 v12, s[4:7], s42 offen lds
    s_add_u32 s40, s34, 72
    s_mul_i32 s41, s40, 171
    s_lshr_b32 s41, s41, 10
    s_mul_i32 s42, s41, 6
    s_sub_u32 s42, s40, s42
    s_mul_i32 s42, s42, 14336
    s_lshl_b32 s41, s41, 6
    s_add_u32 s42, s42, s41
    s_lshl_b32 s43, s40, 10
    s_mov_b32 m0, s43
    s_nop 0
    buffer_load_dwordx4 v12, s[4:7], s42 offen lds
    s_add_u32 s40, s34, 76
    s_mul_i32 s41, s40, 171
    s_lshr_b32 s41, s41, 10
    s_mul_i32 s42, s41, 6
    s_sub_u32 s42, s40, s42
    s_mul_i32 s42, s42, 14336
    s_lshl_b32 s41, s41, 6
    s_add_u32 s42, s42, s41
    s_lshl_b32 s43, s40, 10
    s_mov_b32 m0, s43
    s_nop 0
    buffer_load_dwordx4 v12, s[4:7], s42 offen lds
    s_add_u32 s40, s34, 80
    s_mul_i32 s41, s40, 171
    s_lshr_b32 s41, s41, 10
    s_mul_i32 s42, s41, 6
    s_sub_u32 s42, s40, s42
    s_mul_i32 s42, s42, 14336
    s_lshl_b32 s41, s41, 6
    s_add_u32 s42, s42, s41
    s_lshl_b32 s43, s40, 10
    s_mov_b32 m0, s43
    s_nop 0
    buffer_load_dwordx4 v12, s[4:7], s42 offen lds
    s_lshl_b32 s40, s34, 12
    s_add_u32 s40, s40, 86016
    s_mov_b32 m0, s40
    s_lshl_b32 s41, s34, 16
    s_add_u32 s41, s41, 0
    s_nop 0
    buffer_load_dwordx4 v8, s[8:11], s41 offen lds
    s_add_u32 s40, s40, 1024
    s_mov_b32 m0, s40
    s_add_u32 s41, s41, 16384
    s_nop 0
    buffer_load_dwordx4 v9, s[8:11], s41 offen lds
    s_add_u32 s40, s40, 1024
    s_mov_b32 m0, s40
    s_add_u32 s41, s41, 16384
    s_nop 0
    buffer_load_dwordx4 v10, s[8:11], s41 offen lds
    s_add_u32 s40, s40, 1024
    s_mov_b32 m0, s40
    s_add_u32 s41, s41, 16384
    s_nop 0
    buffer_load_dwordx4 v11, s[8:11], s41 offen lds
    s_lshl_b32 s40, s34, 12
    s_add_u32 s40, s40, 102400
    s_mov_b32 m0, s40
    s_lshl_b32 s41, s34, 16
    s_add_u32 s41, s41, 262144
    s_nop 0
    buffer_load_dwordx4 v8, s[8:11], s41 offen lds
    s_add_u32 s40, s40, 1024
    s_mov_b32 m0, s40
    s_add_u32 s41, s41, 16384
    s_nop 0
    buffer_load_dwordx4 v9, s[8:11], s41 offen lds
    s_add_u32 s40, s40, 1024
    s_mov_b32 m0, s40
    s_add_u32 s41, s41, 16384
    s_nop 0
    buffer_load_dwordx4 v10, s[8:11], s41 offen lds
    s_add_u32 s40, s40, 1024
    s_mov_b32 m0, s40
    s_add_u32 s41, s41, 16384
    s_nop 0
    buffer_load_dwordx4 v11, s[8:11], s41 offen lds
    s_lshl_b32 s40, s34, 12
    s_add_u32 s40, s40, 118784
    s_mov_b32 m0, s40
    s_lshl_b32 s41, s34, 16
    s_add_u32 s41, s41, 524288
    s_nop 0
    buffer_load_dwordx4 v8, s[8:11], s41 offen lds
    s_add_u32 s40, s40, 1024
    s_mov_b32 m0, s40
    s_add_u32 s41, s41, 16384
    s_nop 0
    buffer_load_dwordx4 v9, s[8:11], s41 offen lds
    s_add_u32 s40, s40, 1024
    s_mov_b32 m0, s40
    s_add_u32 s41, s41, 16384
    s_nop 0
    buffer_load_dwordx4 v10, s[8:11], s41 offen lds
    s_add_u32 s40, s40, 1024
    s_mov_b32 m0, s40
    s_add_u32 s41, s41, 16384
    s_nop 0
    buffer_load_dwordx4 v11, s[8:11], s41 offen lds
    v_mov_b32 v64, 0
    v_mov_b32 v65, 0
    v_mov_b32 v66, 0
    v_mov_b32 v67, 0
    v_mov_b32 v68, 0
    v_mov_b32 v69, 0
    v_mov_b32 v70, 0
    v_mov_b32 v71, 0
    v_mov_b32 v72, 0
    v_mov_b32 v73, 0
    v_mov_b32 v74, 0
    v_mov_b32 v75, 0
    v_mov_b32 v76, 0
    v_mov_b32 v77, 0
    v_mov_b32 v78, 0
    v_mov_b32 v79, 0
    v_mov_b32 v80, 0
    v_mov_b32 v81, 0
    v_mov_b32 v82, 0
    v_mov_b32 v83, 0
    v_mov_b32 v84, 0
    v_mov_b32 v85, 0
    v_mov_b32 v86, 0
    v_mov_b32 v87, 0
    v_mov_b32 v88, 0
    v_mov_b32 v89, 0
    v_mov_b32 v90, 0
    v_mov_b32 v91, 0
    v_mov_b32 v92, 0
    v_mov_b32 v93, 0
    v_mov_b32 v94, 0
    v_mov_b32 v95, 0
    v_mov_b32 v96, 0
    v_mov_b32 v97, 0
    v_mov_b32 v98, 0
    v_mov_b32 v99, 0
    v_mov_b32 v100, 0
    v_mov_b32 v101, 0
    v_mov_b32 v102, 0
    v_mov_b32 v103, 0
    v_mov_b32 v104, 0
    v_mov_b32 v105, 0
    v_mov_b32 v106, 0
    v_mov_b32 v107, 0
    v_mov_b32 v108, 0
    v_mov_b32 v109, 0
    v_mov_b32 v110, 0
    v_mov_b32 v111, 0
    v_mov_b32 v112, 0
    v_mov_b32 v113, 0
    v_mov_b32 v114, 0
    v_mov_b32 v115, 0
    v_mov_b32 v116, 0
    v_mov_b32 v117, 0
    v_mov_b32 v118, 0
    v_mov_b32 v119, 0
    v_mov_b32 v120, 0
    v_mov_b32 v121, 0
    v_mov_b32 v122, 0
    v_mov_b32 v123, 0
    v_mov_b32 v124, 0
    v_mov_b32 v125, 0
    v_mov_b32 v126, 0
    v_mov_b32 v127, 0
    v_mov_b32 v128, 0
    v_mov_b32 v129, 0
    v_mov_b32 v130, 0
    v_mov_b32 v131, 0
    v_mov_b32 v132, 0
    v_mov_b32 v133, 0
    v_mov_b32 v134, 0
    v_mov_b32 v135, 0
    v_mov_b32 v136, 0
    v_mov_b32 v137, 0
    v_mov_b32 v138, 0
    v_mov_b32 v139, 0
    v_mov_b32 v140, 0
    v_mov_b32 v141, 0
    v_mov_b32 v142, 0
    v_mov_b32 v143, 0
    v_mov_b32 v144, 0
    v_mov_b32 v145, 0
    v_mov_b32 v146, 0
    v_mov_b32 v147, 0
    v_mov_b32 v148, 0
    v_mov_b32 v149, 0
    v_mov_b32 v150, 0
    v_mov_b32 v151, 0
    v_mov_b32 v152, 0
    v_mov_b32 v153, 0
    v_mov_b32 v154, 0
    v_mov_b32 v155, 0
    v_mov_b32 v156, 0
    v_mov_b32 v157, 0
    v_mov_b32 v158, 0
    v_mov_b32 v159, 0
    s_waitcnt vmcnt(8)
    s_barrier
    ds_read_b64_tr_b16 v[160:161], v25 offset:0
    ds_read_b64_tr_b16 v[162:163], v25 offset:2048
    ds_read_b64_tr_b16 v[164:165], v26 offset:0
    ds_read_b64_tr_b16 v[166:167], v26 offset:2048
    ds_read_b64_tr_b16 v[168:169], v27 offset:0
    ds_read_b64_tr_b16 v[170:171], v27 offset:2048
    ds_read_b64_tr_b16 v[172:173], v28 offset:0
    ds_read_b64_tr_b16 v[174:175], v28 offset:2048
    ds_read_b128 v[176:179], v29 offset:0
    ds_read_b128 v[180:183], v29 offset:1024
    ds_read_b128 v[184:187], v29 offset:2048
    ds_read_b128 v[188:191], v29 offset:3072
    ds_read_b128 v[192:195], v29 offset:4096
    ds_read_b128 v[196:199], v29 offset:5120
    s_waitcnt vmcnt(4) lgkmcnt(0)
    s_barrier
    s_lshl_b32 s40, s34, 12
    s_add_u32 s40, s40, 135168
    s_mov_b32 m0, s40
    s_lshl_b32 s41, s34, 16
    s_add_u32 s41, s41, 786432
    s_nop 0
    buffer_load_dwordx4 v8, s[8:11], s41 offen lds
    s_add_u32 s40, s40, 1024
    s_mov_b32 m0, s40
    s_add_u32 s41, s41, 16384
    s_nop 0
    buffer_load_dwordx4 v9, s[8:11], s41 offen lds
    s_add_u32 s40, s40, 1024
    s_mov_b32 m0, s40
    s_add_u32 s41, s41, 16384
    s_nop 0
    buffer_load_dwordx4 v10, s[8:11], s41 offen lds
    s_add_u32 s40, s40, 1024
    s_mov_b32 m0, s40
    s_add_u32 s41, s41, 16384
    s_nop 0
    buffer_load_dwordx4 v11, s[8:11], s41 offen lds
    ds_read_b64_tr_b16 v[200:201], v25 offset:16384
    ds_read_b64_tr_b16 v[202:203], v25 offset:18432
    ds_read_b64_tr_b16 v[204:205], v26 offset:16384
    ds_read_b64_tr_b16 v[206:207], v26 offset:18432
    ds_read_b64_tr_b16 v[208:209], v27 offset:16384
    ds_read_b64_tr_b16 v[210:211], v27 offset:18432
    ds_read_b64_tr_b16 v[212:213], v28 offset:16384
    ds_read_b64_tr_b16 v[214:215], v28 offset:18432
    ds_read_b128 v[216:219], v29 offset:6144
    ds_read_b128 v[220:223], v29 offset:7168
    ds_read_b128 v[224:227], v29 offset:8192
    ds_read_b128 v[228:231], v29 offset:9216
    ds_read_b128 v[232:235], v29 offset:10240
    ds_read_b128 v[236:239], v29 offset:11264
    v_mfma_f32_16x16x32_bf16 v[64:67], v[160:163], v[176:179], v[64:67]
    v_mfma_f32_16x16x32_bf16 v[68:71], v[160:163], v[180:183], v[68:71]
    v_mfma_f32_16x16x32_bf16 v[72:75], v[160:163], v[184:187], v[72:75]
    v_mfma_f32_16x16x32_bf16 v[76:79], v[160:163], v[188:191], v[76:79]
    v_mfma_f32_16x16x32_bf16 v[80:83], v[160:163], v[192:195], v[80:83]
    v_mfma_f32_16x16x32_bf16 v[84:87], v[160:163], v[196:199], v[84:87]
    v_mfma_f32_16x16x32_bf16 v[88:91], v[164:167], v[176:179], v[88:91]
    v_mfma_f32_16x16x32_bf16 v[92:95], v[164:167], v[180:183], v[92:95]
    v_mfma_f32_16x16x32_bf16 v[96:99], v[164:167], v[184:187], v[96:99]
    v_mfma_f32_16x16x32_bf16 v[100:103], v[164:167], v[188:191], v[100:103]
    v_mfma_f32_16x16x32_bf16 v[104:107], v[164:167], v[192:195], v[104:107]
    v_mfma_f32_16x16x32_bf16 v[108:111], v[164:167], v[196:199], v[108:111]
    v_mfma_f32_16x16x32_bf16 v[112:115], v[168:171], v[176:179], v[112:115]
    v_mfma_f32_16x16x32_bf16 v[116:119], v[168:171], v[180:183], v[116:119]
    v_mfma_f32_16x16x32_bf16 v[120:123], v[168:171], v[184:187], v[120:123]
    v_mfma_f32_16x16x32_bf16 v[124:127], v[168:171], v[188:191], v[124:127]
    v_mfma_f32_16x16x32_bf16 v[128:131], v[168:171], v[192:195], v[128:131]
    v_mfma_f32_16x16x32_bf16 v[132:135], v[168:171], v[196:199], v[132:135]
    v_mfma_f32_16x16x32_bf16 v[136:139], v[172:175], v[176:179], v[136:139]
    v_mfma_f32_16x16x32_bf16 v[140:143], v[172:175], v[180:183], v[140:143]
    v_mfma_f32_16x16x32_bf16 v[144:147], v[172:175], v[184:187], v[144:147]
    v_mfma_f32_16x16x32_bf16 v[148:151], v[172:175], v[188:191], v[148:151]
    v_mfma_f32_16x16x32_bf16 v[152:155], v[172:175], v[192:195], v[152:155]
    v_mfma_f32_16x16x32_bf16 v[156:159], v[172:175], v[196:199], v[156:159]
    s_waitcnt vmcnt(4) lgkmcnt(0)
    s_barrier
    s_lshl_b32 s40, s34, 12
    s_add_u32 s40, s40, 86016
    s_mov_b32 m0, s40
    s_lshl_b32 s41, s34, 16
    s_add_u32 s41, s41, 1048576
    s_nop 0
    buffer_load_dwordx4 v8, s[8:11], s41 offen lds
    s_add_u32 s40, s40, 1024
    s_mov_b32 m0, s40
    s_add_u32 s41, s41, 16384
    s_nop 0
    buffer_load_dwordx4 v9, s[8:11], s41 offen lds
    s_add_u32 s40, s40, 1024
    s_mov_b32 m0, s40
    s_add_u32 s41, s41, 16384
    s_nop 0
    buffer_load_dwordx4 v10, s[8:11], s41 offen lds
    s_add_u32 s40, s40, 1024
    s_mov_b32 m0, s40
    s_add_u32 s41, s41, 16384
    s_nop 0
    buffer_load_dwordx4 v11, s[8:11], s41 offen lds
    ds_read_b64_tr_b16 v[160:161], v25 offset:32768
    ds_read_b64_tr_b16 v[162:163], v25 offset:34816
    ds_read_b64_tr_b16 v[164:165], v26 offset:32768
    ds_read_b64_tr_b16 v[166:167], v26 offset:34816
    ds_read_b64_tr_b16 v[168:169], v27 offset:32768
    ds_read_b64_tr_b16 v[170:171], v27 offset:34816
    ds_read_b64_tr_b16 v[172:173], v28 offset:32768
    ds_read_b64_tr_b16 v[174:175], v28 offset:34816
    ds_read_b128 v[176:179], v29 offset:12288
    ds_read_b128 v[180:183], v29 offset:13312
    ds_read_b128 v[184:187], v29 offset:14336
    ds_read_b128 v[188:191], v29 offset:15360
    ds_read_b128 v[192:195], v29 offset:16384
    ds_read_b128 v[196:199], v29 offset:17408
    v_mfma_f32_16x16x32_bf16 v[64:67], v[200:203], v[216:219], v[64:67]
    v_mfma_f32_16x16x32_bf16 v[68:71], v[200:203], v[220:223], v[68:71]
    v_mfma_f32_16x16x32_bf16 v[72:75], v[200:203], v[224:227], v[72:75]
    v_mfma_f32_16x16x32_bf16 v[76:79], v[200:203], v[228:231], v[76:79]
    v_mfma_f32_16x16x32_bf16 v[80:83], v[200:203], v[232:235], v[80:83]
    v_mfma_f32_16x16x32_bf16 v[84:87], v[200:203], v[236:239], v[84:87]
    v_mfma_f32_16x16x32_bf16 v[88:91], v[204:207], v[216:219], v[88:91]
    v_mfma_f32_16x16x32_bf16 v[92:95], v[204:207], v[220:223], v[92:95]
    v_mfma_f32_16x16x32_bf16 v[96:99], v[204:207], v[224:227], v[96:99]
    v_mfma_f32_16x16x32_bf16 v[100:103], v[204:207], v[228:231], v[100:103]
    v_mfma_f32_16x16x32_bf16 v[104:107], v[204:207], v[232:235], v[104:107]
    v_mfma_f32_16x16x32_bf16 v[108:111], v[204:207], v[236:239], v[108:111]
    v_mfma_f32_16x16x32_bf16 v[112:115], v[208:211], v[216:219], v[112:115]
    v_mfma_f32_16x16x32_bf16 v[116:119], v[208:211], v[220:223], v[116:119]
    v_mfma_f32_16x16x32_bf16 v[120:123], v[208:211], v[224:227], v[120:123]
    v_mfma_f32_16x16x32_bf16 v[124:127], v[208:211], v[228:231], v[124:127]
    v_mfma_f32_16x16x32_bf16 v[128:131], v[208:211], v[232:235], v[128:131]
    v_mfma_f32_16x16x32_bf16 v[132:135], v[208:211], v[236:239], v[132:135]
    v_mfma_f32_16x16x32_bf16 v[136:139], v[212:215], v[216:219], v[136:139]
    v_mfma_f32_16x16x32_bf16 v[140:143], v[212:215], v[220:223], v[140:143]
    v_mfma_f32_16x16x32_bf16 v[144:147], v[212:215], v[224:227], v[144:147]
    v_mfma_f32_16x16x32_bf16 v[148:151], v[212:215], v[228:231], v[148:151]
    v_mfma_f32_16x16x32_bf16 v[152:155], v[212:215], v[232:235], v[152:155]
    v_mfma_f32_16x16x32_bf16 v[156:159], v[212:215], v[236:239], v[156:159]
    s_waitcnt vmcnt(4) lgkmcnt(0)
    s_barrier
    s_lshl_b32 s40, s34, 12
    s_add_u32 s40, s40, 102400
    s_mov_b32 m0, s40
    s_lshl_b32 s41, s34, 16
    s_add_u32 s41, s41, 1310720
    s_nop 0
    buffer_load_dwordx4 v8, s[8:11], s41 offen lds
    s_add_u32 s40, s40, 1024
    s_mov_b32 m0, s40
    s_add_u32 s41, s41, 16384
    s_nop 0
    buffer_load_dwordx4 v9, s[8:11], s41 offen lds
    s_add_u32 s40, s40, 1024
    s_mov_b32 m0, s40
    s_add_u32 s41, s41, 16384
    s_nop 0
    buffer_load_dwordx4 v10, s[8:11], s41 offen lds
    s_add_u32 s40, s40, 1024
    s_mov_b32 m0, s40
    s_add_u32 s41, s41, 16384
    s_nop 0
    buffer_load_dwordx4 v11, s[8:11], s41 offen lds
    ds_read_b64_tr_b16 v[200:201], v25 offset:49152
    ds_read_b64_tr_b16 v[202:203], v25 offset:51200
    ds_read_b64_tr_b16 v[204:205], v26 offset:49152
    ds_read_b64_tr_b16 v[206:207], v26 offset:51200
    ds_read_b64_tr_b16 v[208:209], v27 offset:49152
    ds_read_b64_tr_b16 v[210:211], v27 offset:51200
    ds_read_b64_tr_b16 v[212:213], v28 offset:49152
    ds_read_b64_tr_b16 v[214:215], v28 offset:51200
    ds_read_b128 v[216:219], v29 offset:18432
    ds_read_b128 v[220:223], v29 offset:19456
    ds_read_b128 v[224:227], v29 offset:20480
    ds_read_b128 v[228:231], v29 offset:21504
    ds_read_b128 v[232:235], v29 offset:22528
    ds_read_b128 v[236:239], v29 offset:23552
    v_mfma_f32_16x16x32_bf16 v[64:67], v[160:163], v[176:179], v[64:67]
    v_mfma_f32_16x16x32_bf16 v[68:71], v[160:163], v[180:183], v[68:71]
    v_mfma_f32_16x16x32_bf16 v[72:75], v[160:163], v[184:187], v[72:75]
    v_mfma_f32_16x16x32_bf16 v[76:79], v[160:163], v[188:191], v[76:79]
    v_mfma_f32_16x16x32_bf16 v[80:83], v[160:163], v[192:195], v[80:83]
    v_mfma_f32_16x16x32_bf16 v[84:87], v[160:163], v[196:199], v[84:87]
    v_mfma_f32_16x16x32_bf16 v[88:91], v[164:167], v[176:179], v[88:91]
    v_mfma_f32_16x16x32_bf16 v[92:95], v[164:167], v[180:183], v[92:95]
    v_mfma_f32_16x16x32_bf16 v[96:99], v[164:167], v[184:187], v[96:99]
    v_mfma_f32_16x16x32_bf16 v[100:103], v[164:167], v[188:191], v[100:103]
    v_mfma_f32_16x16x32_bf16 v[104:107], v[164:167], v[192:195], v[104:107]
    v_mfma_f32_16x16x32_bf16 v[108:111], v[164:167], v[196:199], v[108:111]
    v_mfma_f32_16x16x32_bf16 v[112:115], v[168:171], v[176:179], v[112:115]
    v_mfma_f32_16x16x32_bf16 v[116:119], v[168:171], v[180:183], v[116:119]
    v_mfma_f32_16x16x32_bf16 v[120:123], v[168:171], v[184:187], v[120:123]
    v_mfma_f32_16x16x32_bf16 v[124:127], v[168:171], v[188:191], v[124:127]
    v_mfma_f32_16x16x32_bf16 v[128:131], v[168:171], v[192:195], v[128:131]
    v_mfma_f32_16x16x32_bf16 v[132:135], v[168:171], v[196:199], v[132:135]
    v_mfma_f32_16x16x32_bf16 v[136:139], v[172:175], v[176:179], v[136:139]
    v_mfma_f32_16x16x32_bf16 v[140:143], v[172:175], v[180:183], v[140:143]
    v_mfma_f32_16x16x32_bf16 v[144:147], v[172:175], v[184:187], v[144:147]
    v_mfma_f32_16x16x32_bf16 v[148:151], v[172:175], v[188:191], v[148:151]
    v_mfma_f32_16x16x32_bf16 v[152:155], v[172:175], v[192:195], v[152:155]
    v_mfma_f32_16x16x32_bf16 v[156:159], v[172:175], v[196:199], v[156:159]
    s_waitcnt vmcnt(4) lgkmcnt(0)
    s_barrier
    s_lshl_b32 s40, s34, 12
    s_add_u32 s40, s40, 118784
    s_mov_b32 m0, s40
    s_lshl_b32 s41, s34, 16
    s_add_u32 s41, s41, 1572864
    s_nop 0
    buffer_load_dwordx4 v8, s[8:11], s41 offen lds
    s_add_u32 s40, s40, 1024
    s_mov_b32 m0, s40
    s_add_u32 s41, s41, 16384
    s_nop 0
    buffer_load_dwordx4 v9, s[8:11], s41 offen lds
    s_add_u32 s40, s40, 1024
    s_mov_b32 m0, s40
    s_add_u32 s41, s41, 16384
    s_nop 0
    buffer_load_dwordx4 v10, s[8:11], s41 offen lds
    s_add_u32 s40, s40, 1024
    s_mov_b32 m0, s40
    s_add_u32 s41, s41, 16384
    s_nop 0
    buffer_load_dwordx4 v11, s[8:11], s41 offen lds
    ds_read_b64_tr_b16 v[160:161], v25 offset:0
    ds_read_b64_tr_b16 v[162:163], v25 offset:2048
    ds_read_b64_tr_b16 v[164:165], v26 offset:0
    ds_read_b64_tr_b16 v[166:167], v26 offset:2048
    ds_read_b64_tr_b16 v[168:169], v27 offset:0
    ds_read_b64_tr_b16 v[170:171], v27 offset:2048
    ds_read_b64_tr_b16 v[172:173], v28 offset:0
    ds_read_b64_tr_b16 v[174:175], v28 offset:2048
    ds_read_b128 v[176:179], v29 offset:24576
    ds_read_b128 v[180:183], v29 offset:25600
    ds_read_b128 v[184:187], v29 offset:26624
    ds_read_b128 v[188:191], v29 offset:27648
    ds_read_b128 v[192:195], v29 offset:28672
    ds_read_b128 v[196:199], v29 offset:29696
    v_mfma_f32_16x16x32_bf16 v[64:67], v[200:203], v[216:219], v[64:67]
    v_mfma_f32_16x16x32_bf16 v[68:71], v[200:203], v[220:223], v[68:71]
    v_mfma_f32_16x16x32_bf16 v[72:75], v[200:203], v[224:227], v[72:75]
    v_mfma_f32_16x16x32_bf16 v[76:79], v[200:203], v[228:231], v[76:79]
    v_mfma_f32_16x16x32_bf16 v[80:83], v[200:203], v[232:235], v[80:83]
    v_mfma_f32_16x16x32_bf16 v[84:87], v[200:203], v[236:239], v[84:87]
    v_mfma_f32_16x16x32_bf16 v[88:91], v[204:207], v[216:219], v[88:91]
    v_mfma_f32_16x16x32_bf16 v[92:95], v[204:207], v[220:223], v[92:95]
    v_mfma_f32_16x16x32_bf16 v[96:99], v[204:207], v[224:227], v[96:99]
    v_mfma_f32_16x16x32_bf16 v[100:103], v[204:207], v[228:231], v[100:103]
    v_mfma_f32_16x16x32_bf16 v[104:107], v[204:207], v[232:235], v[104:107]
    v_mfma_f32_16x16x32_bf16 v[108:111], v[204:207], v[236:239], v[108:111]
    v_mfma_f32_16x16x32_bf16 v[112:115], v[208:211], v[216:219], v[112:115]
    v_mfma_f32_16x16x32_bf16 v[116:119], v[208:211], v[220:223], v[116:119]
    v_mfma_f32_16x16x32_bf16 v[120:123], v[208:211], v[224:227], v[120:123]
    v_mfma_f32_16x16x32_bf16 v[124:127], v[208:211], v[228:231], v[124:127]
    v_mfma_f32_16x16x32_bf16 v[128:131], v[208:211], v[232:235], v[128:131]
    v_mfma_f32_16x16x32_bf16 v[132:135], v[208:211], v[236:239], v[132:135]
    v_mfma_f32_16x16x32_bf16 v[136:139], v[212:215], v[216:219], v[136:139]
    v_mfma_f32_16x16x32_bf16 v[140:143], v[212:215], v[220:223], v[140:143]
    v_mfma_f32_16x16x32_bf16 v[144:147], v[212:215], v[224:227], v[144:147]
    v_mfma_f32_16x16x32_bf16 v[148:151], v[212:215], v[228:231], v[148:151]
    v_mfma_f32_16x16x32_bf16 v[152:155], v[212:215], v[232:235], v[152:155]
    v_mfma_f32_16x16x32_bf16 v[156:159], v[212:215], v[236:239], v[156:159]
    s_waitcnt vmcnt(4) lgkmcnt(0)
    s_barrier
    s_lshl_b32 s40, s34, 12
    s_add_u32 s40, s40, 135168
    s_mov_b32 m0, s40
    s_lshl_b32 s41, s34, 16
    s_add_u32 s41, s41, 1835008
    s_nop 0
    buffer_load_dwordx4 v8, s[8:11], s41 offen lds
    s_add_u32 s40, s40, 1024
    s_mov_b32 m0, s40
    s_add_u32 s41, s41, 16384
    s_nop 0
    buffer_load_dwordx4 v9, s[8:11], s41 offen lds
    s_add_u32 s40, s40, 1024
    s_mov_b32 m0, s40
    s_add_u32 s41, s41, 16384
    s_nop 0
    buffer_load_dwordx4 v10, s[8:11], s41 offen lds
    s_add_u32 s40, s40, 1024
    s_mov_b32 m0, s40
    s_add_u32 s41, s41, 16384
    s_nop 0
    buffer_load_dwordx4 v11, s[8:11], s41 offen lds
    ds_read_b64_tr_b16 v[200:201], v25 offset:16384
    ds_read_b64_tr_b16 v[202:203], v25 offset:18432
    ds_read_b64_tr_b16 v[204:205], v26 offset:16384
    ds_read_b64_tr_b16 v[206:207], v26 offset:18432
    ds_read_b64_tr_b16 v[208:209], v27 offset:16384
    ds_read_b64_tr_b16 v[210:211], v27 offset:18432
    ds_read_b64_tr_b16 v[212:213], v28 offset:16384
    ds_read_b64_tr_b16 v[214:215], v28 offset:18432
    ds_read_b128 v[216:219], v29 offset:30720
    ds_read_b128 v[220:223], v29 offset:31744
    ds_read_b128 v[224:227], v29 offset:32768
    ds_read_b128 v[228:231], v29 offset:33792
    ds_read_b128 v[232:235], v29 offset:34816
    ds_read_b128 v[236:239], v29 offset:35840
    v_mfma_f32_16x16x32_bf16 v[64:67], v[160:163], v[176:179], v[64:67]
    v_mfma_f32_16x16x32_bf16 v[68:71], v[160:163], v[180:183], v[68:71]
    v_mfma_f32_16x16x32_bf16 v[72:75], v[160:163], v[184:187], v[72:75]
    v_mfma_f32_16x16x32_bf16 v[76:79], v[160:163], v[188:191], v[76:79]
    v_mfma_f32_16x16x32_bf16 v[80:83], v[160:163], v[192:195], v[80:83]
    v_mfma_f32_16x16x32_bf16 v[84:87], v[160:163], v[196:199], v[84:87]
    v_mfma_f32_16x16x32_bf16 v[88:91], v[164:167], v[176:179], v[88:91]
    v_mfma_f32_16x16x32_bf16 v[92:95], v[164:167], v[180:183], v[92:95]
    v_mfma_f32_16x16x32_bf16 v[96:99], v[164:167], v[184:187], v[96:99]
    v_mfma_f32_16x16x32_bf16 v[100:103], v[164:167], v[188:191], v[100:103]
    v_mfma_f32_16x16x32_bf16 v[104:107], v[164:167], v[192:195], v[104:107]
    v_mfma_f32_16x16x32_bf16 v[108:111], v[164:167], v[196:199], v[108:111]
    v_mfma_f32_16x16x32_bf16 v[112:115], v[168:171], v[176:179], v[112:115]
    v_mfma_f32_16x16x32_bf16 v[116:119], v[168:171], v[180:183], v[116:119]
    v_mfma_f32_16x16x32_bf16 v[120:123], v[168:171], v[184:187], v[120:123]
    v_mfma_f32_16x16x32_bf16 v[124:127], v[168:171], v[188:191], v[124:127]
    v_mfma_f32_16x16x32_bf16 v[128:131], v[168:171], v[192:195], v[128:131]
    v_mfma_f32_16x16x32_bf16 v[132:135], v[168:171], v[196:199], v[132:135]
    v_mfma_f32_16x16x32_bf16 v[136:139], v[172:175], v[176:179], v[136:139]
    v_mfma_f32_16x16x32_bf16 v[140:143], v[172:175], v[180:183], v[140:143]
    v_mfma_f32_16x16x32_bf16 v[144:147], v[172:175], v[184:187], v[144:147]
    v_mfma_f32_16x16x32_bf16 v[148:151], v[172:175], v[188:191], v[148:151]
    v_mfma_f32_16x16x32_bf16 v[152:155], v[172:175], v[192:195], v[152:155]
    v_mfma_f32_16x16x32_bf16 v[156:159], v[172:175], v[196:199], v[156:159]
    s_waitcnt vmcnt(4) lgkmcnt(0)
    s_barrier
    s_lshl_b32 s40, s34, 12
    s_add_u32 s40, s40, 86016
    s_mov_b32 m0, s40
    s_lshl_b32 s41, s34, 16
    s_add_u32 s41, s41, 2097152
    s_nop 0
    buffer_load_dwordx4 v8, s[8:11], s41 offen lds
    s_add_u32 s40, s40, 1024
    s_mov_b32 m0, s40
    s_add_u32 s41, s41, 16384
    s_nop 0
    buffer_load_dwordx4 v9, s[8:11], s41 offen lds
    s_add_u32 s40, s40, 1024
    s_mov_b32 m0, s40
    s_add_u32 s41, s41, 16384
    s_nop 0
    buffer_load_dwordx4 v10, s[8:11], s41 offen lds
    s_add_u32 s40, s40, 1024
    s_mov_b32 m0, s40
    s_add_u32 s41, s41, 16384
    s_nop 0
    buffer_load_dwordx4 v11, s[8:11], s41 offen lds
    ds_read_b64_tr_b16 v[160:161], v25 offset:32768
    ds_read_b64_tr_b16 v[162:163], v25 offset:34816
    ds_read_b64_tr_b16 v[164:165], v26 offset:32768
    ds_read_b64_tr_b16 v[166:167], v26 offset:34816
    ds_read_b64_tr_b16 v[168:169], v27 offset:32768
    ds_read_b64_tr_b16 v[170:171], v27 offset:34816
    ds_read_b64_tr_b16 v[172:173], v28 offset:32768
    ds_read_b64_tr_b16 v[174:175], v28 offset:34816
    ds_read_b128 v[176:179], v29 offset:36864
    ds_read_b128 v[180:183], v29 offset:37888
    ds_read_b128 v[184:187], v29 offset:38912
    ds_read_b128 v[188:191], v29 offset:39936
    ds_read_b128 v[192:195], v29 offset:40960
    ds_read_b128 v[196:199], v29 offset:41984
    v_mfma_f32_16x16x32_bf16 v[64:67], v[200:203], v[216:219], v[64:67]
    v_mfma_f32_16x16x32_bf16 v[68:71], v[200:203], v[220:223], v[68:71]
    v_mfma_f32_16x16x32_bf16 v[72:75], v[200:203], v[224:227], v[72:75]
    v_mfma_f32_16x16x32_bf16 v[76:79], v[200:203], v[228:231], v[76:79]
    v_mfma_f32_16x16x32_bf16 v[80:83], v[200:203], v[232:235], v[80:83]
    v_mfma_f32_16x16x32_bf16 v[84:87], v[200:203], v[236:239], v[84:87]
    v_mfma_f32_16x16x32_bf16 v[88:91], v[204:207], v[216:219], v[88:91]
    v_mfma_f32_16x16x32_bf16 v[92:95], v[204:207], v[220:223], v[92:95]
    v_mfma_f32_16x16x32_bf16 v[96:99], v[204:207], v[224:227], v[96:99]
    v_mfma_f32_16x16x32_bf16 v[100:103], v[204:207], v[228:231], v[100:103]
    v_mfma_f32_16x16x32_bf16 v[104:107], v[204:207], v[232:235], v[104:107]
    v_mfma_f32_16x16x32_bf16 v[108:111], v[204:207], v[236:239], v[108:111]
    v_mfma_f32_16x16x32_bf16 v[112:115], v[208:211], v[216:219], v[112:115]
    v_mfma_f32_16x16x32_bf16 v[116:119], v[208:211], v[220:223], v[116:119]
    v_mfma_f32_16x16x32_bf16 v[120:123], v[208:211], v[224:227], v[120:123]
    v_mfma_f32_16x16x32_bf16 v[124:127], v[208:211], v[228:231], v[124:127]
    v_mfma_f32_16x16x32_bf16 v[128:131], v[208:211], v[232:235], v[128:131]
    v_mfma_f32_16x16x32_bf16 v[132:135], v[208:211], v[236:239], v[132:135]
    v_mfma_f32_16x16x32_bf16 v[136:139], v[212:215], v[216:219], v[136:139]
    v_mfma_f32_16x16x32_bf16 v[140:143], v[212:215], v[220:223], v[140:143]
    v_mfma_f32_16x16x32_bf16 v[144:147], v[212:215], v[224:227], v[144:147]
    v_mfma_f32_16x16x32_bf16 v[148:151], v[212:215], v[228:231], v[148:151]
    v_mfma_f32_16x16x32_bf16 v[152:155], v[212:215], v[232:235], v[152:155]
    v_mfma_f32_16x16x32_bf16 v[156:159], v[212:215], v[236:239], v[156:159]
    s_waitcnt vmcnt(4) lgkmcnt(0)
    s_barrier
    s_lshl_b32 s40, s34, 12
    s_add_u32 s40, s40, 102400
    s_mov_b32 m0, s40
    s_lshl_b32 s41, s34, 16
    s_add_u32 s41, s41, 2359296
    s_nop 0
    buffer_load_dwordx4 v8, s[8:11], s41 offen lds
    s_add_u32 s40, s40, 1024
    s_mov_b32 m0, s40
    s_add_u32 s41, s41, 16384
    s_nop 0
    buffer_load_dwordx4 v9, s[8:11], s41 offen lds
    s_add_u32 s40, s40, 1024
    s_mov_b32 m0, s40
    s_add_u32 s41, s41, 16384
    s_nop 0
    buffer_load_dwordx4 v10, s[8:11], s41 offen lds
    s_add_u32 s40, s40, 1024
    s_mov_b32 m0, s40
    s_add_u32 s41, s41, 16384
    s_nop 0
    buffer_load_dwordx4 v11, s[8:11], s41 offen lds
    ds_read_b64_tr_b16 v[200:201], v25 offset:49152
    ds_read_b64_tr_b16 v[202:203], v25 offset:51200
    ds_read_b64_tr_b16 v[204:205], v26 offset:49152
    ds_read_b64_tr_b16 v[206:207], v26 offset:51200
    ds_read_b64_tr_b16 v[208:209], v27 offset:49152
    ds_read_b64_tr_b16 v[210:211], v27 offset:51200
    ds_read_b64_tr_b16 v[212:213], v28 offset:49152
    ds_read_b64_tr_b16 v[214:215], v28 offset:51200
    ds_read_b128 v[216:219], v29 offset:43008
    ds_read_b128 v[220:223], v29 offset:44032
    ds_read_b128 v[224:227], v29 offset:45056
    ds_read_b128 v[228:231], v29 offset:46080
    ds_read_b128 v[232:235], v29 offset:47104
    ds_read_b128 v[236:239], v29 offset:48128
    v_mfma_f32_16x16x32_bf16 v[64:67], v[160:163], v[176:179], v[64:67]
    v_mfma_f32_16x16x32_bf16 v[68:71], v[160:163], v[180:183], v[68:71]
    v_mfma_f32_16x16x32_bf16 v[72:75], v[160:163], v[184:187], v[72:75]
    v_mfma_f32_16x16x32_bf16 v[76:79], v[160:163], v[188:191], v[76:79]
    v_mfma_f32_16x16x32_bf16 v[80:83], v[160:163], v[192:195], v[80:83]
    v_mfma_f32_16x16x32_bf16 v[84:87], v[160:163], v[196:199], v[84:87]
    v_mfma_f32_16x16x32_bf16 v[88:91], v[164:167], v[176:179], v[88:91]
    v_mfma_f32_16x16x32_bf16 v[92:95], v[164:167], v[180:183], v[92:95]
    v_mfma_f32_16x16x32_bf16 v[96:99], v[164:167], v[184:187], v[96:99]
    v_mfma_f32_16x16x32_bf16 v[100:103], v[164:167], v[188:191], v[100:103]
    v_mfma_f32_16x16x32_bf16 v[104:107], v[164:167], v[192:195], v[104:107]
    v_mfma_f32_16x16x32_bf16 v[108:111], v[164:167], v[196:199], v[108:111]
    v_mfma_f32_16x16x32_bf16 v[112:115], v[168:171], v[176:179], v[112:115]
    v_mfma_f32_16x16x32_bf16 v[116:119], v[168:171], v[180:183], v[116:119]
    v_mfma_f32_16x16x32_bf16 v[120:123], v[168:171], v[184:187], v[120:123]
    v_mfma_f32_16x16x32_bf16 v[124:127], v[168:171], v[188:191], v[124:127]
    v_mfma_f32_16x16x32_bf16 v[128:131], v[168:171], v[192:195], v[128:131]
    v_mfma_f32_16x16x32_bf16 v[132:135], v[168:171], v[196:199], v[132:135]
    v_mfma_f32_16x16x32_bf16 v[136:139], v[172:175], v[176:179], v[136:139]
    v_mfma_f32_16x16x32_bf16 v[140:143], v[172:175], v[180:183], v[140:143]
    v_mfma_f32_16x16x32_bf16 v[144:147], v[172:175], v[184:187], v[144:147]
    v_mfma_f32_16x16x32_bf16 v[148:151], v[172:175], v[188:191], v[148:151]
    v_mfma_f32_16x16x32_bf16 v[152:155], v[172:175], v[192:195], v[152:155]
    v_mfma_f32_16x16x32_bf16 v[156:159], v[172:175], v[196:199], v[156:159]
    s_waitcnt vmcnt(4) lgkmcnt(0)
    s_barrier
    s_lshl_b32 s40, s34, 12
    s_add_u32 s40, s40, 118784
    s_mov_b32 m0, s40
    s_lshl_b32 s41, s34, 16
    s_add_u32 s41, s41, 2621440
    s_nop 0
    buffer_load_dwordx4 v8, s[8:11], s41 offen lds
    s_add_u32 s40, s40, 1024
    s_mov_b32 m0, s40
    s_add_u32 s41, s41, 16384
    s_nop 0
    buffer_load_dwordx4 v9, s[8:11], s41 offen lds
    s_add_u32 s40, s40, 1024
    s_mov_b32 m0, s40
    s_add_u32 s41, s41, 16384
    s_nop 0
    buffer_load_dwordx4 v10, s[8:11], s41 offen lds
    s_add_u32 s40, s40, 1024
    s_mov_b32 m0, s40
    s_add_u32 s41, s41, 16384
    s_nop 0
    buffer_load_dwordx4 v11, s[8:11], s41 offen lds
    ds_read_b64_tr_b16 v[160:161], v25 offset:0
    ds_read_b64_tr_b16 v[162:163], v25 offset:2048
    ds_read_b64_tr_b16 v[164:165], v26 offset:0
    ds_read_b64_tr_b16 v[166:167], v26 offset:2048
    ds_read_b64_tr_b16 v[168:169], v27 offset:0
    ds_read_b64_tr_b16 v[170:171], v27 offset:2048
    ds_read_b64_tr_b16 v[172:173], v28 offset:0
    ds_read_b64_tr_b16 v[174:175], v28 offset:2048
    ds_read_b128 v[176:179], v29 offset:49152
    ds_read_b128 v[180:183], v29 offset:50176
    ds_read_b128 v[184:187], v29 offset:51200
    ds_read_b128 v[188:191], v29 offset:52224
    ds_read_b128 v[192:195], v29 offset:53248
    ds_read_b128 v[196:199], v29 offset:54272
    v_mfma_f32_16x16x32_bf16 v[64:67], v[200:203], v[216:219], v[64:67]
    v_mfma_f32_16x16x32_bf16 v[68:71], v[200:203], v[220:223], v[68:71]
    v_mfma_f32_16x16x32_bf16 v[72:75], v[200:203], v[224:227], v[72:75]
    v_mfma_f32_16x16x32_bf16 v[76:79], v[200:203], v[228:231], v[76:79]
    v_mfma_f32_16x16x32_bf16 v[80:83], v[200:203], v[232:235], v[80:83]
    v_mfma_f32_16x16x32_bf16 v[84:87], v[200:203], v[236:239], v[84:87]
    v_mfma_f32_16x16x32_bf16 v[88:91], v[204:207], v[216:219], v[88:91]
    v_mfma_f32_16x16x32_bf16 v[92:95], v[204:207], v[220:223], v[92:95]
    v_mfma_f32_16x16x32_bf16 v[96:99], v[204:207], v[224:227], v[96:99]
    v_mfma_f32_16x16x32_bf16 v[100:103], v[204:207], v[228:231], v[100:103]
    v_mfma_f32_16x16x32_bf16 v[104:107], v[204:207], v[232:235], v[104:107]
    v_mfma_f32_16x16x32_bf16 v[108:111], v[204:207], v[236:239], v[108:111]
    v_mfma_f32_16x16x32_bf16 v[112:115], v[208:211], v[216:219], v[112:115]
    v_mfma_f32_16x16x32_bf16 v[116:119], v[208:211], v[220:223], v[116:119]
    v_mfma_f32_16x16x32_bf16 v[120:123], v[208:211], v[224:227], v[120:123]
    v_mfma_f32_16x16x32_bf16 v[124:127], v[208:211], v[228:231], v[124:127]
    v_mfma_f32_16x16x32_bf16 v[128:131], v[208:211], v[232:235], v[128:131]
    v_mfma_f32_16x16x32_bf16 v[132:135], v[208:211], v[236:239], v[132:135]
    v_mfma_f32_16x16x32_bf16 v[136:139], v[212:215], v[216:219], v[136:139]
    v_mfma_f32_16x16x32_bf16 v[140:143], v[212:215], v[220:223], v[140:143]
    v_mfma_f32_16x16x32_bf16 v[144:147], v[212:215], v[224:227], v[144:147]
    v_mfma_f32_16x16x32_bf16 v[148:151], v[212:215], v[228:231], v[148:151]
    v_mfma_f32_16x16x32_bf16 v[152:155], v[212:215], v[232:235], v[152:155]
    v_mfma_f32_16x16x32_bf16 v[156:159], v[212:215], v[236:239], v[156:159]
    s_waitcnt vmcnt(4) lgkmcnt(0)
    s_barrier
    s_lshl_b32 s40, s34, 12
    s_add_u32 s40, s40, 135168
    s_mov_b32 m0, s40
    s_lshl_b32 s41, s34, 16
    s_add_u32 s41, s41, 2883584
    s_nop 0
    buffer_load_dwordx4 v8, s[8:11], s41 offen lds
    s_add_u32 s40, s40, 1024
    s_mov_b32 m0, s40
    s_add_u32 s41, s41, 16384
    s_nop 0
    buffer_load_dwordx4 v9, s[8:11], s41 offen lds
    s_add_u32 s40, s40, 1024
    s_mov_b32 m0, s40
    s_add_u32 s41, s41, 16384
    s_nop 0
    buffer_load_dwordx4 v10, s[8:11], s41 offen lds
    s_add_u32 s40, s40, 1024
    s_mov_b32 m0, s40
    s_add_u32 s41, s41, 16384
    s_nop 0
    buffer_load_dwordx4 v11, s[8:11], s41 offen lds
    ds_read_b64_tr_b16 v[200:201], v25 offset:16384
    ds_read_b64_tr_b16 v[202:203], v25 offset:18432
    ds_read_b64_tr_b16 v[204:205], v26 offset:16384
    ds_read_b64_tr_b16 v[206:207], v26 offset:18432
    ds_read_b64_tr_b16 v[208:209], v27 offset:16384
    ds_read_b64_tr_b16 v[210:211], v27 offset:18432
    ds_read_b64_tr_b16 v[212:213], v28 offset:16384
    ds_read_b64_tr_b16 v[214:215], v28 offset:18432
    ds_read_b128 v[216:219], v29 offset:55296
    ds_read_b128 v[220:223], v29 offset:56320
    ds_read_b128 v[224:227], v29 offset:57344
    ds_read_b128 v[228:231], v29 offset:58368
    ds_read_b128 v[232:235], v29 offset:59392
    ds_read_b128 v[236:239], v29 offset:60416
    v_mfma_f32_16x16x32_bf16 v[64:67], v[160:163], v[176:179], v[64:67]
    v_mfma_f32_16x16x32_bf16 v[68:71], v[160:163], v[180:183], v[68:71]
    v_mfma_f32_16x16x32_bf16 v[72:75], v[160:163], v[184:187], v[72:75]
    v_mfma_f32_16x16x32_bf16 v[76:79], v[160:163], v[188:191], v[76:79]
    v_mfma_f32_16x16x32_bf16 v[80:83], v[160:163], v[192:195], v[80:83]
    v_mfma_f32_16x16x32_bf16 v[84:87], v[160:163], v[196:199], v[84:87]
    v_mfma_f32_16x16x32_bf16 v[88:91], v[164:167], v[176:179], v[88:91]
    v_mfma_f32_16x16x32_bf16 v[92:95], v[164:167], v[180:183], v[92:95]
    v_mfma_f32_16x16x32_bf16 v[96:99], v[164:167], v[184:187], v[96:99]
    v_mfma_f32_16x16x32_bf16 v[100:103], v[164:167], v[188:191], v[100:103]
    v_mfma_f32_16x16x32_bf16 v[104:107], v[164:167], v[192:195], v[104:107]
    v_mfma_f32_16x16x32_bf16 v[108:111], v[164:167], v[196:199], v[108:111]
    v_mfma_f32_16x16x32_bf16 v[112:115], v[168:171], v[176:179], v[112:115]
    v_mfma_f32_16x16x32_bf16 v[116:119], v[168:171], v[180:183], v[116:119]
    v_mfma_f32_16x16x32_bf16 v[120:123], v[168:171], v[184:187], v[120:123]
    v_mfma_f32_16x16x32_bf16 v[124:127], v[168:171], v[188:191], v[124:127]
    v_mfma_f32_16x16x32_bf16 v[128:131], v[168:171], v[192:195], v[128:131]
    v_mfma_f32_16x16x32_bf16 v[132:135], v[168:171], v[196:199], v[132:135]
    v_mfma_f32_16x16x32_bf16 v[136:139], v[172:175], v[176:179], v[136:139]
    v_mfma_f32_16x16x32_bf16 v[140:143], v[172:175], v[180:183], v[140:143]
    v_mfma_f32_16x16x32_bf16 v[144:147], v[172:175], v[184:187], v[144:147]
    v_mfma_f32_16x16x32_bf16 v[148:151], v[172:175], v[188:191], v[148:151]
    v_mfma_f32_16x16x32_bf16 v[152:155], v[172:175], v[192:195], v[152:155]
    v_mfma_f32_16x16x32_bf16 v[156:159], v[172:175], v[196:199], v[156:159]
    s_waitcnt vmcnt(4) lgkmcnt(0)
    s_barrier
    s_lshl_b32 s40, s34, 12
    s_add_u32 s40, s40, 86016
    s_mov_b32 m0, s40
    s_lshl_b32 s41, s34, 16
    s_add_u32 s41, s41, 3145728
    s_nop 0
    buffer_load_dwordx4 v8, s[8:11], s41 offen lds
    s_add_u32 s40, s40, 1024
    s_mov_b32 m0, s40
    s_add_u32 s41, s41, 16384
    s_nop 0
    buffer_load_dwordx4 v9, s[8:11], s41 offen lds
    s_add_u32 s40, s40, 1024
    s_mov_b32 m0, s40
    s_add_u32 s41, s41, 16384
    s_nop 0
    buffer_load_dwordx4 v10, s[8:11], s41 offen lds
    s_add_u32 s40, s40, 1024
    s_mov_b32 m0, s40
    s_add_u32 s41, s41, 16384
    s_nop 0
    buffer_load_dwordx4 v11, s[8:11], s41 offen lds
    ds_read_b64_tr_b16 v[160:161], v25 offset:32768
    ds_read_b64_tr_b16 v[162:163], v25 offset:34816
    ds_read_b64_tr_b16 v[164:165], v26 offset:32768
    ds_read_b64_tr_b16 v[166:167], v26 offset:34816
    ds_read_b64_tr_b16 v[168:169], v27 offset:32768
    ds_read_b64_tr_b16 v[170:171], v27 offset:34816
    ds_read_b64_tr_b16 v[172:173], v28 offset:32768
    ds_read_b64_tr_b16 v[174:175], v28 offset:34816
    ds_read_b128 v[176:179], v29 offset:61440
    ds_read_b128 v[180:183], v29 offset:62464
    ds_read_b128 v[184:187], v29 offset:63488
    ds_read_b128 v[188:191], v29 offset:64512
    ds_read_b128 v[192:195], v37 offset:0
    ds_read_b128 v[196:199], v37 offset:1024
    v_mfma_f32_16x16x32_bf16 v[64:67], v[200:203], v[216:219], v[64:67]
    v_mfma_f32_16x16x32_bf16 v[68:71], v[200:203], v[220:223], v[68:71]
    v_mfma_f32_16x16x32_bf16 v[72:75], v[200:203], v[224:227], v[72:75]
    v_mfma_f32_16x16x32_bf16 v[76:79], v[200:203], v[228:231], v[76:79]
    v_mfma_f32_16x16x32_bf16 v[80:83], v[200:203], v[232:235], v[80:83]
    v_mfma_f32_16x16x32_bf16 v[84:87], v[200:203], v[236:239], v[84:87]
    v_mfma_f32_16x16x32_bf16 v[88:91], v[204:207], v[216:219], v[88:91]
    v_mfma_f32_16x16x32_bf16 v[92:95], v[204:207], v[220:223], v[92:95]
    v_mfma_f32_16x16x32_bf16 v[96:99], v[204:207], v[224:227], v[96:99]
    v_mfma_f32_16x16x32_bf16 v[100:103], v[204:207], v[228:231], v[100:103]
    v_mfma_f32_16x16x32_bf16 v[104:107], v[204:207], v[232:235], v[104:107]
    v_mfma_f32_16x16x32_bf16 v[108:111], v[204:207], v[236:239], v[108:111]
    v_mfma_f32_16x16x32_bf16 v[112:115], v[208:211], v[216:219], v[112:115]
    v_mfma_f32_16x16x32_bf16 v[116:119], v[208:211], v[220:223], v[116:119]
    v_mfma_f32_16x16x32_bf16 v[120:123], v[208:211], v[224:227], v[120:123]
    v_mfma_f32_16x16x32_bf16 v[124:127], v[208:211], v[228:231], v[124:127]
    v_mfma_f32_16x16x32_bf16 v[128:131], v[208:211], v[232:235], v[128:131]
    v_mfma_f32_16x16x32_bf16 v[132:135], v[208:211], v[236:239], v[132:135]
    v_mfma_f32_16x16x32_bf16 v[136:139], v[212:215], v[216:219], v[136:139]
    v_mfma_f32_16x16x32_bf16 v[140:143], v[212:215], v[220:223], v[140:143]
    v_mfma_f32_16x16x32_bf16 v[144:147], v[212:215], v[224:227], v[144:147]
    v_mfma_f32_16x16x32_bf16 v[148:151], v[212:215], v[228:231], v[148:151]
    v_mfma_f32_16x16x32_bf16 v[152:155], v[212:215], v[232:235], v[152:155]
    v_mfma_f32_16x16x32_bf16 v[156:159], v[212:215], v[236:239], v[156:159]
    s_waitcnt vmcnt(4) lgkmcnt(0)
    s_barrier
    s_lshl_b32 s40, s34, 12
    s_add_u32 s40, s40, 102400
    s_mov_b32 m0, s40
    s_lshl_b32 s41, s34, 16
    s_add_u32 s41, s41, 3407872
    s_nop 0
    buffer_load_dwordx4 v8, s[8:11], s41 offen lds
    s_add_u32 s40, s40, 1024
    s_mov_b32 m0, s40
    s_add_u32 s41, s41, 16384
    s_nop 0
    buffer_load_dwordx4 v9, s[8:11], s41 offen lds
    s_add_u32 s40, s40, 1024
    s_mov_b32 m0, s40
    s_add_u32 s41, s41, 16384
    s_nop 0
    buffer_load_dwordx4 v10, s[8:11], s41 offen lds
    s_add_u32 s40, s40, 1024
    s_mov_b32 m0, s40
    s_add_u32 s41, s41, 16384
    s_nop 0
    buffer_load_dwordx4 v11, s[8:11], s41 offen lds
    ds_read_b64_tr_b16 v[200:201], v25 offset:49152
    ds_read_b64_tr_b16 v[202:203], v25 offset:51200
    ds_read_b64_tr_b16 v[204:205], v26 offset:49152
    ds_read_b64_tr_b16 v[206:207], v26 offset:51200
    ds_read_b64_tr_b16 v[208:209], v27 offset:49152
    ds_read_b64_tr_b16 v[210:211], v27 offset:51200
    ds_read_b64_tr_b16 v[212:213], v28 offset:49152
    ds_read_b64_tr_b16 v[214:215], v28 offset:51200
    ds_read_b128 v[216:219], v37 offset:2048
    ds_read_b128 v[220:223], v37 offset:3072
    ds_read_b128 v[224:227], v37 offset:4096
    ds_read_b128 v[228:231], v37 offset:5120
    ds_read_b128 v[232:235], v37 offset:6144
    ds_read_b128 v[236:239], v37 offset:7168
    v_mfma_f32_16x16x32_bf16 v[64:67], v[160:163], v[176:179], v[64:67]
    v_mfma_f32_16x16x32_bf16 v[68:71], v[160:163], v[180:183], v[68:71]
    v_mfma_f32_16x16x32_bf16 v[72:75], v[160:163], v[184:187], v[72:75]
    v_mfma_f32_16x16x32_bf16 v[76:79], v[160:163], v[188:191], v[76:79]
    v_mfma_f32_16x16x32_bf16 v[80:83], v[160:163], v[192:195], v[80:83]
    v_mfma_f32_16x16x32_bf16 v[84:87], v[160:163], v[196:199], v[84:87]
    v_mfma_f32_16x16x32_bf16 v[88:91], v[164:167], v[176:179], v[88:91]
    v_mfma_f32_16x16x32_bf16 v[92:95], v[164:167], v[180:183], v[92:95]
    v_mfma_f32_16x16x32_bf16 v[96:99], v[164:167], v[184:187], v[96:99]
    v_mfma_f32_16x16x32_bf16 v[100:103], v[164:167], v[188:191], v[100:103]
    v_mfma_f32_16x16x32_bf16 v[104:107], v[164:167], v[192:195], v[104:107]
    v_mfma_f32_16x16x32_bf16 v[108:111], v[164:167], v[196:199], v[108:111]
    v_mfma_f32_16x16x32_bf16 v[112:115], v[168:171], v[176:179], v[112:115]
    v_mfma_f32_16x16x32_bf16 v[116:119], v[168:171], v[180:183], v[116:119]
    v_mfma_f32_16x16x32_bf16 v[120:123], v[168:171], v[184:187], v[120:123]
    v_mfma_f32_16x16x32_bf16 v[124:127], v[168:171], v[188:191], v[124:127]
    v_mfma_f32_16x16x32_bf16 v[128:131], v[168:171], v[192:195], v[128:131]
    v_mfma_f32_16x16x32_bf16 v[132:135], v[168:171], v[196:199], v[132:135]
    v_mfma_f32_16x16x32_bf16 v[136:139], v[172:175], v[176:179], v[136:139]
    v_mfma_f32_16x16x32_bf16 v[140:143], v[172:175], v[180:183], v[140:143]
    v_mfma_f32_16x16x32_bf16 v[144:147], v[172:175], v[184:187], v[144:147]
    v_mfma_f32_16x16x32_bf16 v[148:151], v[172:175], v[188:191], v[148:151]
    v_mfma_f32_16x16x32_bf16 v[152:155], v[172:175], v[192:195], v[152:155]
    v_mfma_f32_16x16x32_bf16 v[156:159], v[172:175], v[196:199], v[156:159]
    s_waitcnt vmcnt(4) lgkmcnt(0)
    s_barrier
    ds_read_b64_tr_b16 v[160:161], v25 offset:0
    ds_read_b64_tr_b16 v[162:163], v25 offset:2048
    ds_read_b64_tr_b16 v[164:165], v26 offset:0
    ds_read_b64_tr_b16 v[166:167], v26 offset:2048
    ds_read_b64_tr_b16 v[168:169], v27 offset:0
    ds_read_b64_tr_b16 v[170:171], v27 offset:2048
    ds_read_b64_tr_b16 v[172:173], v28 offset:0
    ds_read_b64_tr_b16 v[174:175], v28 offset:2048
    ds_read_b128 v[176:179], v37 offset:8192
    ds_read_b128 v[180:183], v37 offset:9216
    ds_read_b128 v[184:187], v37 offset:10240
    ds_read_b128 v[188:191], v37 offset:11264
    ds_read_b128 v[192:195], v37 offset:12288
    ds_read_b128 v[196:199], v37 offset:13312
    v_mfma_f32_16x16x32_bf16 v[64:67], v[200:203], v[216:219], v[64:67]
    v_mfma_f32_16x16x32_bf16 v[68:71], v[200:203], v[220:223], v[68:71]
    v_mfma_f32_16x16x32_bf16 v[72:75], v[200:203], v[224:227], v[72:75]
    v_mfma_f32_16x16x32_bf16 v[76:79], v[200:203], v[228:231], v[76:79]
    v_mfma_f32_16x16x32_bf16 v[80:83], v[200:203], v[232:235], v[80:83]
    v_mfma_f32_16x16x32_bf16 v[84:87], v[200:203], v[236:239], v[84:87]
    v_mfma_f32_16x16x32_bf16 v[88:91], v[204:207], v[216:219], v[88:91]
    v_mfma_f32_16x16x32_bf16 v[92:95], v[204:207], v[220:223], v[92:95]
    v_mfma_f32_16x16x32_bf16 v[96:99], v[204:207], v[224:227], v[96:99]
    v_mfma_f32_16x16x32_bf16 v[100:103], v[204:207], v[228:231], v[100:103]
    v_mfma_f32_16x16x32_bf16 v[104:107], v[204:207], v[232:235], v[104:107]
    v_mfma_f32_16x16x32_bf16 v[108:111], v[204:207], v[236:239], v[108:111]
    v_mfma_f32_16x16x32_bf16 v[112:115], v[208:211], v[216:219], v[112:115]
    v_mfma_f32_16x16x32_bf16 v[116:119], v[208:211], v[220:223], v[116:119]
    v_mfma_f32_16x16x32_bf16 v[120:123], v[208:211], v[224:227], v[120:123]
    v_mfma_f32_16x16x32_bf16 v[124:127], v[208:211], v[228:231], v[124:127]
    v_mfma_f32_16x16x32_bf16 v[128:131], v[208:211], v[232:235], v[128:131]
    v_mfma_f32_16x16x32_bf16 v[132:135], v[208:211], v[236:239], v[132:135]
    v_mfma_f32_16x16x32_bf16 v[136:139], v[212:215], v[216:219], v[136:139]
    v_mfma_f32_16x16x32_bf16 v[140:143], v[212:215], v[220:223], v[140:143]
    v_mfma_f32_16x16x32_bf16 v[144:147], v[212:215], v[224:227], v[144:147]
    v_mfma_f32_16x16x32_bf16 v[148:151], v[212:215], v[228:231], v[148:151]
    v_mfma_f32_16x16x32_bf16 v[152:155], v[212:215], v[232:235], v[152:155]
    v_mfma_f32_16x16x32_bf16 v[156:159], v[212:215], v[236:239], v[156:159]
    s_waitcnt vmcnt(0) lgkmcnt(0)
    s_barrier
    ds_read_b64_tr_b16 v[200:201], v25 offset:16384
    ds_read_b64_tr_b16 v[202:203], v25 offset:18432
    ds_read_b64_tr_b16 v[204:205], v26 offset:16384
    ds_read_b64_tr_b16 v[206:207], v26 offset:18432
    ds_read_b64_tr_b16 v[208:209], v27 offset:16384
    ds_read_b64_tr_b16 v[210:211], v27 offset:18432
    ds_read_b64_tr_b16 v[212:213], v28 offset:16384
    ds_read_b64_tr_b16 v[214:215], v28 offset:18432
    ds_read_b128 v[216:219], v37 offset:14336
    ds_read_b128 v[220:223], v37 offset:15360
    ds_read_b128 v[224:227], v37 offset:16384
    ds_read_b128 v[228:231], v37 offset:17408
    ds_read_b128 v[232:235], v37 offset:18432
    ds_read_b128 v[236:239], v37 offset:19456
    v_mfma_f32_16x16x32_bf16 v[64:67], v[160:163], v[176:179], v[64:67]
    v_mfma_f32_16x16x32_bf16 v[68:71], v[160:163], v[180:183], v[68:71]
    v_mfma_f32_16x16x32_bf16 v[72:75], v[160:163], v[184:187], v[72:75]
    v_mfma_f32_16x16x32_bf16 v[76:79], v[160:163], v[188:191], v[76:79]
    v_mfma_f32_16x16x32_bf16 v[80:83], v[160:163], v[192:195], v[80:83]
    v_mfma_f32_16x16x32_bf16 v[84:87], v[160:163], v[196:199], v[84:87]
    v_mfma_f32_16x16x32_bf16 v[88:91], v[164:167], v[176:179], v[88:91]
    v_mfma_f32_16x16x32_bf16 v[92:95], v[164:167], v[180:183], v[92:95]
    v_mfma_f32_16x16x32_bf16 v[96:99], v[164:167], v[184:187], v[96:99]
    v_mfma_f32_16x16x32_bf16 v[100:103], v[164:167], v[188:191], v[100:103]
    v_mfma_f32_16x16x32_bf16 v[104:107], v[164:167], v[192:195], v[104:107]
    v_mfma_f32_16x16x32_bf16 v[108:111], v[164:167], v[196:199], v[108:111]
    v_mfma_f32_16x16x32_bf16 v[112:115], v[168:171], v[176:179], v[112:115]
    v_mfma_f32_16x16x32_bf16 v[116:119], v[168:171], v[180:183], v[116:119]
    v_mfma_f32_16x16x32_bf16 v[120:123], v[168:171], v[184:187], v[120:123]
    v_mfma_f32_16x16x32_bf16 v[124:127], v[168:171], v[188:191], v[124:127]
    v_mfma_f32_16x16x32_bf16 v[128:131], v[168:171], v[192:195], v[128:131]
    v_mfma_f32_16x16x32_bf16 v[132:135], v[168:171], v[196:199], v[132:135]
    v_mfma_f32_16x16x32_bf16 v[136:139], v[172:175], v[176:179], v[136:139]
    v_mfma_f32_16x16x32_bf16 v[140:143], v[172:175], v[180:183], v[140:143]
    v_mfma_f32_16x16x32_bf16 v[144:147], v[172:175], v[184:187], v[144:147]
    v_mfma_f32_16x16x32_bf16 v[148:151], v[172:175], v[188:191], v[148:151]
    v_mfma_f32_16x16x32_bf16 v[152:155], v[172:175], v[192:195], v[152:155]
    v_mfma_f32_16x16x32_bf16 v[156:159], v[172:175], v[196:199], v[156:159]
    s_waitcnt lgkmcnt(0)
    v_mfma_f32_16x16x32_bf16 v[64:67], v[200:203], v[216:219], v[64:67]
    v_mfma_f32_16x16x32_bf16 v[68:71], v[200:203], v[220:223], v[68:71]
    v_mfma_f32_16x16x32_bf16 v[72:75], v[200:203], v[224:227], v[72:75]
    v_mfma_f32_16x16x32_bf16 v[76:79], v[200:203], v[228:231], v[76:79]
    v_mfma_f32_16x16x32_bf16 v[80:83], v[200:203], v[232:235], v[80:83]
    v_mfma_f32_16x16x32_bf16 v[84:87], v[200:203], v[236:239], v[84:87]
    v_mfma_f32_16x16x32_bf16 v[88:91], v[204:207], v[216:219], v[88:91]
    v_mfma_f32_16x16x32_bf16 v[92:95], v[204:207], v[220:223], v[92:95]
    v_mfma_f32_16x16x32_bf16 v[96:99], v[204:207], v[224:227], v[96:99]
    v_mfma_f32_16x16x32_bf16 v[100:103], v[204:207], v[228:231], v[100:103]
    v_mfma_f32_16x16x32_bf16 v[104:107], v[204:207], v[232:235], v[104:107]
    v_mfma_f32_16x16x32_bf16 v[108:111], v[204:207], v[236:239], v[108:111]
    v_mfma_f32_16x16x32_bf16 v[112:115], v[208:211], v[216:219], v[112:115]
    v_mfma_f32_16x16x32_bf16 v[116:119], v[208:211], v[220:223], v[116:119]
    v_mfma_f32_16x16x32_bf16 v[120:123], v[208:211], v[224:227], v[120:123]
    v_mfma_f32_16x16x32_bf16 v[124:127], v[208:211], v[228:231], v[124:127]
    v_mfma_f32_16x16x32_bf16 v[128:131], v[208:211], v[232:235], v[128:131]
    v_mfma_f32_16x16x32_bf16 v[132:135], v[208:211], v[236:239], v[132:135]
    v_mfma_f32_16x16x32_bf16 v[136:139], v[212:215], v[216:219], v[136:139]
    v_mfma_f32_16x16x32_bf16 v[140:143], v[212:215], v[220:223], v[140:143]
    v_mfma_f32_16x16x32_bf16 v[144:147], v[212:215], v[224:227], v[144:147]
    v_mfma_f32_16x16x32_bf16 v[148:151], v[212:215], v[228:231], v[148:151]
    v_mfma_f32_16x16x32_bf16 v[152:155], v[212:215], v[232:235], v[152:155]
    v_mfma_f32_16x16x32_bf16 v[156:159], v[212:215], v[236:239], v[156:159]
    s_nop 7
    s_nop 7
    s_barrier
    s_lshl_b32 s40, s34, 13
    s_add_u32 s41, s40, 0
    s_add_u32 s40, s40, 0
    s_mov_b32 m0, s40
    s_nop 0
    buffer_load_dwordx4 v4, s[12:15], s41 offen offset:0 lds
    buffer_load_dwordx4 v5, s[12:15], s41 offen offset:1024 lds
    buffer_load_dwordx4 v6, s[12:15], s41 offen offset:2048 lds
    buffer_load_dwordx4 v7, s[12:15], s41 offen offset:3072 lds
    s_add_u32 s40, s40, 4096
    s_add_u32 s41, s41, 4096
    s_mov_b32 m0, s40
    s_nop 0
    buffer_load_dwordx4 v4, s[12:15], s41 offen offset:0 lds
    buffer_load_dwordx4 v5, s[12:15], s41 offen offset:1024 lds
    buffer_load_dwordx4 v6, s[12:15], s41 offen offset:2048 lds
    buffer_load_dwordx4 v7, s[12:15], s41 offen offset:3072 lds
    s_lshl_b32 s40, s34, 13
    s_add_u32 s41, s40, 0
    s_add_u32 s40, s40, 65536
    s_mov_b32 m0, s40
    s_nop 0
    buffer_load_dwordx4 v4, s[16:19], s41 offen offset:0 lds
    buffer_load_dwordx4 v5, s[16:19], s41 offen offset:1024 lds
    buffer_load_dwordx4 v6, s[16:19], s41 offen offset:2048 lds
    buffer_load_dwordx4 v7, s[16:19], s41 offen offset:3072 lds
    s_add_u32 s40, s40, 4096
    s_add_u32 s41, s41, 4096
    s_mov_b32 m0, s40
    s_nop 0
    buffer_load_dwordx4 v4, s[16:19], s41 offen offset:0 lds
    buffer_load_dwordx4 v5, s[16:19], s41 offen offset:1024 lds
    buffer_load_dwordx4 v6, s[16:19], s41 offen offset:2048 lds
    buffer_load_dwordx4 v7, s[16:19], s41 offen offset:3072 lds
    s_lshl_b32 s40, s34, 13
    s_add_u32 s41, s40, 32768
    s_add_u32 s40, s40, 32768
    s_mov_b32 m0, s40
    s_nop 0
    buffer_load_dwordx4 v4, s[12:15], s41 offen offset:0 lds
    buffer_load_dwordx4 v5, s[12:15], s41 offen offset:1024 lds
    buffer_load_dwordx4 v6, s[12:15], s41 offen offset:2048 lds
    buffer_load_dwordx4 v7, s[12:15], s41 offen offset:3072 lds
    s_add_u32 s40, s40, 4096
    s_add_u32 s41, s41, 4096
    s_mov_b32 m0, s40
    s_nop 0
    buffer_load_dwordx4 v4, s[12:15], s41 offen offset:0 lds
    buffer_load_dwordx4 v5, s[12:15], s41 offen offset:1024 lds
    buffer_load_dwordx4 v6, s[12:15], s41 offen offset:2048 lds
    buffer_load_dwordx4 v7, s[12:15], s41 offen offset:3072 lds
    v_mul_u32_u24 v32, 528, v2
    v_lshl_add_u32 v32, v3, 3, v32
    s_lshl_b32 s40, s34, 7
    s_add_u32 s40, s40, 98304
    v_add_u32 v32, s40, v32
    v_cvt_pk_bf16_f32 v160, v64, v65
    v_cvt_pk_bf16_f32 v161, v66, v67
    ds_write_b64 v32, v[160:161] offset:0
    v_cvt_pk_bf16_f32 v164, v68, v69
    v_cvt_pk_bf16_f32 v165, v70, v71
    ds_write_b64 v32, v[164:165] offset:8448
    v_cvt_pk_bf16_f32 v168, v72, v73
    v_cvt_pk_bf16_f32 v169, v74, v75
    ds_write_b64 v32, v[168:169] offset:16896
    v_cvt_pk_bf16_f32 v172, v76, v77
    v_cvt_pk_bf16_f32 v173, v78, v79
    ds_write_b64 v32, v[172:173] offset:25344
    v_cvt_pk_bf16_f32 v176, v80, v81
    v_cvt_pk_bf16_f32 v177, v82, v83
    ds_write_b64 v32, v[176:177] offset:33792
    v_cvt_pk_bf16_f32 v180, v84, v85
    v_cvt_pk_bf16_f32 v181, v86, v87
    ds_write_b64 v32, v[180:181] offset:42240
    v_cvt_pk_bf16_f32 v160, v88, v89
    v_cvt_pk_bf16_f32 v161, v90, v91
    ds_write_b64 v32, v[160:161] offset:32
    v_cvt_pk_bf16_f32 v164, v92, v93
    v_cvt_pk_bf16_f32 v165, v94, v95
    ds_write_b64 v32, v[164:165] offset:8480
    v_cvt_pk_bf16_f32 v168, v96, v97
    v_cvt_pk_bf16_f32 v169, v98, v99
    ds_write_b64 v32, v[168:169] offset:16928
    v_cvt_pk_bf16_f32 v172, v100, v101
    v_cvt_pk_bf16_f32 v173, v102, v103
    ds_write_b64 v32, v[172:173] offset:25376
    v_cvt_pk_bf16_f32 v176, v104, v105
    v_cvt_pk_bf16_f32 v177, v106, v107
    ds_write_b64 v32, v[176:177] offset:33824
    v_cvt_pk_bf16_f32 v180, v108, v109
    v_cvt_pk_bf16_f32 v181, v110, v111
    ds_write_b64 v32, v[180:181] offset:42272
    v_cvt_pk_bf16_f32 v160, v112, v113
    v_cvt_pk_bf16_f32 v161, v114, v115
    ds_write_b64 v32, v[160:161] offset:64
    v_cvt_pk_bf16_f32 v164, v116, v117
    v_cvt_pk_bf16_f32 v165, v118, v119
    ds_write_b64 v32, v[164:165] offset:8512
    v_cvt_pk_bf16_f32 v168, v120, v121
    v_cvt_pk_bf16_f32 v169, v122, v123
    ds_write_b64 v32, v[168:169] offset:16960
    v_cvt_pk_bf16_f32 v172, v124, v125
    v_cvt_pk_bf16_f32 v173, v126, v127
    ds_write_b64 v32, v[172:173] offset:25408
    v_cvt_pk_bf16_f32 v176, v128, v129
    v_cvt_pk_bf16_f32 v177, v130, v131
    ds_write_b64 v32, v[176:177] offset:33856
    v_cvt_pk_bf16_f32 v180, v132, v133
    v_cvt_pk_bf16_f32 v181, v134, v135
    ds_write_b64 v32, v[180:181] offset:42304
    v_cvt_pk_bf16_f32 v160, v136, v137
    v_cvt_pk_bf16_f32 v161, v138, v139
    ds_write_b64 v32, v[160:161] offset:96
    v_cvt_pk_bf16_f32 v164, v140, v141
    v_cvt_pk_bf16_f32 v165, v142, v143
    ds_write_b64 v32, v[164:165] offset:8544
    v_cvt_pk_bf16_f32 v168, v144, v145
    v_cvt_pk_bf16_f32 v169, v146, v147
    ds_write_b64 v32, v[168:169] offset:16992
    v_cvt_pk_bf16_f32 v172, v148, v149
    v_cvt_pk_bf16_f32 v173, v150, v151
    ds_write_b64 v32, v[172:173] offset:25440
    v_cvt_pk_bf16_f32 v176, v152, v153
    v_cvt_pk_bf16_f32 v177, v154, v155
    ds_write_b64 v32, v[176:177] offset:33888
    v_cvt_pk_bf16_f32 v180, v156, v157
    v_cvt_pk_bf16_f32 v181, v158, v159
    ds_write_b64 v32, v[180:181] offset:42336
    s_waitcnt lgkmcnt(0)
    s_barrier
    s_mul_i32 s40, s38, 48
    v_add_u32 v32, s40, v2
    v_mul_u32_u24 v32, 528, v32
    v_lshl_add_u32 v32, v3, 4, v32
    v_add_u32 v32, 98304, v32
    ds_read_b128 v[64:67], v32 offset:0
    ds_read_b128 v[68:71], v32 offset:8448
    ds_read_b128 v[72:75], v32 offset:16896
    ds_read_b128 v[76:79], v32 offset:64
    ds_read_b128 v[80:83], v32 offset:8512
    ds_read_b128 v[84:87], v32 offset:16960
    ds_read_b128 v[88:91], v32 offset:128
    ds_read_b128 v[92:95], v32 offset:8576
    ds_read_b128 v[96:99], v32 offset:17024
    ds_read_b128 v[100:103], v32 offset:192
    ds_read_b128 v[104:107], v32 offset:8640
    ds_read_b128 v[108:111], v32 offset:17088
    ds_read_b128 v[112:115], v32 offset:256
    ds_read_b128 v[116:119], v32 offset:8704
    ds_read_b128 v[120:123], v32 offset:17152
    ds_read_b128 v[124:127], v32 offset:320
    ds_read_b128 v[128:131], v32 offset:8768
    ds_read_b128 v[132:135], v32 offset:17216
    ds_read_b128 v[136:139], v32 offset:384
    ds_read_b128 v[140:143], v32 offset:8832
    ds_read_b128 v[144:147], v32 offset:17280
    ds_read_b128 v[148:151], v32 offset:448
    ds_read_b128 v[152:155], v32 offset:8896
    ds_read_b128 v[156:159], v32 offset:17344
    s_waitcnt lgkmcnt(0)
    s_barrier
    v_mov_b32 v236, 0xff800000
    v_mov_b32 v239, 0xff800000
    v_mov_b32 v242, 0
    v_mov_b32 v245, 0
    v_mov_b32 v237, 0xff800000
    v_mov_b32 v240, 0xff800000
    v_mov_b32 v243, 0
    v_mov_b32 v246, 0
    v_mov_b32 v238, 0xff800000
    v_mov_b32 v241, 0xff800000
    v_mov_b32 v244, 0
    v_mov_b32 v247, 0
    v_accvgpr_write_b32 a0, 0
    v_accvgpr_write_b32 a1, 0
    v_accvgpr_write_b32 a2, 0
    v_accvgpr_write_b32 a3, 0
    v_accvgpr_write_b32 a4, 0
    v_accvgpr_write_b32 a5, 0
    v_accvgpr_write_b32 a6, 0
    v_accvgpr_write_b32 a7, 0
    v_accvgpr_write_b32 a8, 0
    v_accvgpr_write_b32 a9, 0
    v_accvgpr_write_b32 a10, 0
    v_accvgpr_write_b32 a11, 0
    v_accvgpr_write_b32 a12, 0
    v_accvgpr_write_b32 a13, 0
    v_accvgpr_write_b32 a14, 0
    v_accvgpr_write_b32 a15, 0
    v_accvgpr_write_b32 a16, 0
    v_accvgpr_write_b32 a17, 0
    v_accvgpr_write_b32 a18, 0
    v_accvgpr_write_b32 a19, 0
    v_accvgpr_write_b32 a20, 0
    v_accvgpr_write_b32 a21, 0
    v_accvgpr_write_b32 a22, 0
    v_accvgpr_write_b32 a23, 0
    v_accvgpr_write_b32 a24, 0
    v_accvgpr_write_b32 a25, 0
    v_accvgpr_write_b32 a26, 0
    v_accvgpr_write_b32 a27, 0
    v_accvgpr_write_b32 a28, 0
    v_accvgpr_write_b32 a29, 0
    v_accvgpr_write_b32 a30, 0
    v_accvgpr_write_b32 a31, 0
    v_accvgpr_write_b32 a32, 0
    v_accvgpr_write_b32 a33, 0
    v_accvgpr_write_b32 a34, 0
    v_accvgpr_write_b32 a35, 0
    v_accvgpr_write_b32 a36, 0
    v_accvgpr_write_b32 a37, 0
    v_accvgpr_write_b32 a38, 0
    v_accvgpr_write_b32 a39, 0
    v_accvgpr_write_b32 a40, 0
    v_accvgpr_write_b32 a41, 0
    v_accvgpr_write_b32 a42, 0
    v_accvgpr_write_b32 a43, 0
    v_accvgpr_write_b32 a44, 0
    v_accvgpr_write_b32 a45, 0
    v_accvgpr_write_b32 a46, 0
    v_accvgpr_write_b32 a47, 0
    v_accvgpr_write_b32 a48, 0
    v_accvgpr_write_b32 a49, 0
    v_accvgpr_write_b32 a50, 0
    v_accvgpr_write_b32 a51, 0
    v_accvgpr_write_b32 a52, 0
    v_accvgpr_write_b32 a53, 0
    v_accvgpr_write_b32 a54, 0
    v_accvgpr_write_b32 a55, 0
    v_accvgpr_write_b32 a56, 0
    v_accvgpr_write_b32 a57, 0
    v_accvgpr_write_b32 a58, 0
    v_accvgpr_write_b32 a59, 0
    v_accvgpr_write_b32 a60, 0
    v_accvgpr_write_b32 a61, 0
    v_accvgpr_write_b32 a62, 0
    v_accvgpr_write_b32 a63, 0
    v_accvgpr_write_b32 a64, 0
    v_accvgpr_write_b32 a65, 0
    v_accvgpr_write_b32 a66, 0
    v_accvgpr_write_b32 a67, 0
    v_accvgpr_write_b32 a68, 0
    v_accvgpr_write_b32 a69, 0
    v_accvgpr_write_b32 a70, 0
    v_accvgpr_write_b32 a71, 0
    v_accvgpr_write_b32 a72, 0
    v_accvgpr_write_b32 a73, 0
    v_accvgpr_write_b32 a74, 0
    v_accvgpr_write_b32 a75, 0
    v_accvgpr_write_b32 a76, 0
    v_accvgpr_write_b32 a77, 0
    v_accvgpr_write_b32 a78, 0
    v_accvgpr_write_b32 a79, 0
    v_accvgpr_write_b32 a80, 0
    v_accvgpr_write_b32 a81, 0
    v_accvgpr_write_b32 a82, 0
    v_accvgpr_write_b32 a83, 0
    v_accvgpr_write_b32 a84, 0
    v_accvgpr_write_b32 a85, 0
    v_accvgpr_write_b32 a86, 0
    v_accvgpr_write_b32 a87, 0
    v_accvgpr_write_b32 a88, 0
    v_accvgpr_write_b32 a89, 0
    v_accvgpr_write_b32 a90, 0
    v_accvgpr_write_b32 a91, 0
    v_accvgpr_write_b32 a92, 0
    v_accvgpr_write_b32 a93, 0
    v_accvgpr_write_b32 a94, 0
    v_accvgpr_write_b32 a95, 0
    v_accvgpr_write_b32 a96, 0
    v_accvgpr_write_b32 a97, 0
    v_accvgpr_write_b32 a98, 0
    v_accvgpr_write_b32 a99, 0
    v_accvgpr_write_b32 a100, 0
    v_accvgpr_write_b32 a101, 0
    v_accvgpr_write_b32 a102, 0
    v_accvgpr_write_b32 a103, 0
    v_accvgpr_write_b32 a104, 0
    v_accvgpr_write_b32 a105, 0
    v_accvgpr_write_b32 a106, 0
    v_accvgpr_write_b32 a107, 0
    v_accvgpr_write_b32 a108, 0
    v_accvgpr_write_b32 a109, 0
    v_accvgpr_write_b32 a110, 0
    v_accvgpr_write_b32 a111, 0
    v_accvgpr_write_b32 a112, 0
    v_accvgpr_write_b32 a113, 0
    v_accvgpr_write_b32 a114, 0
    v_accvgpr_write_b32 a115, 0
    v_accvgpr_write_b32 a116, 0
    v_accvgpr_write_b32 a117, 0
    v_accvgpr_write_b32 a118, 0
    v_accvgpr_write_b32 a119, 0
    v_accvgpr_write_b32 a120, 0
    v_accvgpr_write_b32 a121, 0
    v_accvgpr_write_b32 a122, 0
    v_accvgpr_write_b32 a123, 0
    v_accvgpr_write_b32 a124, 0
    v_accvgpr_write_b32 a125, 0
    v_accvgpr_write_b32 a126, 0
    v_accvgpr_write_b32 a127, 0
    v_accvgpr_write_b32 a128, 0
    v_accvgpr_write_b32 a129, 0
    v_accvgpr_write_b32 a130, 0
    v_accvgpr_write_b32 a131, 0
    v_accvgpr_write_b32 a132, 0
    v_accvgpr_write_b32 a133, 0
    v_accvgpr_write_b32 a134, 0
    v_accvgpr_write_b32 a135, 0
    v_accvgpr_write_b32 a136, 0
    v_accvgpr_write_b32 a137, 0
    v_accvgpr_write_b32 a138, 0
    v_accvgpr_write_b32 a139, 0
    v_accvgpr_write_b32 a140, 0
    v_accvgpr_write_b32 a141, 0
    v_accvgpr_write_b32 a142, 0
    v_accvgpr_write_b32 a143, 0
    v_accvgpr_write_b32 a144, 0
    v_accvgpr_write_b32 a145, 0
    v_accvgpr_write_b32 a146, 0
    v_accvgpr_write_b32 a147, 0
    v_accvgpr_write_b32 a148, 0
    v_accvgpr_write_b32 a149, 0
    v_accvgpr_write_b32 a150, 0
    v_accvgpr_write_b32 a151, 0
    v_accvgpr_write_b32 a152, 0
    v_accvgpr_write_b32 a153, 0
    v_accvgpr_write_b32 a154, 0
    v_accvgpr_write_b32 a155, 0
    v_accvgpr_write_b32 a156, 0
    v_accvgpr_write_b32 a157, 0
    v_accvgpr_write_b32 a158, 0
    v_accvgpr_write_b32 a159, 0
    v_accvgpr_write_b32 a160, 0
    v_accvgpr_write_b32 a161, 0
    v_accvgpr_write_b32 a162, 0
    v_accvgpr_write_b32 a163, 0
    v_accvgpr_write_b32 a164, 0
    v_accvgpr_write_b32 a165, 0
    v_accvgpr_write_b32 a166, 0
    v_accvgpr_write_b32 a167, 0
    v_accvgpr_write_b32 a168, 0
    v_accvgpr_write_b32 a169, 0
    v_accvgpr_write_b32 a170, 0
    v_accvgpr_write_b32 a171, 0
    v_accvgpr_write_b32 a172, 0
    v_accvgpr_write_b32 a173, 0
    v_accvgpr_write_b32 a174, 0
    v_accvgpr_write_b32 a175, 0
    v_accvgpr_write_b32 a176, 0
    v_accvgpr_write_b32 a177, 0
    v_accvgpr_write_b32 a178, 0
    v_accvgpr_write_b32 a179, 0
    v_accvgpr_write_b32 a180, 0
    v_accvgpr_write_b32 a181, 0
    v_accvgpr_write_b32 a182, 0
    v_accvgpr_write_b32 a183, 0
    v_accvgpr_write_b32 a184, 0
    v_accvgpr_write_b32 a185, 0
    v_accvgpr_write_b32 a186, 0
    v_accvgpr_write_b32 a187, 0
    v_accvgpr_write_b32 a188, 0
    v_accvgpr_write_b32 a189, 0
    v_accvgpr_write_b32 a190, 0
    v_accvgpr_write_b32 a191, 0
    s_mov_b32 s46, 0x3db8aa3b
    s_waitcnt vmcnt(16)
    s_barrier
    ds_read_b128 v[220:223], v13 offset:0
    ds_read_b128 v[224:227], v13 offset:8192
    ds_read_b128 v[228:231], v14 offset:0
    ds_read_b128 v[232:235], v14 offset:8192
    s_waitcnt lgkmcnt(2)
    v_mfma_f32_16x16x32_bf16 v[160:163], v[220:223], v[64:67], 0
    v_mfma_f32_16x16x32_bf16 v[164:167], v[220:223], v[68:71], 0
    v_mfma_f32_16x16x32_bf16 v[168:171], v[220:223], v[72:75], 0
    v_mfma_f32_16x16x32_bf16 v[172:175], v[224:227], v[64:67], 0
    v_mfma_f32_16x16x32_bf16 v[176:179], v[224:227], v[68:71], 0
    v_mfma_f32_16x16x32_bf16 v[180:183], v[224:227], v[72:75], 0
    ds_read_b128 v[220:223], v15 offset:0
    ds_read_b128 v[224:227], v15 offset:8192
    s_waitcnt lgkmcnt(2)
    v_mfma_f32_16x16x32_bf16 v[160:163], v[228:231], v[76:79], v[160:163]
    v_mfma_f32_16x16x32_bf16 v[164:167], v[228:231], v[80:83], v[164:167]
    v_mfma_f32_16x16x32_bf16 v[168:171], v[228:231], v[84:87], v[168:171]
    v_mfma_f32_16x16x32_bf16 v[172:175], v[232:235], v[76:79], v[172:175]
    v_mfma_f32_16x16x32_bf16 v[176:179], v[232:235], v[80:83], v[176:179]
    v_mfma_f32_16x16x32_bf16 v[180:183], v[232:235], v[84:87], v[180:183]
    ds_read_b128 v[228:231], v16 offset:0
    ds_read_b128 v[232:235], v16 offset:8192
    s_waitcnt lgkmcnt(2)
    v_mfma_f32_16x16x32_bf16 v[160:163], v[220:223], v[88:91], v[160:163]
    v_mfma_f32_16x16x32_bf16 v[164:167], v[220:223], v[92:95], v[164:167]
    v_mfma_f32_16x16x32_bf16 v[168:171], v[220:223], v[96:99], v[168:171]
    v_mfma_f32_16x16x32_bf16 v[172:175], v[224:227], v[88:91], v[172:175]
    v_mfma_f32_16x16x32_bf16 v[176:179], v[224:227], v[92:95], v[176:179]
    v_mfma_f32_16x16x32_bf16 v[180:183], v[224:227], v[96:99], v[180:183]
    ds_read_b128 v[220:223], v13 offset:256
    ds_read_b128 v[224:227], v13 offset:8448
    s_waitcnt lgkmcnt(2)
    v_mfma_f32_16x16x32_bf16 v[160:163], v[228:231], v[100:103], v[160:163]
    v_mfma_f32_16x16x32_bf16 v[164:167], v[228:231], v[104:107], v[164:167]
    v_mfma_f32_16x16x32_bf16 v[168:171], v[228:231], v[108:111], v[168:171]
    v_mfma_f32_16x16x32_bf16 v[172:175], v[232:235], v[100:103], v[172:175]
    v_mfma_f32_16x16x32_bf16 v[176:179], v[232:235], v[104:107], v[176:179]
    v_mfma_f32_16x16x32_bf16 v[180:183], v[232:235], v[108:111], v[180:183]
    ds_read_b128 v[228:231], v14 offset:256
    ds_read_b128 v[232:235], v14 offset:8448
    s_waitcnt lgkmcnt(2)
    v_mfma_f32_16x16x32_bf16 v[160:163], v[220:223], v[112:115], v[160:163]
    v_mfma_f32_16x16x32_bf16 v[164:167], v[220:223], v[116:119], v[164:167]
    v_mfma_f32_16x16x32_bf16 v[168:171], v[220:223], v[120:123], v[168:171]
    v_mfma_f32_16x16x32_bf16 v[172:175], v[224:227], v[112:115], v[172:175]
    v_mfma_f32_16x16x32_bf16 v[176:179], v[224:227], v[116:119], v[176:179]
    v_mfma_f32_16x16x32_bf16 v[180:183], v[224:227], v[120:123], v[180:183]
    ds_read_b128 v[220:223], v15 offset:256
    ds_read_b128 v[224:227], v15 offset:8448
    s_waitcnt lgkmcnt(2)
    v_mfma_f32_16x16x32_bf16 v[160:163], v[228:231], v[124:127], v[160:163]
    v_mfma_f32_16x16x32_bf16 v[164:167], v[228:231], v[128:131], v[164:167]
    v_mfma_f32_16x16x32_bf16 v[168:171], v[228:231], v[132:135], v[168:171]
    v_mfma_f32_16x16x32_bf16 v[172:175], v[232:235], v[124:127], v[172:175]
    v_mfma_f32_16x16x32_bf16 v[176:179], v[232:235], v[128:131], v[176:179]
    v_mfma_f32_16x16x32_bf16 v[180:183], v[232:235], v[132:135], v[180:183]
    ds_read_b128 v[228:231], v16 offset:256
    ds_read_b128 v[232:235], v16 offset:8448
    s_waitcnt lgkmcnt(2)
    v_mfma_f32_16x16x32_bf16 v[160:163], v[220:223], v[136:139], v[160:163]
    v_mfma_f32_16x16x32_bf16 v[164:167], v[220:223], v[140:143], v[164:167]
    v_mfma_f32_16x16x32_bf16 v[168:171], v[220:223], v[144:147], v[168:171]
    v_mfma_f32_16x16x32_bf16 v[172:175], v[224:227], v[136:139], v[172:175]
    v_mfma_f32_16x16x32_bf16 v[176:179], v[224:227], v[140:143], v[176:179]
    v_mfma_f32_16x16x32_bf16 v[180:183], v[224:227], v[144:147], v[180:183]
    s_waitcnt lgkmcnt(0)
    v_mfma_f32_16x16x32_bf16 v[160:163], v[228:231], v[148:151], v[160:163]
    v_mfma_f32_16x16x32_bf16 v[164:167], v[228:231], v[152:155], v[164:167]
    v_mfma_f32_16x16x32_bf16 v[168:171], v[228:231], v[156:159], v[168:171]
    v_mfma_f32_16x16x32_bf16 v[172:175], v[232:235], v[148:151], v[172:175]
    v_mfma_f32_16x16x32_bf16 v[176:179], v[232:235], v[152:155], v[176:179]
    v_mfma_f32_16x16x32_bf16 v[180:183], v[232:235], v[156:159], v[180:183]
    s_nop 7
    v_max3_f32 v248, v160, v161, v162
    v_max3_f32 v248, v248, v163, v172
    v_max3_f32 v248, v248, v173, v174
    v_max_f32 v248, v248, v175
    v_max3_f32 v249, v164, v165, v166
    v_max3_f32 v249, v249, v167, v176
    v_max3_f32 v249, v249, v177, v178
    v_max_f32 v249, v249, v179
    v_max3_f32 v250, v168, v169, v170
    v_max3_f32 v250, v250, v171, v180
    v_max3_f32 v250, v250, v181, v182
    v_max_f32 v250, v250, v183
    v_mov_b32 v38, v248
    v_mov_b32 v39, v249
    v_mov_b32 v40, v250
    s_nop 1
    v_permlane16_swap_b32 v248, v38
    v_permlane16_swap_b32 v249, v39
    v_permlane16_swap_b32 v250, v40
    v_max_f32 v248, v248, v38
    v_max_f32 v249, v249, v39
    v_max_f32 v250, v250, v40
    v_mov_b32 v38, v248
    v_mov_b32 v39, v249
    v_mov_b32 v40, v250
    s_nop 1
    v_permlane32_swap_b32 v248, v38
    v_permlane32_swap_b32 v249, v39
    v_permlane32_swap_b32 v250, v40
    v_max_f32 v248, v248, v38
    v_max_f32 v249, v249, v39
    v_max_f32 v250, v250, v40
    v_cmp_gt_f32 s[48:49], v248, v239
    v_cmp_gt_f32 s[50:51], v249, v240
    v_cmp_gt_f32 s[52:53], v250, v241
    s_nop 3
    s_or_b64 s[48:49], s[48:49], s[50:51]
    s_or_b64 s[48:49], s[48:49], s[52:53]
    s_cbranch_scc0 L_norescale0
    v_max_f32 v252, v236, v248
    v_sub_f32 v253, v236, v252
    v_mul_f32 v253, s46, v253
    v_exp_f32 v253, v253
    v_mov_b32 v236, v252
    v_add_f32 v239, 0x42b17218, v252
    v_mul_f32 v242, s46, v252
    v_mul_f32 v245, v245, v253
    v_accvgpr_read_b32 v254, a0
    v_mul_f32 v254, v254, v253
    v_accvgpr_write_b32 a0, v254
    v_accvgpr_read_b32 v254, a1
    v_mul_f32 v254, v254, v253
    v_accvgpr_write_b32 a1, v254
    v_accvgpr_read_b32 v254, a2
    v_mul_f32 v254, v254, v253
    v_accvgpr_write_b32 a2, v254
    v_accvgpr_read_b32 v254, a3
    v_mul_f32 v254, v254, v253
    v_accvgpr_write_b32 a3, v254
    v_accvgpr_read_b32 v254, a12
    v_mul_f32 v254, v254, v253
    v_accvgpr_write_b32 a12, v254
    v_accvgpr_read_b32 v254, a13
    v_mul_f32 v254, v254, v253
    v_accvgpr_write_b32 a13, v254
    v_accvgpr_read_b32 v254, a14
    v_mul_f32 v254, v254, v253
    v_accvgpr_write_b32 a14, v254
    v_accvgpr_read_b32 v254, a15
    v_mul_f32 v254, v254, v253
    v_accvgpr_write_b32 a15, v254
    v_accvgpr_read_b32 v254, a24
    v_mul_f32 v254, v254, v253
    v_accvgpr_write_b32 a24, v254
    v_accvgpr_read_b32 v254, a25
    v_mul_f32 v254, v254, v253
    v_accvgpr_write_b32 a25, v254
    v_accvgpr_read_b32 v254, a26
    v_mul_f32 v254, v254, v253
    v_accvgpr_write_b32 a26, v254
    v_accvgpr_read_b32 v254, a27
    v_mul_f32 v254, v254, v253
    v_accvgpr_write_b32 a27, v254
    v_accvgpr_read_b32 v254, a36
    v_mul_f32 v254, v254, v253
    v_accvgpr_write_b32 a36, v254
    v_accvgpr_read_b32 v254, a37
    v_mul_f32 v254, v254, v253
    v_accvgpr_write_b32 a37, v254
    v_accvgpr_read_b32 v254, a38
    v_mul_f32 v254, v254, v253
    v_accvgpr_write_b32 a38, v254
    v_accvgpr_read_b32 v254, a39
    v_mul_f32 v254, v254, v253
    v_accvgpr_write_b32 a39, v254
    v_accvgpr_read_b32 v254, a48
    v_mul_f32 v254, v254, v253
    v_accvgpr_write_b32 a48, v254
    v_accvgpr_read_b32 v254, a49
    v_mul_f32 v254, v254, v253
    v_accvgpr_write_b32 a49, v254
    v_accvgpr_read_b32 v254, a50
    v_mul_f32 v254, v254, v253
    v_accvgpr_write_b32 a50, v254
    v_accvgpr_read_b32 v254, a51
    v_mul_f32 v254, v254, v253
    v_accvgpr_write_b32 a51, v254
    v_accvgpr_read_b32 v254, a60
    v_mul_f32 v254, v254, v253
    v_accvgpr_write_b32 a60, v254
    v_accvgpr_read_b32 v254, a61
    v_mul_f32 v254, v254, v253
    v_accvgpr_write_b32 a61, v254
    v_accvgpr_read_b32 v254, a62
    v_mul_f32 v254, v254, v253
    v_accvgpr_write_b32 a62, v254
    v_accvgpr_read_b32 v254, a63
    v_mul_f32 v254, v254, v253
    v_accvgpr_write_b32 a63, v254
    v_accvgpr_read_b32 v254, a72
    v_mul_f32 v254, v254, v253
    v_accvgpr_write_b32 a72, v254
    v_accvgpr_read_b32 v254, a73
    v_mul_f32 v254, v254, v253
    v_accvgpr_write_b32 a73, v254
    v_accvgpr_read_b32 v254, a74
    v_mul_f32 v254, v254, v253
    v_accvgpr_write_b32 a74, v254
    v_accvgpr_read_b32 v254, a75
    v_mul_f32 v254, v254, v253
    v_accvgpr_write_b32 a75, v254
    v_accvgpr_read_b32 v254, a84
    v_mul_f32 v254, v254, v253
    v_accvgpr_write_b32 a84, v254
    v_accvgpr_read_b32 v254, a85
    v_mul_f32 v254, v254, v253
    v_accvgpr_write_b32 a85, v254
    v_accvgpr_read_b32 v254, a86
    v_mul_f32 v254, v254, v253
    v_accvgpr_write_b32 a86, v254
    v_accvgpr_read_b32 v254, a87
    v_mul_f32 v254, v254, v253
    v_accvgpr_write_b32 a87, v254
    v_accvgpr_read_b32 v254, a96
    v_mul_f32 v254, v254, v253
    v_accvgpr_write_b32 a96, v254
    v_accvgpr_read_b32 v254, a97
    v_mul_f32 v254, v254, v253
    v_accvgpr_write_b32 a97, v254
    v_accvgpr_read_b32 v254, a98
    v_mul_f32 v254, v254, v253
    v_accvgpr_write_b32 a98, v254
    v_accvgpr_read_b32 v254, a99
    v_mul_f32 v254, v254, v253
    v_accvgpr_write_b32 a99, v254
    v_accvgpr_read_b32 v254, a108
    v_mul_f32 v254, v254, v253
    v_accvgpr_write_b32 a108, v254
    v_accvgpr_read_b32 v254, a109
    v_mul_f32 v254, v254, v253
    v_accvgpr_write_b32 a109, v254
    v_accvgpr_read_b32 v254, a110
    v_mul_f32 v254, v254, v253
    v_accvgpr_write_b32 a110, v254
    v_accvgpr_read_b32 v254, a111
    v_mul_f32 v254, v254, v253
    v_accvgpr_write_b32 a111, v254
    v_accvgpr_read_b32 v254, a120
    v_mul_f32 v254, v254, v253
    v_accvgpr_write_b32 a120, v254
    v_accvgpr_read_b32 v254, a121
    v_mul_f32 v254, v254, v253
    v_accvgpr_write_b32 a121, v254
    v_accvgpr_read_b32 v254, a122
    v_mul_f32 v254, v254, v253
    v_accvgpr_write_b32 a122, v254
    v_accvgpr_read_b32 v254, a123
    v_mul_f32 v254, v254, v253
    v_accvgpr_write_b32 a123, v254
    v_accvgpr_read_b32 v254, a132
    v_mul_f32 v254, v254, v253
    v_accvgpr_write_b32 a132, v254
    v_accvgpr_read_b32 v254, a133
    v_mul_f32 v254, v254, v253
    v_accvgpr_write_b32 a133, v254
    v_accvgpr_read_b32 v254, a134
    v_mul_f32 v254, v254, v253
    v_accvgpr_write_b32 a134, v254
    v_accvgpr_read_b32 v254, a135
    v_mul_f32 v254, v254, v253
    v_accvgpr_write_b32 a135, v254
    v_accvgpr_read_b32 v254, a144
    v_mul_f32 v254, v254, v253
    v_accvgpr_write_b32 a144, v254
    v_accvgpr_read_b32 v254, a145
    v_mul_f32 v254, v254, v253
    v_accvgpr_write_b32 a145, v254
    v_accvgpr_read_b32 v254, a146
    v_mul_f32 v254, v254, v253
    v_accvgpr_write_b32 a146, v254
    v_accvgpr_read_b32 v254, a147
    v_mul_f32 v254, v254, v253
    v_accvgpr_write_b32 a147, v254
    v_accvgpr_read_b32 v254, a156
    v_mul_f32 v254, v254, v253
    v_accvgpr_write_b32 a156, v254
    v_accvgpr_read_b32 v254, a157
    v_mul_f32 v254, v254, v253
    v_accvgpr_write_b32 a157, v254
    v_accvgpr_read_b32 v254, a158
    v_mul_f32 v254, v254, v253
    v_accvgpr_write_b32 a158, v254
    v_accvgpr_read_b32 v254, a159
    v_mul_f32 v254, v254, v253
    v_accvgpr_write_b32 a159, v254
    v_accvgpr_read_b32 v254, a168
    v_mul_f32 v254, v254, v253
    v_accvgpr_write_b32 a168, v254
    v_accvgpr_read_b32 v254, a169
    v_mul_f32 v254, v254, v253
    v_accvgpr_write_b32 a169, v254
    v_accvgpr_read_b32 v254, a170
    v_mul_f32 v254, v254, v253
    v_accvgpr_write_b32 a170, v254
    v_accvgpr_read_b32 v254, a171
    v_mul_f32 v254, v254, v253
    v_accvgpr_write_b32 a171, v254
    v_accvgpr_read_b32 v254, a180
    v_mul_f32 v254, v254, v253
    v_accvgpr_write_b32 a180, v254
    v_accvgpr_read_b32 v254, a181
    v_mul_f32 v254, v254, v253
    v_accvgpr_write_b32 a181, v254
    v_accvgpr_read_b32 v254, a182
    v_mul_f32 v254, v254, v253
    v_accvgpr_write_b32 a182, v254
    v_accvgpr_read_b32 v254, a183
    v_mul_f32 v254, v254, v253
    v_accvgpr_write_b32 a183, v254
    v_max_f32 v252, v237, v249
    v_sub_f32 v253, v237, v252
    v_mul_f32 v253, s46, v253
    v_exp_f32 v253, v253
    v_mov_b32 v237, v252
    v_add_f32 v240, 0x42b17218, v252
    v_mul_f32 v243, s46, v252
    v_mul_f32 v246, v246, v253
    v_accvgpr_read_b32 v254, a4
    v_mul_f32 v254, v254, v253
    v_accvgpr_write_b32 a4, v254
    v_accvgpr_read_b32 v254, a5
    v_mul_f32 v254, v254, v253
    v_accvgpr_write_b32 a5, v254
    v_accvgpr_read_b32 v254, a6
    v_mul_f32 v254, v254, v253
    v_accvgpr_write_b32 a6, v254
    v_accvgpr_read_b32 v254, a7
    v_mul_f32 v254, v254, v253
    v_accvgpr_write_b32 a7, v254
    v_accvgpr_read_b32 v254, a16
    v_mul_f32 v254, v254, v253
    v_accvgpr_write_b32 a16, v254
    v_accvgpr_read_b32 v254, a17
    v_mul_f32 v254, v254, v253
    v_accvgpr_write_b32 a17, v254
    v_accvgpr_read_b32 v254, a18
    v_mul_f32 v254, v254, v253
    v_accvgpr_write_b32 a18, v254
    v_accvgpr_read_b32 v254, a19
    v_mul_f32 v254, v254, v253
    v_accvgpr_write_b32 a19, v254
    v_accvgpr_read_b32 v254, a28
    v_mul_f32 v254, v254, v253
    v_accvgpr_write_b32 a28, v254
    v_accvgpr_read_b32 v254, a29
    v_mul_f32 v254, v254, v253
    v_accvgpr_write_b32 a29, v254
    v_accvgpr_read_b32 v254, a30
    v_mul_f32 v254, v254, v253
    v_accvgpr_write_b32 a30, v254
    v_accvgpr_read_b32 v254, a31
    v_mul_f32 v254, v254, v253
    v_accvgpr_write_b32 a31, v254
    v_accvgpr_read_b32 v254, a40
    v_mul_f32 v254, v254, v253
    v_accvgpr_write_b32 a40, v254
    v_accvgpr_read_b32 v254, a41
    v_mul_f32 v254, v254, v253
    v_accvgpr_write_b32 a41, v254
    v_accvgpr_read_b32 v254, a42
    v_mul_f32 v254, v254, v253
    v_accvgpr_write_b32 a42, v254
    v_accvgpr_read_b32 v254, a43
    v_mul_f32 v254, v254, v253
    v_accvgpr_write_b32 a43, v254
    v_accvgpr_read_b32 v254, a52
    v_mul_f32 v254, v254, v253
    v_accvgpr_write_b32 a52, v254
    v_accvgpr_read_b32 v254, a53
    v_mul_f32 v254, v254, v253
    v_accvgpr_write_b32 a53, v254
    v_accvgpr_read_b32 v254, a54
    v_mul_f32 v254, v254, v253
    v_accvgpr_write_b32 a54, v254
    v_accvgpr_read_b32 v254, a55
    v_mul_f32 v254, v254, v253
    v_accvgpr_write_b32 a55, v254
    v_accvgpr_read_b32 v254, a64
    v_mul_f32 v254, v254, v253
    v_accvgpr_write_b32 a64, v254
    v_accvgpr_read_b32 v254, a65
    v_mul_f32 v254, v254, v253
    v_accvgpr_write_b32 a65, v254
    v_accvgpr_read_b32 v254, a66
    v_mul_f32 v254, v254, v253
    v_accvgpr_write_b32 a66, v254
    v_accvgpr_read_b32 v254, a67
    v_mul_f32 v254, v254, v253
    v_accvgpr_write_b32 a67, v254
    v_accvgpr_read_b32 v254, a76
    v_mul_f32 v254, v254, v253
    v_accvgpr_write_b32 a76, v254
    v_accvgpr_read_b32 v254, a77
    v_mul_f32 v254, v254, v253
    v_accvgpr_write_b32 a77, v254
    v_accvgpr_read_b32 v254, a78
    v_mul_f32 v254, v254, v253
    v_accvgpr_write_b32 a78, v254
    v_accvgpr_read_b32 v254, a79
    v_mul_f32 v254, v254, v253
    v_accvgpr_write_b32 a79, v254
    v_accvgpr_read_b32 v254, a88
    v_mul_f32 v254, v254, v253
    v_accvgpr_write_b32 a88, v254
    v_accvgpr_read_b32 v254, a89
    v_mul_f32 v254, v254, v253
    v_accvgpr_write_b32 a89, v254
    v_accvgpr_read_b32 v254, a90
    v_mul_f32 v254, v254, v253
    v_accvgpr_write_b32 a90, v254
    v_accvgpr_read_b32 v254, a91
    v_mul_f32 v254, v254, v253
    v_accvgpr_write_b32 a91, v254
    v_accvgpr_read_b32 v254, a100
    v_mul_f32 v254, v254, v253
    v_accvgpr_write_b32 a100, v254
    v_accvgpr_read_b32 v254, a101
    v_mul_f32 v254, v254, v253
    v_accvgpr_write_b32 a101, v254
    v_accvgpr_read_b32 v254, a102
    v_mul_f32 v254, v254, v253
    v_accvgpr_write_b32 a102, v254
    v_accvgpr_read_b32 v254, a103
    v_mul_f32 v254, v254, v253
    v_accvgpr_write_b32 a103, v254
    v_accvgpr_read_b32 v254, a112
    v_mul_f32 v254, v254, v253
    v_accvgpr_write_b32 a112, v254
    v_accvgpr_read_b32 v254, a113
    v_mul_f32 v254, v254, v253
    v_accvgpr_write_b32 a113, v254
    v_accvgpr_read_b32 v254, a114
    v_mul_f32 v254, v254, v253
    v_accvgpr_write_b32 a114, v254
    v_accvgpr_read_b32 v254, a115
    v_mul_f32 v254, v254, v253
    v_accvgpr_write_b32 a115, v254
    v_accvgpr_read_b32 v254, a124
    v_mul_f32 v254, v254, v253
    v_accvgpr_write_b32 a124, v254
    v_accvgpr_read_b32 v254, a125
    v_mul_f32 v254, v254, v253
    v_accvgpr_write_b32 a125, v254
    v_accvgpr_read_b32 v254, a126
    v_mul_f32 v254, v254, v253
    v_accvgpr_write_b32 a126, v254
    v_accvgpr_read_b32 v254, a127
    v_mul_f32 v254, v254, v253
    v_accvgpr_write_b32 a127, v254
    v_accvgpr_read_b32 v254, a136
    v_mul_f32 v254, v254, v253
    v_accvgpr_write_b32 a136, v254
    v_accvgpr_read_b32 v254, a137
    v_mul_f32 v254, v254, v253
    v_accvgpr_write_b32 a137, v254
    v_accvgpr_read_b32 v254, a138
    v_mul_f32 v254, v254, v253
    v_accvgpr_write_b32 a138, v254
    v_accvgpr_read_b32 v254, a139
    v_mul_f32 v254, v254, v253
    v_accvgpr_write_b32 a139, v254
    v_accvgpr_read_b32 v254, a148
    v_mul_f32 v254, v254, v253
    v_accvgpr_write_b32 a148, v254
    v_accvgpr_read_b32 v254, a149
    v_mul_f32 v254, v254, v253
    v_accvgpr_write_b32 a149, v254
    v_accvgpr_read_b32 v254, a150
    v_mul_f32 v254, v254, v253
    v_accvgpr_write_b32 a150, v254
    v_accvgpr_read_b32 v254, a151
    v_mul_f32 v254, v254, v253
    v_accvgpr_write_b32 a151, v254
    v_accvgpr_read_b32 v254, a160
    v_mul_f32 v254, v254, v253
    v_accvgpr_write_b32 a160, v254
    v_accvgpr_read_b32 v254, a161
    v_mul_f32 v254, v254, v253
    v_accvgpr_write_b32 a161, v254
    v_accvgpr_read_b32 v254, a162
    v_mul_f32 v254, v254, v253
    v_accvgpr_write_b32 a162, v254
    v_accvgpr_read_b32 v254, a163
    v_mul_f32 v254, v254, v253
    v_accvgpr_write_b32 a163, v254
    v_accvgpr_read_b32 v254, a172
    v_mul_f32 v254, v254, v253
    v_accvgpr_write_b32 a172, v254
    v_accvgpr_read_b32 v254, a173
    v_mul_f32 v254, v254, v253
    v_accvgpr_write_b32 a173, v254
    v_accvgpr_read_b32 v254, a174
    v_mul_f32 v254, v254, v253
    v_accvgpr_write_b32 a174, v254
    v_accvgpr_read_b32 v254, a175
    v_mul_f32 v254, v254, v253
    v_accvgpr_write_b32 a175, v254
    v_accvgpr_read_b32 v254, a184
    v_mul_f32 v254, v254, v253
    v_accvgpr_write_b32 a184, v254
    v_accvgpr_read_b32 v254, a185
    v_mul_f32 v254, v254, v253
    v_accvgpr_write_b32 a185, v254
    v_accvgpr_read_b32 v254, a186
    v_mul_f32 v254, v254, v253
    v_accvgpr_write_b32 a186, v254
    v_accvgpr_read_b32 v254, a187
    v_mul_f32 v254, v254, v253
    v_accvgpr_write_b32 a187, v254
    v_max_f32 v252, v238, v250
    v_sub_f32 v253, v238, v252
    v_mul_f32 v253, s46, v253
    v_exp_f32 v253, v253
    v_mov_b32 v238, v252
    v_add_f32 v241, 0x42b17218, v252
    v_mul_f32 v244, s46, v252
    v_mul_f32 v247, v247, v253
    v_accvgpr_read_b32 v254, a8
    v_mul_f32 v254, v254, v253
    v_accvgpr_write_b32 a8, v254
    v_accvgpr_read_b32 v254, a9
    v_mul_f32 v254, v254, v253
    v_accvgpr_write_b32 a9, v254
    v_accvgpr_read_b32 v254, a10
    v_mul_f32 v254, v254, v253
    v_accvgpr_write_b32 a10, v254
    v_accvgpr_read_b32 v254, a11
    v_mul_f32 v254, v254, v253
    v_accvgpr_write_b32 a11, v254
    v_accvgpr_read_b32 v254, a20
    v_mul_f32 v254, v254, v253
    v_accvgpr_write_b32 a20, v254
    v_accvgpr_read_b32 v254, a21
    v_mul_f32 v254, v254, v253
    v_accvgpr_write_b32 a21, v254
    v_accvgpr_read_b32 v254, a22
    v_mul_f32 v254, v254, v253
    v_accvgpr_write_b32 a22, v254
    v_accvgpr_read_b32 v254, a23
    v_mul_f32 v254, v254, v253
    v_accvgpr_write_b32 a23, v254
    v_accvgpr_read_b32 v254, a32
    v_mul_f32 v254, v254, v253
    v_accvgpr_write_b32 a32, v254
    v_accvgpr_read_b32 v254, a33
    v_mul_f32 v254, v254, v253
    v_accvgpr_write_b32 a33, v254
    v_accvgpr_read_b32 v254, a34
    v_mul_f32 v254, v254, v253
    v_accvgpr_write_b32 a34, v254
    v_accvgpr_read_b32 v254, a35
    v_mul_f32 v254, v254, v253
    v_accvgpr_write_b32 a35, v254
    v_accvgpr_read_b32 v254, a44
    v_mul_f32 v254, v254, v253
    v_accvgpr_write_b32 a44, v254
    v_accvgpr_read_b32 v254, a45
    v_mul_f32 v254, v254, v253
    v_accvgpr_write_b32 a45, v254
    v_accvgpr_read_b32 v254, a46
    v_mul_f32 v254, v254, v253
    v_accvgpr_write_b32 a46, v254
    v_accvgpr_read_b32 v254, a47
    v_mul_f32 v254, v254, v253
    v_accvgpr_write_b32 a47, v254
    v_accvgpr_read_b32 v254, a56
    v_mul_f32 v254, v254, v253
    v_accvgpr_write_b32 a56, v254
    v_accvgpr_read_b32 v254, a57
    v_mul_f32 v254, v254, v253
    v_accvgpr_write_b32 a57, v254
    v_accvgpr_read_b32 v254, a58
    v_mul_f32 v254, v254, v253
    v_accvgpr_write_b32 a58, v254
    v_accvgpr_read_b32 v254, a59
    v_mul_f32 v254, v254, v253
    v_accvgpr_write_b32 a59, v254
    v_accvgpr_read_b32 v254, a68
    v_mul_f32 v254, v254, v253
    v_accvgpr_write_b32 a68, v254
    v_accvgpr_read_b32 v254, a69
    v_mul_f32 v254, v254, v253
    v_accvgpr_write_b32 a69, v254
    v_accvgpr_read_b32 v254, a70
    v_mul_f32 v254, v254, v253
    v_accvgpr_write_b32 a70, v254
    v_accvgpr_read_b32 v254, a71
    v_mul_f32 v254, v254, v253
    v_accvgpr_write_b32 a71, v254
    v_accvgpr_read_b32 v254, a80
    v_mul_f32 v254, v254, v253
    v_accvgpr_write_b32 a80, v254
    v_accvgpr_read_b32 v254, a81
    v_mul_f32 v254, v254, v253
    v_accvgpr_write_b32 a81, v254
    v_accvgpr_read_b32 v254, a82
    v_mul_f32 v254, v254, v253
    v_accvgpr_write_b32 a82, v254
    v_accvgpr_read_b32 v254, a83
    v_mul_f32 v254, v254, v253
    v_accvgpr_write_b32 a83, v254
    v_accvgpr_read_b32 v254, a92
    v_mul_f32 v254, v254, v253
    v_accvgpr_write_b32 a92, v254
    v_accvgpr_read_b32 v254, a93
    v_mul_f32 v254, v254, v253
    v_accvgpr_write_b32 a93, v254
    v_accvgpr_read_b32 v254, a94
    v_mul_f32 v254, v254, v253
    v_accvgpr_write_b32 a94, v254
    v_accvgpr_read_b32 v254, a95
    v_mul_f32 v254, v254, v253
    v_accvgpr_write_b32 a95, v254
    v_accvgpr_read_b32 v254, a104
    v_mul_f32 v254, v254, v253
    v_accvgpr_write_b32 a104, v254
    v_accvgpr_read_b32 v254, a105
    v_mul_f32 v254, v254, v253
    v_accvgpr_write_b32 a105, v254
    v_accvgpr_read_b32 v254, a106
    v_mul_f32 v254, v254, v253
    v_accvgpr_write_b32 a106, v254
    v_accvgpr_read_b32 v254, a107
    v_mul_f32 v254, v254, v253
    v_accvgpr_write_b32 a107, v254
    v_accvgpr_read_b32 v254, a116
    v_mul_f32 v254, v254, v253
    v_accvgpr_write_b32 a116, v254
    v_accvgpr_read_b32 v254, a117
    v_mul_f32 v254, v254, v253
    v_accvgpr_write_b32 a117, v254
    v_accvgpr_read_b32 v254, a118
    v_mul_f32 v254, v254, v253
    v_accvgpr_write_b32 a118, v254
    v_accvgpr_read_b32 v254, a119
    v_mul_f32 v254, v254, v253
    v_accvgpr_write_b32 a119, v254
    v_accvgpr_read_b32 v254, a128
    v_mul_f32 v254, v254, v253
    v_accvgpr_write_b32 a128, v254
    v_accvgpr_read_b32 v254, a129
    v_mul_f32 v254, v254, v253
    v_accvgpr_write_b32 a129, v254
    v_accvgpr_read_b32 v254, a130
    v_mul_f32 v254, v254, v253
    v_accvgpr_write_b32 a130, v254
    v_accvgpr_read_b32 v254, a131
    v_mul_f32 v254, v254, v253
    v_accvgpr_write_b32 a131, v254
    v_accvgpr_read_b32 v254, a140
    v_mul_f32 v254, v254, v253
    v_accvgpr_write_b32 a140, v254
    v_accvgpr_read_b32 v254, a141
    v_mul_f32 v254, v254, v253
    v_accvgpr_write_b32 a141, v254
    v_accvgpr_read_b32 v254, a142
    v_mul_f32 v254, v254, v253
    v_accvgpr_write_b32 a142, v254
    v_accvgpr_read_b32 v254, a143
    v_mul_f32 v254, v254, v253
    v_accvgpr_write_b32 a143, v254
    v_accvgpr_read_b32 v254, a152
    v_mul_f32 v254, v254, v253
    v_accvgpr_write_b32 a152, v254
    v_accvgpr_read_b32 v254, a153
    v_mul_f32 v254, v254, v253
    v_accvgpr_write_b32 a153, v254
    v_accvgpr_read_b32 v254, a154
    v_mul_f32 v254, v254, v253
    v_accvgpr_write_b32 a154, v254
    v_accvgpr_read_b32 v254, a155
    v_mul_f32 v254, v254, v253
    v_accvgpr_write_b32 a155, v254
    v_accvgpr_read_b32 v254, a164
    v_mul_f32 v254, v254, v253
    v_accvgpr_write_b32 a164, v254
    v_accvgpr_read_b32 v254, a165
    v_mul_f32 v254, v254, v253
    v_accvgpr_write_b32 a165, v254
    v_accvgpr_read_b32 v254, a166
    v_mul_f32 v254, v254, v253
    v_accvgpr_write_b32 a166, v254
    v_accvgpr_read_b32 v254, a167
    v_mul_f32 v254, v254, v253
    v_accvgpr_write_b32 a167, v254
    v_accvgpr_read_b32 v254, a176
    v_mul_f32 v254, v254, v253
    v_accvgpr_write_b32 a176, v254
    v_accvgpr_read_b32 v254, a177
    v_mul_f32 v254, v254, v253
    v_accvgpr_write_b32 a177, v254
    v_accvgpr_read_b32 v254, a178
    v_mul_f32 v254, v254, v253
    v_accvgpr_write_b32 a178, v254
    v_accvgpr_read_b32 v254, a179
    v_mul_f32 v254, v254, v253
    v_accvgpr_write_b32 a179, v254
    v_accvgpr_read_b32 v254, a188
    v_mul_f32 v254, v254, v253
    v_accvgpr_write_b32 a188, v254
    v_accvgpr_read_b32 v254, a189
    v_mul_f32 v254, v254, v253
    v_accvgpr_write_b32 a189, v254
    v_accvgpr_read_b32 v254, a190
    v_mul_f32 v254, v254, v253
    v_accvgpr_write_b32 a190, v254
    v_accvgpr_read_b32 v254, a191
    v_mul_f32 v254, v254, v253
    v_accvgpr_write_b32 a191, v254
L_norescale0:
    s_waitcnt vmcnt(0)
    s_barrier
    s_lshl_b32 s40, s34, 13
    s_add_u32 s41, s40, 65536
    s_add_u32 s40, s40, 0
    s_mov_b32 m0, s40
    s_nop 0
    buffer_load_dwordx4 v4, s[12:15], s41 offen offset:0 lds
    buffer_load_dwordx4 v5, s[12:15], s41 offen offset:1024 lds
    buffer_load_dwordx4 v6, s[12:15], s41 offen offset:2048 lds
    buffer_load_dwordx4 v7, s[12:15], s41 offen offset:3072 lds
    s_add_u32 s40, s40, 4096
    s_add_u32 s41, s41, 4096
    s_mov_b32 m0, s40
    s_nop 0
    buffer_load_dwordx4 v4, s[12:15], s41 offen offset:0 lds
    buffer_load_dwordx4 v5, s[12:15], s41 offen offset:1024 lds
    buffer_load_dwordx4 v6, s[12:15], s41 offen offset:2048 lds
    buffer_load_dwordx4 v7, s[12:15], s41 offen offset:3072 lds
    s_lshl_b32 s40, s34, 13
    s_add_u32 s41, s40, 32768
    s_add_u32 s40, s40, 98304
    s_mov_b32 m0, s40
    s_nop 0
    buffer_load_dwordx4 v4, s[16:19], s41 offen offset:0 lds
    buffer_load_dwordx4 v5, s[16:19], s41 offen offset:1024 lds
    buffer_load_dwordx4 v6, s[16:19], s41 offen offset:2048 lds
    buffer_load_dwordx4 v7, s[16:19], s41 offen offset:3072 lds
    s_add_u32 s40, s40, 4096
    s_add_u32 s41, s41, 4096
    s_mov_b32 m0, s40
    s_nop 0
    buffer_load_dwordx4 v4, s[16:19], s41 offen offset:0 lds
    buffer_load_dwordx4 v5, s[16:19], s41 offen offset:1024 lds
    buffer_load_dwordx4 v6, s[16:19], s41 offen offset:2048 lds
    buffer_load_dwordx4 v7, s[16:19], s41 offen offset:3072 lds
    s_mov_b32 s44, 0
    s_mov_b32 s45, 65536
    s_mov_b32 s47, 98304
L_loop:
    ds_read_b128 v[220:223], v13 offset:32768
    ds_read_b128 v[224:227], v13 offset:40960
    ds_read_b128 v[228:231], v14 offset:32768
    ds_read_b128 v[232:235], v14 offset:40960
    s_waitcnt lgkmcnt(2)
    v_mfma_f32_16x16x32_bf16 v[184:187], v[220:223], v[64:67], 0
    v_fma_f32 v160, v160, s46, -v242
    v_mfma_f32_16x16x32_bf16 v[188:191], v[220:223], v[68:71], 0
    v_exp_f32 v160, v160
    v_fma_f32 v161, v161, s46, -v242
    v_mfma_f32_16x16x32_bf16 v[192:195], v[220:223], v[72:75], 0
    v_exp_f32 v161, v161
    v_fma_f32 v162, v162, s46, -v242
    v_mfma_f32_16x16x32_bf16 v[196:199], v[224:227], v[64:67], 0
    v_exp_f32 v162, v162
    v_fma_f32 v163, v163, s46, -v242
    v_mfma_f32_16x16x32_bf16 v[200:203], v[224:227], v[68:71], 0
    v_exp_f32 v163, v163
    v_mfma_f32_16x16x32_bf16 v[204:207], v[224:227], v[72:75], 0
    v_fma_f32 v172, v172, s46, -v242
    v_exp_f32 v172, v172
    ds_read_b128 v[220:223], v15 offset:32768
    ds_read_b128 v[224:227], v15 offset:40960
    s_waitcnt lgkmcnt(2)
    v_mfma_f32_16x16x32_bf16 v[184:187], v[228:231], v[76:79], v[184:187]
    v_fma_f32 v173, v173, s46, -v242
    v_exp_f32 v173, v173
    v_mfma_f32_16x16x32_bf16 v[188:191], v[228:231], v[80:83], v[188:191]
    v_fma_f32 v174, v174, s46, -v242
    v_exp_f32 v174, v174
    v_mfma_f32_16x16x32_bf16 v[192:195], v[228:231], v[84:87], v[192:195]
    v_fma_f32 v175, v175, s46, -v242
    v_mfma_f32_16x16x32_bf16 v[196:199], v[232:235], v[76:79], v[196:199]
    v_exp_f32 v175, v175
    v_add_f32 v38, v160, v161
    v_mfma_f32_16x16x32_bf16 v[200:203], v[232:235], v[80:83], v[200:203]
    v_add_f32 v39, v162, v163
    v_add_f32 v40, v172, v173
    v_mfma_f32_16x16x32_bf16 v[204:207], v[232:235], v[84:87], v[204:207]
    v_add_f32 v41, v174, v175
    v_add_f32 v38, v38, v39
    ds_read_b128 v[228:231], v16 offset:32768
    ds_read_b128 v[232:235], v16 offset:40960
    s_waitcnt lgkmcnt(2)
    v_mfma_f32_16x16x32_bf16 v[184:187], v[220:223], v[88:91], v[184:187]
    v_add_f32 v40, v40, v41
    v_mfma_f32_16x16x32_bf16 v[188:191], v[220:223], v[92:95], v[188:191]
    v_add_f32 v245, v245, v38
    v_add_f32 v245, v245, v40
    v_mfma_f32_16x16x32_bf16 v[192:195], v[220:223], v[96:99], v[192:195]
    v_cvt_pk_bf16_f32 v208, v160, v161
    v_cvt_pk_bf16_f32 v209, v162, v163
    v_mfma_f32_16x16x32_bf16 v[196:199], v[224:227], v[88:91], v[196:199]
    v_cvt_pk_bf16_f32 v210, v172, v173
    v_cvt_pk_bf16_f32 v211, v174, v175
    v_mfma_f32_16x16x32_bf16 v[200:203], v[224:227], v[92:95], v[200:203]
    v_fma_f32 v164, v164, s46, -v243
    v_mfma_f32_16x16x32_bf16 v[204:207], v[224:227], v[96:99], v[204:207]
    v_exp_f32 v164, v164
    v_fma_f32 v165, v165, s46, -v243
    ds_read_b128 v[220:223], v13 offset:33024
    ds_read_b128 v[224:227], v13 offset:41216
    s_waitcnt lgkmcnt(2)
    v_mfma_f32_16x16x32_bf16 v[184:187], v[228:231], v[100:103], v[184:187]
    v_exp_f32 v165, v165
    v_fma_f32 v166, v166, s46, -v243
    v_mfma_f32_16x16x32_bf16 v[188:191], v[228:231], v[104:107], v[188:191]
    v_exp_f32 v166, v166
    v_fma_f32 v167, v167, s46, -v243
    v_mfma_f32_16x16x32_bf16 v[192:195], v[228:231], v[108:111], v[192:195]
    v_exp_f32 v167, v167
    v_mfma_f32_16x16x32_bf16 v[196:199], v[232:235], v[100:103], v[196:199]
    v_fma_f32 v176, v176, s46, -v243
    v_exp_f32 v176, v176
    v_mfma_f32_16x16x32_bf16 v[200:203], v[232:235], v[104:107], v[200:203]
    v_fma_f32 v177, v177, s46, -v243
    v_exp_f32 v177, v177
    v_mfma_f32_16x16x32_bf16 v[204:207], v[232:235], v[108:111], v[204:207]
    v_fma_f32 v178, v178, s46, -v243
    v_exp_f32 v178, v178
    ds_read_b128 v[228:231], v14 offset:33024
    ds_read_b128 v[232:235], v14 offset:41216
    s_waitcnt lgkmcnt(2)
    v_mfma_f32_16x16x32_bf16 v[184:187], v[220:223], v[112:115], v[184:187]
    v_fma_f32 v179, v179, s46, -v243
    v_mfma_f32_16x16x32_bf16 v[188:191], v[220:223], v[116:119], v[188:191]
    v_exp_f32 v179, v179
    v_add_f32 v42, v164, v165
    v_mfma_f32_16x16x32_bf16 v[192:195], v[220:223], v[120:123], v[192:195]
    v_add_f32 v43, v166, v167
    v_add_f32 v44, v176, v177
    v_mfma_f32_16x16x32_bf16 v[196:199], v[224:227], v[112:115], v[196:199]
    v_add_f32 v45, v178, v179
    v_add_f32 v42, v42, v43
    v_mfma_f32_16x16x32_bf16 v[200:203], v[224:227], v[116:119], v[200:203]
    v_add_f32 v44, v44, v45
    v_mfma_f32_16x16x32_bf16 v[204:207], v[224:227], v[120:123], v[204:207]
    v_add_f32 v246, v246, v42
    v_add_f32 v246, v246, v44
    ds_read_b128 v[220:223], v15 offset:33024
    ds_read_b128 v[224:227], v15 offset:41216
    s_waitcnt lgkmcnt(2)
    v_mfma_f32_16x16x32_bf16 v[184:187], v[228:231], v[124:127], v[184:187]
    v_cvt_pk_bf16_f32 v212, v164, v165
    v_cvt_pk_bf16_f32 v213, v166, v167
    v_mfma_f32_16x16x32_bf16 v[188:191], v[228:231], v[128:131], v[188:191]
    v_cvt_pk_bf16_f32 v214, v176, v177
    v_cvt_pk_bf16_f32 v215, v178, v179
    v_mfma_f32_16x16x32_bf16 v[192:195], v[228:231], v[132:135], v[192:195]
    v_fma_f32 v168, v168, s46, -v244
    v_mfma_f32_16x16x32_bf16 v[196:199], v[232:235], v[124:127], v[196:199]
    v_exp_f32 v168, v168
    v_fma_f32 v169, v169, s46, -v244
    v_mfma_f32_16x16x32_bf16 v[200:203], v[232:235], v[128:131], v[200:203]
    v_exp_f32 v169, v169
    v_fma_f32 v170, v170, s46, -v244
    v_mfma_f32_16x16x32_bf16 v[204:207], v[232:235], v[132:135], v[204:207]
    v_exp_f32 v170, v170
    v_fma_f32 v171, v171, s46, -v244
    ds_read_b128 v[228:231], v16 offset:33024
    ds_read_b128 v[232:235], v16 offset:41216
    s_waitcnt lgkmcnt(2)
    v_mfma_f32_16x16x32_bf16 v[184:187], v[220:223], v[136:139], v[184:187]
    v_exp_f32 v171, v171
    v_mfma_f32_16x16x32_bf16 v[188:191], v[220:223], v[140:143], v[188:191]
    v_fma_f32 v180, v180, s46, -v244
    v_exp_f32 v180, v180
    v_mfma_f32_16x16x32_bf16 v[192:195], v[220:223], v[144:147], v[192:195]
    v_fma_f32 v181, v181, s46, -v244
    v_exp_f32 v181, v181
    v_mfma_f32_16x16x32_bf16 v[196:199], v[224:227], v[136:139], v[196:199]
    v_fma_f32 v182, v182, s46, -v244
    v_exp_f32 v182, v182
    v_mfma_f32_16x16x32_bf16 v[200:203], v[224:227], v[140:143], v[200:203]
    v_fma_f32 v183, v183, s46, -v244
    v_mfma_f32_16x16x32_bf16 v[204:207], v[224:227], v[144:147], v[204:207]
    v_exp_f32 v183, v183
    v_add_f32 v46, v168, v169
    s_waitcnt lgkmcnt(0)
    v_mfma_f32_16x16x32_bf16 v[184:187], v[228:231], v[148:151], v[184:187]
    v_add_f32 v47, v170, v171
    v_add_f32 v48, v180, v181
    v_mfma_f32_16x16x32_bf16 v[188:191], v[228:231], v[152:155], v[188:191]
    v_add_f32 v49, v182, v183
    v_add_f32 v46, v46, v47
    v_mfma_f32_16x16x32_bf16 v[192:195], v[228:231], v[156:159], v[192:195]
    v_add_f32 v48, v48, v49
    v_mfma_f32_16x16x32_bf16 v[196:199], v[232:235], v[148:151], v[196:199]
    v_add_f32 v247, v247, v46
    v_add_f32 v247, v247, v48
    v_mfma_f32_16x16x32_bf16 v[200:203], v[232:235], v[152:155], v[200:203]
    v_cvt_pk_bf16_f32 v216, v168, v169
    v_cvt_pk_bf16_f32 v217, v170, v171
    v_mfma_f32_16x16x32_bf16 v[204:207], v[232:235], v[156:159], v[204:207]
    v_cvt_pk_bf16_f32 v218, v180, v181
    v_cvt_pk_bf16_f32 v219, v182, v183
    s_waitcnt vmcnt(16)
    s_barrier
    ds_read_b64_tr_b16 v[220:221], v17 offset:0
    ds_read_b64_tr_b16 v[222:223], v17 offset:8192
    ds_read_b64_tr_b16 v[224:225], v18 offset:0
    ds_read_b64_tr_b16 v[226:227], v18 offset:8192
    ds_read_b64_tr_b16 v[228:229], v19 offset:0
    ds_read_b64_tr_b16 v[230:231], v19 offset:8192
    s_waitcnt lgkmcnt(4)
    v_mfma_f32_16x16x32_bf16 a[0:3], v[220:223], v[208:211], a[0:3]
    s_lshl_b32 s40, s34, 13
    v_mfma_f32_16x16x32_bf16 a[4:7], v[220:223], v[212:215], a[4:7]
    s_add_u32 s41, s40, s47
    v_mfma_f32_16x16x32_bf16 a[8:11], v[220:223], v[216:219], a[8:11]
    s_add_u32 s40, s40, 32768
    ds_read_b64_tr_b16 v[232:233], v20 offset:0
    ds_read_b64_tr_b16 v[234:235], v20 offset:8192
    s_waitcnt lgkmcnt(4)
    v_mfma_f32_16x16x32_bf16 a[12:15], v[224:227], v[208:211], a[12:15]
    s_mov_b32 m0, s40
    v_mfma_f32_16x16x32_bf16 a[16:19], v[224:227], v[212:215], a[16:19]
    s_nop 0
    v_mfma_f32_16x16x32_bf16 a[20:23], v[224:227], v[216:219], a[20:23]
    buffer_load_dwordx4 v4, s[12:15], s41 offen offset:0 lds
    ds_read_b64_tr_b16 v[220:221], v21 offset:0
    ds_read_b64_tr_b16 v[222:223], v21 offset:8192
    s_waitcnt lgkmcnt(4)
    v_mfma_f32_16x16x32_bf16 a[24:27], v[228:231], v[208:211], a[24:27]
    buffer_load_dwordx4 v5, s[12:15], s41 offen offset:1024 lds
    v_mfma_f32_16x16x32_bf16 a[28:31], v[228:231], v[212:215], a[28:31]
    buffer_load_dwordx4 v6, s[12:15], s41 offen offset:2048 lds
    v_mfma_f32_16x16x32_bf16 a[32:35], v[228:231], v[216:219], a[32:35]
    buffer_load_dwordx4 v7, s[12:15], s41 offen offset:3072 lds
    ds_read_b64_tr_b16 v[224:225], v22 offset:0
    ds_read_b64_tr_b16 v[226:227], v22 offset:8192
    s_waitcnt lgkmcnt(4)
    v_mfma_f32_16x16x32_bf16 a[36:39], v[232:235], v[208:211], a[36:39]
    s_add_u32 s40, s40, 4096
    s_add_u32 s41, s41, 4096
    v_mfma_f32_16x16x32_bf16 a[40:43], v[232:235], v[212:215], a[40:43]
    s_mov_b32 m0, s40
    v_mfma_f32_16x16x32_bf16 a[44:47], v[232:235], v[216:219], a[44:47]
    s_nop 0
    ds_read_b64_tr_b16 v[228:229], v23 offset:0
    ds_read_b64_tr_b16 v[230:231], v23 offset:8192
    s_waitcnt lgkmcnt(4)
    v_mfma_f32_16x16x32_bf16 a[48:51], v[220:223], v[208:211], a[48:51]
    buffer_load_dwordx4 v4, s[12:15], s41 offen offset:0 lds
    v_mfma_f32_16x16x32_bf16 a[52:55], v[220:223], v[212:215], a[52:55]
    buffer_load_dwordx4 v5, s[12:15], s41 offen offset:1024 lds
    v_mfma_f32_16x16x32_bf16 a[56:59], v[220:223], v[216:219], a[56:59]
    buffer_load_dwordx4 v6, s[12:15], s41 offen offset:2048 lds
    ds_read_b64_tr_b16 v[232:233], v24 offset:0
    ds_read_b64_tr_b16 v[234:235], v24 offset:8192
    s_waitcnt lgkmcnt(4)
    v_mfma_f32_16x16x32_bf16 a[60:63], v[224:227], v[208:211], a[60:63]
    buffer_load_dwordx4 v7, s[12:15], s41 offen offset:3072 lds
    v_mfma_f32_16x16x32_bf16 a[64:67], v[224:227], v[212:215], a[64:67]
    s_nop 4
    v_mfma_f32_16x16x32_bf16 a[68:71], v[224:227], v[216:219], a[68:71]
    v_max3_f32 v248, v184, v185, v186
    ds_read_b64_tr_b16 v[220:221], v17 offset:256
    ds_read_b64_tr_b16 v[222:223], v17 offset:8448
    s_waitcnt lgkmcnt(4)
    v_mfma_f32_16x16x32_bf16 a[72:75], v[228:231], v[208:211], a[72:75]
    v_max3_f32 v248, v248, v187, v196
    v_mfma_f32_16x16x32_bf16 a[76:79], v[228:231], v[212:215], a[76:79]
    v_max3_f32 v248, v248, v197, v198
    v_max_f32 v248, v248, v199
    v_mfma_f32_16x16x32_bf16 a[80:83], v[228:231], v[216:219], a[80:83]
    v_max3_f32 v249, v188, v189, v190
    ds_read_b64_tr_b16 v[224:225], v18 offset:256
    ds_read_b64_tr_b16 v[226:227], v18 offset:8448
    s_waitcnt lgkmcnt(4)
    v_mfma_f32_16x16x32_bf16 a[84:87], v[232:235], v[208:211], a[84:87]
    v_max3_f32 v249, v249, v191, v200
    v_mfma_f32_16x16x32_bf16 a[88:91], v[232:235], v[212:215], a[88:91]
    v_max3_f32 v249, v249, v201, v202
    v_mfma_f32_16x16x32_bf16 a[92:95], v[232:235], v[216:219], a[92:95]
    v_max_f32 v249, v249, v203
    ds_read_b64_tr_b16 v[228:229], v19 offset:256
    ds_read_b64_tr_b16 v[230:231], v19 offset:8448
    s_waitcnt lgkmcnt(4)
    v_mfma_f32_16x16x32_bf16 a[96:99], v[220:223], v[208:211], a[96:99]
    v_max3_f32 v250, v192, v193, v194
    v_mfma_f32_16x16x32_bf16 a[100:103], v[220:223], v[212:215], a[100:103]
    v_max3_f32 v250, v250, v195, v204
    v_mfma_f32_16x16x32_bf16 a[104:107], v[220:223], v[216:219], a[104:107]
    v_max3_f32 v250, v250, v205, v206
    ds_read_b64_tr_b16 v[232:233], v20 offset:256
    ds_read_b64_tr_b16 v[234:235], v20 offset:8448
    s_waitcnt lgkmcnt(4)
    v_mfma_f32_16x16x32_bf16 a[108:111], v[224:227], v[208:211], a[108:111]
    v_max_f32 v250, v250, v207
    v_mfma_f32_16x16x32_bf16 a[112:115], v[224:227], v[212:215], a[112:115]
    v_mov_b32 v38, v248
    v_mov_b32 v39, v249
    v_mfma_f32_16x16x32_bf16 a[116:119], v[224:227], v[216:219], a[116:119]
    v_mov_b32 v40, v250
    ds_read_b64_tr_b16 v[220:221], v21 offset:256
    ds_read_b64_tr_b16 v[222:223], v21 offset:8448
    s_waitcnt lgkmcnt(4)
    v_mfma_f32_16x16x32_bf16 a[120:123], v[228:231], v[208:211], a[120:123]
    s_nop 1
    v_mfma_f32_16x16x32_bf16 a[124:127], v[228:231], v[212:215], a[124:127]
    v_permlane16_swap_b32 v248, v38
    v_mfma_f32_16x16x32_bf16 a[128:131], v[228:231], v[216:219], a[128:131]
    v_permlane16_swap_b32 v249, v39
    ds_read_b64_tr_b16 v[224:225], v22 offset:256
    ds_read_b64_tr_b16 v[226:227], v22 offset:8448
    s_waitcnt lgkmcnt(4)
    v_mfma_f32_16x16x32_bf16 a[132:135], v[232:235], v[208:211], a[132:135]
    v_permlane16_swap_b32 v250, v40
    v_mfma_f32_16x16x32_bf16 a[136:139], v[232:235], v[212:215], a[136:139]
    v_max_f32 v248, v248, v38
    v_mfma_f32_16x16x32_bf16 a[140:143], v[232:235], v[216:219], a[140:143]
    v_max_f32 v249, v249, v39
    ds_read_b64_tr_b16 v[228:229], v23 offset:256
    ds_read_b64_tr_b16 v[230:231], v23 offset:8448
    s_waitcnt lgkmcnt(4)
    v_mfma_f32_16x16x32_bf16 a[144:147], v[220:223], v[208:211], a[144:147]
    v_max_f32 v250, v250, v40
    v_mfma_f32_16x16x32_bf16 a[148:151], v[220:223], v[212:215], a[148:151]
    v_mov_b32 v38, v248
    v_mfma_f32_16x16x32_bf16 a[152:155], v[220:223], v[216:219], a[152:155]
    v_mov_b32 v39, v249
    v_mov_b32 v40, v250
    ds_read_b64_tr_b16 v[232:233], v24 offset:256
    ds_read_b64_tr_b16 v[234:235], v24 offset:8448
    s_waitcnt lgkmcnt(4)
    v_mfma_f32_16x16x32_bf16 a[156:159], v[224:227], v[208:211], a[156:159]
    s_nop 1
    v_mfma_f32_16x16x32_bf16 a[160:163], v[224:227], v[212:215], a[160:163]
    v_permlane32_swap_b32 v248, v38
    v_mfma_f32_16x16x32_bf16 a[164:167], v[224:227], v[216:219], a[164:167]
    v_permlane32_swap_b32 v249, v39
    s_waitcnt lgkmcnt(2)
    v_mfma_f32_16x16x32_bf16 a[168:171], v[228:231], v[208:211], a[168:171]
    v_permlane32_swap_b32 v250, v40
    v_mfma_f32_16x16x32_bf16 a[172:175], v[228:231], v[212:215], a[172:175]
    v_max_f32 v248, v248, v38
    v_mfma_f32_16x16x32_bf16 a[176:179], v[228:231], v[216:219], a[176:179]
    v_max_f32 v249, v249, v39
    s_waitcnt lgkmcnt(0)
    v_mfma_f32_16x16x32_bf16 a[180:183], v[232:235], v[208:211], a[180:183]
    v_max_f32 v250, v250, v40
    v_mfma_f32_16x16x32_bf16 a[184:187], v[232:235], v[212:215], a[184:187]
    v_cmp_gt_f32 s[48:49], v248, v239
    v_mfma_f32_16x16x32_bf16 a[188:191], v[232:235], v[216:219], a[188:191]
    v_cmp_gt_f32 s[50:51], v249, v240
    v_cmp_gt_f32 s[52:53], v250, v241
    s_nop 3
    s_or_b64 s[48:49], s[48:49], s[50:51]
    s_or_b64 s[48:49], s[48:49], s[52:53]
    s_cbranch_scc0 L_norescale1
    v_max_f32 v252, v236, v248
    v_sub_f32 v253, v236, v252
    v_mul_f32 v253, s46, v253
    v_exp_f32 v253, v253
    v_mov_b32 v236, v252
    v_add_f32 v239, 0x42b17218, v252
    v_mul_f32 v242, s46, v252
    v_mul_f32 v245, v245, v253
    v_accvgpr_read_b32 v254, a0
    v_mul_f32 v254, v254, v253
    v_accvgpr_write_b32 a0, v254
    v_accvgpr_read_b32 v254, a1
    v_mul_f32 v254, v254, v253
    v_accvgpr_write_b32 a1, v254
    v_accvgpr_read_b32 v254, a2
    v_mul_f32 v254, v254, v253
    v_accvgpr_write_b32 a2, v254
    v_accvgpr_read_b32 v254, a3
    v_mul_f32 v254, v254, v253
    v_accvgpr_write_b32 a3, v254
    v_accvgpr_read_b32 v254, a12
    v_mul_f32 v254, v254, v253
    v_accvgpr_write_b32 a12, v254
    v_accvgpr_read_b32 v254, a13
    v_mul_f32 v254, v254, v253
    v_accvgpr_write_b32 a13, v254
    v_accvgpr_read_b32 v254, a14
    v_mul_f32 v254, v254, v253
    v_accvgpr_write_b32 a14, v254
    v_accvgpr_read_b32 v254, a15
    v_mul_f32 v254, v254, v253
    v_accvgpr_write_b32 a15, v254
    v_accvgpr_read_b32 v254, a24
    v_mul_f32 v254, v254, v253
    v_accvgpr_write_b32 a24, v254
    v_accvgpr_read_b32 v254, a25
    v_mul_f32 v254, v254, v253
    v_accvgpr_write_b32 a25, v254
    v_accvgpr_read_b32 v254, a26
    v_mul_f32 v254, v254, v253
    v_accvgpr_write_b32 a26, v254
    v_accvgpr_read_b32 v254, a27
    v_mul_f32 v254, v254, v253
    v_accvgpr_write_b32 a27, v254
    v_accvgpr_read_b32 v254, a36
    v_mul_f32 v254, v254, v253
    v_accvgpr_write_b32 a36, v254
    v_accvgpr_read_b32 v254, a37
    v_mul_f32 v254, v254, v253
    v_accvgpr_write_b32 a37, v254
    v_accvgpr_read_b32 v254, a38
    v_mul_f32 v254, v254, v253
    v_accvgpr_write_b32 a38, v254
    v_accvgpr_read_b32 v254, a39
    v_mul_f32 v254, v254, v253
    v_accvgpr_write_b32 a39, v254
    v_accvgpr_read_b32 v254, a48
    v_mul_f32 v254, v254, v253
    v_accvgpr_write_b32 a48, v254
    v_accvgpr_read_b32 v254, a49
    v_mul_f32 v254, v254, v253
    v_accvgpr_write_b32 a49, v254
    v_accvgpr_read_b32 v254, a50
    v_mul_f32 v254, v254, v253
    v_accvgpr_write_b32 a50, v254
    v_accvgpr_read_b32 v254, a51
    v_mul_f32 v254, v254, v253
    v_accvgpr_write_b32 a51, v254
    v_accvgpr_read_b32 v254, a60
    v_mul_f32 v254, v254, v253
    v_accvgpr_write_b32 a60, v254
    v_accvgpr_read_b32 v254, a61
    v_mul_f32 v254, v254, v253
    v_accvgpr_write_b32 a61, v254
    v_accvgpr_read_b32 v254, a62
    v_mul_f32 v254, v254, v253
    v_accvgpr_write_b32 a62, v254
    v_accvgpr_read_b32 v254, a63
    v_mul_f32 v254, v254, v253
    v_accvgpr_write_b32 a63, v254
    v_accvgpr_read_b32 v254, a72
    v_mul_f32 v254, v254, v253
    v_accvgpr_write_b32 a72, v254
    v_accvgpr_read_b32 v254, a73
    v_mul_f32 v254, v254, v253
    v_accvgpr_write_b32 a73, v254
    v_accvgpr_read_b32 v254, a74
    v_mul_f32 v254, v254, v253
    v_accvgpr_write_b32 a74, v254
    v_accvgpr_read_b32 v254, a75
    v_mul_f32 v254, v254, v253
    v_accvgpr_write_b32 a75, v254
    v_accvgpr_read_b32 v254, a84
    v_mul_f32 v254, v254, v253
    v_accvgpr_write_b32 a84, v254
    v_accvgpr_read_b32 v254, a85
    v_mul_f32 v254, v254, v253
    v_accvgpr_write_b32 a85, v254
    v_accvgpr_read_b32 v254, a86
    v_mul_f32 v254, v254, v253
    v_accvgpr_write_b32 a86, v254
    v_accvgpr_read_b32 v254, a87
    v_mul_f32 v254, v254, v253
    v_accvgpr_write_b32 a87, v254
    v_accvgpr_read_b32 v254, a96
    v_mul_f32 v254, v254, v253
    v_accvgpr_write_b32 a96, v254
    v_accvgpr_read_b32 v254, a97
    v_mul_f32 v254, v254, v253
    v_accvgpr_write_b32 a97, v254
    v_accvgpr_read_b32 v254, a98
    v_mul_f32 v254, v254, v253
    v_accvgpr_write_b32 a98, v254
    v_accvgpr_read_b32 v254, a99
    v_mul_f32 v254, v254, v253
    v_accvgpr_write_b32 a99, v254
    v_accvgpr_read_b32 v254, a108
    v_mul_f32 v254, v254, v253
    v_accvgpr_write_b32 a108, v254
    v_accvgpr_read_b32 v254, a109
    v_mul_f32 v254, v254, v253
    v_accvgpr_write_b32 a109, v254
    v_accvgpr_read_b32 v254, a110
    v_mul_f32 v254, v254, v253
    v_accvgpr_write_b32 a110, v254
    v_accvgpr_read_b32 v254, a111
    v_mul_f32 v254, v254, v253
    v_accvgpr_write_b32 a111, v254
    v_accvgpr_read_b32 v254, a120
    v_mul_f32 v254, v254, v253
    v_accvgpr_write_b32 a120, v254
    v_accvgpr_read_b32 v254, a121
    v_mul_f32 v254, v254, v253
    v_accvgpr_write_b32 a121, v254
    v_accvgpr_read_b32 v254, a122
    v_mul_f32 v254, v254, v253
    v_accvgpr_write_b32 a122, v254
    v_accvgpr_read_b32 v254, a123
    v_mul_f32 v254, v254, v253
    v_accvgpr_write_b32 a123, v254
    v_accvgpr_read_b32 v254, a132
    v_mul_f32 v254, v254, v253
    v_accvgpr_write_b32 a132, v254
    v_accvgpr_read_b32 v254, a133
    v_mul_f32 v254, v254, v253
    v_accvgpr_write_b32 a133, v254
    v_accvgpr_read_b32 v254, a134
    v_mul_f32 v254, v254, v253
    v_accvgpr_write_b32 a134, v254
    v_accvgpr_read_b32 v254, a135
    v_mul_f32 v254, v254, v253
    v_accvgpr_write_b32 a135, v254
    v_accvgpr_read_b32 v254, a144
    v_mul_f32 v254, v254, v253
    v_accvgpr_write_b32 a144, v254
    v_accvgpr_read_b32 v254, a145
    v_mul_f32 v254, v254, v253
    v_accvgpr_write_b32 a145, v254
    v_accvgpr_read_b32 v254, a146
    v_mul_f32 v254, v254, v253
    v_accvgpr_write_b32 a146, v254
    v_accvgpr_read_b32 v254, a147
    v_mul_f32 v254, v254, v253
    v_accvgpr_write_b32 a147, v254
    v_accvgpr_read_b32 v254, a156
    v_mul_f32 v254, v254, v253
    v_accvgpr_write_b32 a156, v254
    v_accvgpr_read_b32 v254, a157
    v_mul_f32 v254, v254, v253
    v_accvgpr_write_b32 a157, v254
    v_accvgpr_read_b32 v254, a158
    v_mul_f32 v254, v254, v253
    v_accvgpr_write_b32 a158, v254
    v_accvgpr_read_b32 v254, a159
    v_mul_f32 v254, v254, v253
    v_accvgpr_write_b32 a159, v254
    v_accvgpr_read_b32 v254, a168
    v_mul_f32 v254, v254, v253
    v_accvgpr_write_b32 a168, v254
    v_accvgpr_read_b32 v254, a169
    v_mul_f32 v254, v254, v253
    v_accvgpr_write_b32 a169, v254
    v_accvgpr_read_b32 v254, a170
    v_mul_f32 v254, v254, v253
    v_accvgpr_write_b32 a170, v254
    v_accvgpr_read_b32 v254, a171
    v_mul_f32 v254, v254, v253
    v_accvgpr_write_b32 a171, v254
    v_accvgpr_read_b32 v254, a180
    v_mul_f32 v254, v254, v253
    v_accvgpr_write_b32 a180, v254
    v_accvgpr_read_b32 v254, a181
    v_mul_f32 v254, v254, v253
    v_accvgpr_write_b32 a181, v254
    v_accvgpr_read_b32 v254, a182
    v_mul_f32 v254, v254, v253
    v_accvgpr_write_b32 a182, v254
    v_accvgpr_read_b32 v254, a183
    v_mul_f32 v254, v254, v253
    v_accvgpr_write_b32 a183, v254
    v_max_f32 v252, v237, v249
    v_sub_f32 v253, v237, v252
    v_mul_f32 v253, s46, v253
    v_exp_f32 v253, v253
    v_mov_b32 v237, v252
    v_add_f32 v240, 0x42b17218, v252
    v_mul_f32 v243, s46, v252
    v_mul_f32 v246, v246, v253
    v_accvgpr_read_b32 v254, a4
    v_mul_f32 v254, v254, v253
    v_accvgpr_write_b32 a4, v254
    v_accvgpr_read_b32 v254, a5
    v_mul_f32 v254, v254, v253
    v_accvgpr_write_b32 a5, v254
    v_accvgpr_read_b32 v254, a6
    v_mul_f32 v254, v254, v253
    v_accvgpr_write_b32 a6, v254
    v_accvgpr_read_b32 v254, a7
    v_mul_f32 v254, v254, v253
    v_accvgpr_write_b32 a7, v254
    v_accvgpr_read_b32 v254, a16
    v_mul_f32 v254, v254, v253
    v_accvgpr_write_b32 a16, v254
    v_accvgpr_read_b32 v254, a17
    v_mul_f32 v254, v254, v253
    v_accvgpr_write_b32 a17, v254
    v_accvgpr_read_b32 v254, a18
    v_mul_f32 v254, v254, v253
    v_accvgpr_write_b32 a18, v254
    v_accvgpr_read_b32 v254, a19
    v_mul_f32 v254, v254, v253
    v_accvgpr_write_b32 a19, v254
    v_accvgpr_read_b32 v254, a28
    v_mul_f32 v254, v254, v253
    v_accvgpr_write_b32 a28, v254
    v_accvgpr_read_b32 v254, a29
    v_mul_f32 v254, v254, v253
    v_accvgpr_write_b32 a29, v254
    v_accvgpr_read_b32 v254, a30
    v_mul_f32 v254, v254, v253
    v_accvgpr_write_b32 a30, v254
    v_accvgpr_read_b32 v254, a31
    v_mul_f32 v254, v254, v253
    v_accvgpr_write_b32 a31, v254
    v_accvgpr_read_b32 v254, a40
    v_mul_f32 v254, v254, v253
    v_accvgpr_write_b32 a40, v254
    v_accvgpr_read_b32 v254, a41
    v_mul_f32 v254, v254, v253
    v_accvgpr_write_b32 a41, v254
    v_accvgpr_read_b32 v254, a42
    v_mul_f32 v254, v254, v253
    v_accvgpr_write_b32 a42, v254
    v_accvgpr_read_b32 v254, a43
    v_mul_f32 v254, v254, v253
    v_accvgpr_write_b32 a43, v254
    v_accvgpr_read_b32 v254, a52
    v_mul_f32 v254, v254, v253
    v_accvgpr_write_b32 a52, v254
    v_accvgpr_read_b32 v254, a53
    v_mul_f32 v254, v254, v253
    v_accvgpr_write_b32 a53, v254
    v_accvgpr_read_b32 v254, a54
    v_mul_f32 v254, v254, v253
    v_accvgpr_write_b32 a54, v254
    v_accvgpr_read_b32 v254, a55
    v_mul_f32 v254, v254, v253
    v_accvgpr_write_b32 a55, v254
    v_accvgpr_read_b32 v254, a64
    v_mul_f32 v254, v254, v253
    v_accvgpr_write_b32 a64, v254
    v_accvgpr_read_b32 v254, a65
    v_mul_f32 v254, v254, v253
    v_accvgpr_write_b32 a65, v254
    v_accvgpr_read_b32 v254, a66
    v_mul_f32 v254, v254, v253
    v_accvgpr_write_b32 a66, v254
    v_accvgpr_read_b32 v254, a67
    v_mul_f32 v254, v254, v253
    v_accvgpr_write_b32 a67, v254
    v_accvgpr_read_b32 v254, a76
    v_mul_f32 v254, v254, v253
    v_accvgpr_write_b32 a76, v254
    v_accvgpr_read_b32 v254, a77
    v_mul_f32 v254, v254, v253
    v_accvgpr_write_b32 a77, v254
    v_accvgpr_read_b32 v254, a78
    v_mul_f32 v254, v254, v253
    v_accvgpr_write_b32 a78, v254
    v_accvgpr_read_b32 v254, a79
    v_mul_f32 v254, v254, v253
    v_accvgpr_write_b32 a79, v254
    v_accvgpr_read_b32 v254, a88
    v_mul_f32 v254, v254, v253
    v_accvgpr_write_b32 a88, v254
    v_accvgpr_read_b32 v254, a89
    v_mul_f32 v254, v254, v253
    v_accvgpr_write_b32 a89, v254
    v_accvgpr_read_b32 v254, a90
    v_mul_f32 v254, v254, v253
    v_accvgpr_write_b32 a90, v254
    v_accvgpr_read_b32 v254, a91
    v_mul_f32 v254, v254, v253
    v_accvgpr_write_b32 a91, v254
    v_accvgpr_read_b32 v254, a100
    v_mul_f32 v254, v254, v253
    v_accvgpr_write_b32 a100, v254
    v_accvgpr_read_b32 v254, a101
    v_mul_f32 v254, v254, v253
    v_accvgpr_write_b32 a101, v254
    v_accvgpr_read_b32 v254, a102
    v_mul_f32 v254, v254, v253
    v_accvgpr_write_b32 a102, v254
    v_accvgpr_read_b32 v254, a103
    v_mul_f32 v254, v254, v253
    v_accvgpr_write_b32 a103, v254
    v_accvgpr_read_b32 v254, a112
    v_mul_f32 v254, v254, v253
    v_accvgpr_write_b32 a112, v254
    v_accvgpr_read_b32 v254, a113
    v_mul_f32 v254, v254, v253
    v_accvgpr_write_b32 a113, v254
    v_accvgpr_read_b32 v254, a114
    v_mul_f32 v254, v254, v253
    v_accvgpr_write_b32 a114, v254
    v_accvgpr_read_b32 v254, a115
    v_mul_f32 v254, v254, v253
    v_accvgpr_write_b32 a115, v254
    v_accvgpr_read_b32 v254, a124
    v_mul_f32 v254, v254, v253
    v_accvgpr_write_b32 a124, v254
    v_accvgpr_read_b32 v254, a125
    v_mul_f32 v254, v254, v253
    v_accvgpr_write_b32 a125, v254
    v_accvgpr_read_b32 v254, a126
    v_mul_f32 v254, v254, v253
    v_accvgpr_write_b32 a126, v254
    v_accvgpr_read_b32 v254, a127
    v_mul_f32 v254, v254, v253
    v_accvgpr_write_b32 a127, v254
    v_accvgpr_read_b32 v254, a136
    v_mul_f32 v254, v254, v253
    v_accvgpr_write_b32 a136, v254
    v_accvgpr_read_b32 v254, a137
    v_mul_f32 v254, v254, v253
    v_accvgpr_write_b32 a137, v254
    v_accvgpr_read_b32 v254, a138
    v_mul_f32 v254, v254, v253
    v_accvgpr_write_b32 a138, v254
    v_accvgpr_read_b32 v254, a139
    v_mul_f32 v254, v254, v253
    v_accvgpr_write_b32 a139, v254
    v_accvgpr_read_b32 v254, a148
    v_mul_f32 v254, v254, v253
    v_accvgpr_write_b32 a148, v254
    v_accvgpr_read_b32 v254, a149
    v_mul_f32 v254, v254, v253
    v_accvgpr_write_b32 a149, v254
    v_accvgpr_read_b32 v254, a150
    v_mul_f32 v254, v254, v253
    v_accvgpr_write_b32 a150, v254
    v_accvgpr_read_b32 v254, a151
    v_mul_f32 v254, v254, v253
    v_accvgpr_write_b32 a151, v254
    v_accvgpr_read_b32 v254, a160
    v_mul_f32 v254, v254, v253
    v_accvgpr_write_b32 a160, v254
    v_accvgpr_read_b32 v254, a161
    v_mul_f32 v254, v254, v253
    v_accvgpr_write_b32 a161, v254
    v_accvgpr_read_b32 v254, a162
    v_mul_f32 v254, v254, v253
    v_accvgpr_write_b32 a162, v254
    v_accvgpr_read_b32 v254, a163
    v_mul_f32 v254, v254, v253
    v_accvgpr_write_b32 a163, v254
    v_accvgpr_read_b32 v254, a172
    v_mul_f32 v254, v254, v253
    v_accvgpr_write_b32 a172, v254
    v_accvgpr_read_b32 v254, a173
    v_mul_f32 v254, v254, v253
    v_accvgpr_write_b32 a173, v254
    v_accvgpr_read_b32 v254, a174
    v_mul_f32 v254, v254, v253
    v_accvgpr_write_b32 a174, v254
    v_accvgpr_read_b32 v254, a175
    v_mul_f32 v254, v254, v253
    v_accvgpr_write_b32 a175, v254
    v_accvgpr_read_b32 v254, a184
    v_mul_f32 v254, v254, v253
    v_accvgpr_write_b32 a184, v254
    v_accvgpr_read_b32 v254, a185
    v_mul_f32 v254, v254, v253
    v_accvgpr_write_b32 a185, v254
    v_accvgpr_read_b32 v254, a186
    v_mul_f32 v254, v254, v253
    v_accvgpr_write_b32 a186, v254
    v_accvgpr_read_b32 v254, a187
    v_mul_f32 v254, v254, v253
    v_accvgpr_write_b32 a187, v254
    v_max_f32 v252, v238, v250
    v_sub_f32 v253, v238, v252
    v_mul_f32 v253, s46, v253
    v_exp_f32 v253, v253
    v_mov_b32 v238, v252
    v_add_f32 v241, 0x42b17218, v252
    v_mul_f32 v244, s46, v252
    v_mul_f32 v247, v247, v253
    v_accvgpr_read_b32 v254, a8
    v_mul_f32 v254, v254, v253
    v_accvgpr_write_b32 a8, v254
    v_accvgpr_read_b32 v254, a9
    v_mul_f32 v254, v254, v253
    v_accvgpr_write_b32 a9, v254
    v_accvgpr_read_b32 v254, a10
    v_mul_f32 v254, v254, v253
    v_accvgpr_write_b32 a10, v254
    v_accvgpr_read_b32 v254, a11
    v_mul_f32 v254, v254, v253
    v_accvgpr_write_b32 a11, v254
    v_accvgpr_read_b32 v254, a20
    v_mul_f32 v254, v254, v253
    v_accvgpr_write_b32 a20, v254
    v_accvgpr_read_b32 v254, a21
    v_mul_f32 v254, v254, v253
    v_accvgpr_write_b32 a21, v254
    v_accvgpr_read_b32 v254, a22
    v_mul_f32 v254, v254, v253
    v_accvgpr_write_b32 a22, v254
    v_accvgpr_read_b32 v254, a23
    v_mul_f32 v254, v254, v253
    v_accvgpr_write_b32 a23, v254
    v_accvgpr_read_b32 v254, a32
    v_mul_f32 v254, v254, v253
    v_accvgpr_write_b32 a32, v254
    v_accvgpr_read_b32 v254, a33
    v_mul_f32 v254, v254, v253
    v_accvgpr_write_b32 a33, v254
    v_accvgpr_read_b32 v254, a34
    v_mul_f32 v254, v254, v253
    v_accvgpr_write_b32 a34, v254
    v_accvgpr_read_b32 v254, a35
    v_mul_f32 v254, v254, v253
    v_accvgpr_write_b32 a35, v254
    v_accvgpr_read_b32 v254, a44
    v_mul_f32 v254, v254, v253
    v_accvgpr_write_b32 a44, v254
    v_accvgpr_read_b32 v254, a45
    v_mul_f32 v254, v254, v253
    v_accvgpr_write_b32 a45, v254
    v_accvgpr_read_b32 v254, a46
    v_mul_f32 v254, v254, v253
    v_accvgpr_write_b32 a46, v254
    v_accvgpr_read_b32 v254, a47
    v_mul_f32 v254, v254, v253
    v_accvgpr_write_b32 a47, v254
    v_accvgpr_read_b32 v254, a56
    v_mul_f32 v254, v254, v253
    v_accvgpr_write_b32 a56, v254
    v_accvgpr_read_b32 v254, a57
    v_mul_f32 v254, v254, v253
    v_accvgpr_write_b32 a57, v254
    v_accvgpr_read_b32 v254, a58
    v_mul_f32 v254, v254, v253
    v_accvgpr_write_b32 a58, v254
    v_accvgpr_read_b32 v254, a59
    v_mul_f32 v254, v254, v253
    v_accvgpr_write_b32 a59, v254
    v_accvgpr_read_b32 v254, a68
    v_mul_f32 v254, v254, v253
    v_accvgpr_write_b32 a68, v254
    v_accvgpr_read_b32 v254, a69
    v_mul_f32 v254, v254, v253
    v_accvgpr_write_b32 a69, v254
    v_accvgpr_read_b32 v254, a70
    v_mul_f32 v254, v254, v253
    v_accvgpr_write_b32 a70, v254
    v_accvgpr_read_b32 v254, a71
    v_mul_f32 v254, v254, v253
    v_accvgpr_write_b32 a71, v254
    v_accvgpr_read_b32 v254, a80
    v_mul_f32 v254, v254, v253
    v_accvgpr_write_b32 a80, v254
    v_accvgpr_read_b32 v254, a81
    v_mul_f32 v254, v254, v253
    v_accvgpr_write_b32 a81, v254
    v_accvgpr_read_b32 v254, a82
    v_mul_f32 v254, v254, v253
    v_accvgpr_write_b32 a82, v254
    v_accvgpr_read_b32 v254, a83
    v_mul_f32 v254, v254, v253
    v_accvgpr_write_b32 a83, v254
    v_accvgpr_read_b32 v254, a92
    v_mul_f32 v254, v254, v253
    v_accvgpr_write_b32 a92, v254
    v_accvgpr_read_b32 v254, a93
    v_mul_f32 v254, v254, v253
    v_accvgpr_write_b32 a93, v254
    v_accvgpr_read_b32 v254, a94
    v_mul_f32 v254, v254, v253
    v_accvgpr_write_b32 a94, v254
    v_accvgpr_read_b32 v254, a95
    v_mul_f32 v254, v254, v253
    v_accvgpr_write_b32 a95, v254
    v_accvgpr_read_b32 v254, a104
    v_mul_f32 v254, v254, v253
    v_accvgpr_write_b32 a104, v254
    v_accvgpr_read_b32 v254, a105
    v_mul_f32 v254, v254, v253
    v_accvgpr_write_b32 a105, v254
    v_accvgpr_read_b32 v254, a106
    v_mul_f32 v254, v254, v253
    v_accvgpr_write_b32 a106, v254
    v_accvgpr_read_b32 v254, a107
    v_mul_f32 v254, v254, v253
    v_accvgpr_write_b32 a107, v254
    v_accvgpr_read_b32 v254, a116
    v_mul_f32 v254, v254, v253
    v_accvgpr_write_b32 a116, v254
    v_accvgpr_read_b32 v254, a117
    v_mul_f32 v254, v254, v253
    v_accvgpr_write_b32 a117, v254
    v_accvgpr_read_b32 v254, a118
    v_mul_f32 v254, v254, v253
    v_accvgpr_write_b32 a118, v254
    v_accvgpr_read_b32 v254, a119
    v_mul_f32 v254, v254, v253
    v_accvgpr_write_b32 a119, v254
    v_accvgpr_read_b32 v254, a128
    v_mul_f32 v254, v254, v253
    v_accvgpr_write_b32 a128, v254
    v_accvgpr_read_b32 v254, a129
    v_mul_f32 v254, v254, v253
    v_accvgpr_write_b32 a129, v254
    v_accvgpr_read_b32 v254, a130
    v_mul_f32 v254, v254, v253
    v_accvgpr_write_b32 a130, v254
    v_accvgpr_read_b32 v254, a131
    v_mul_f32 v254, v254, v253
    v_accvgpr_write_b32 a131, v254
    v_accvgpr_read_b32 v254, a140
    v_mul_f32 v254, v254, v253
    v_accvgpr_write_b32 a140, v254
    v_accvgpr_read_b32 v254, a141
    v_mul_f32 v254, v254, v253
    v_accvgpr_write_b32 a141, v254
    v_accvgpr_read_b32 v254, a142
    v_mul_f32 v254, v254, v253
    v_accvgpr_write_b32 a142, v254
    v_accvgpr_read_b32 v254, a143
    v_mul_f32 v254, v254, v253
    v_accvgpr_write_b32 a143, v254
    v_accvgpr_read_b32 v254, a152
    v_mul_f32 v254, v254, v253
    v_accvgpr_write_b32 a152, v254
    v_accvgpr_read_b32 v254, a153
    v_mul_f32 v254, v254, v253
    v_accvgpr_write_b32 a153, v254
    v_accvgpr_read_b32 v254, a154
    v_mul_f32 v254, v254, v253
    v_accvgpr_write_b32 a154, v254
    v_accvgpr_read_b32 v254, a155
    v_mul_f32 v254, v254, v253
    v_accvgpr_write_b32 a155, v254
    v_accvgpr_read_b32 v254, a164
    v_mul_f32 v254, v254, v253
    v_accvgpr_write_b32 a164, v254
    v_accvgpr_read_b32 v254, a165
    v_mul_f32 v254, v254, v253
    v_accvgpr_write_b32 a165, v254
    v_accvgpr_read_b32 v254, a166
    v_mul_f32 v254, v254, v253
    v_accvgpr_write_b32 a166, v254
    v_accvgpr_read_b32 v254, a167
    v_mul_f32 v254, v254, v253
    v_accvgpr_write_b32 a167, v254
    v_accvgpr_read_b32 v254, a176
    v_mul_f32 v254, v254, v253
    v_accvgpr_write_b32 a176, v254
    v_accvgpr_read_b32 v254, a177
    v_mul_f32 v254, v254, v253
    v_accvgpr_write_b32 a177, v254
    v_accvgpr_read_b32 v254, a178
    v_mul_f32 v254, v254, v253
    v_accvgpr_write_b32 a178, v254
    v_accvgpr_read_b32 v254, a179
    v_mul_f32 v254, v254, v253
    v_accvgpr_write_b32 a179, v254
    v_accvgpr_read_b32 v254, a188
    v_mul_f32 v254, v254, v253
    v_accvgpr_write_b32 a188, v254
    v_accvgpr_read_b32 v254, a189
    v_mul_f32 v254, v254, v253
    v_accvgpr_write_b32 a189, v254
    v_accvgpr_read_b32 v254, a190
    v_mul_f32 v254, v254, v253
    v_accvgpr_write_b32 a190, v254
    v_accvgpr_read_b32 v254, a191
    v_mul_f32 v254, v254, v253
    v_accvgpr_write_b32 a191, v254
L_norescale1:
    s_waitcnt vmcnt(16)
    s_barrier
    s_lshl_b32 s40, s34, 13
    s_add_u32 s41, s40, s45
    s_add_u32 s40, s40, 65536
    s_mov_b32 m0, s40
    s_nop 0
    buffer_load_dwordx4 v4, s[16:19], s41 offen offset:0 lds
    buffer_load_dwordx4 v5, s[16:19], s41 offen offset:1024 lds
    buffer_load_dwordx4 v6, s[16:19], s41 offen offset:2048 lds
    buffer_load_dwordx4 v7, s[16:19], s41 offen offset:3072 lds
    s_add_u32 s40, s40, 4096
    s_add_u32 s41, s41, 4096
    s_mov_b32 m0, s40
    s_nop 0
    buffer_load_dwordx4 v4, s[16:19], s41 offen offset:0 lds
    buffer_load_dwordx4 v5, s[16:19], s41 offen offset:1024 lds
    buffer_load_dwordx4 v6, s[16:19], s41 offen offset:2048 lds
    buffer_load_dwordx4 v7, s[16:19], s41 offen offset:3072 lds
    s_add_u32 s45, s45, 32768
    s_add_u32 s47, s45, 32768
    ds_read_b128 v[220:223], v13 offset:0
    ds_read_b128 v[224:227], v13 offset:8192
    ds_read_b128 v[228:231], v14 offset:0
    ds_read_b128 v[232:235], v14 offset:8192
    s_waitcnt lgkmcnt(2)
    v_mfma_f32_16x16x32_bf16 v[160:163], v[220:223], v[64:67], 0
    v_fma_f32 v184, v184, s46, -v242
    v_mfma_f32_16x16x32_bf16 v[164:167], v[220:223], v[68:71], 0
    v_exp_f32 v184, v184
    v_fma_f32 v185, v185, s46, -v242
    v_mfma_f32_16x16x32_bf16 v[168:171], v[220:223], v[72:75], 0
    v_exp_f32 v185, v185
    v_fma_f32 v186, v186, s46, -v242
    v_mfma_f32_16x16x32_bf16 v[172:175], v[224:227], v[64:67], 0
    v_exp_f32 v186, v186
    v_fma_f32 v187, v187, s46, -v242
    v_mfma_f32_16x16x32_bf16 v[176:179], v[224:227], v[68:71], 0
    v_exp_f32 v187, v187
    v_mfma_f32_16x16x32_bf16 v[180:183], v[224:227], v[72:75], 0
    v_fma_f32 v196, v196, s46, -v242
    v_exp_f32 v196, v196
    ds_read_b128 v[220:223], v15 offset:0
    ds_read_b128 v[224:227], v15 offset:8192
    s_waitcnt lgkmcnt(2)
    v_mfma_f32_16x16x32_bf16 v[160:163], v[228:231], v[76:79], v[160:163]
    v_fma_f32 v197, v197, s46, -v242
    v_exp_f32 v197, v197
    v_mfma_f32_16x16x32_bf16 v[164:167], v[228:231], v[80:83], v[164:167]
    v_fma_f32 v198, v198, s46, -v242
    v_exp_f32 v198, v198
    v_mfma_f32_16x16x32_bf16 v[168:171], v[228:231], v[84:87], v[168:171]
    v_fma_f32 v199, v199, s46, -v242
    v_mfma_f32_16x16x32_bf16 v[172:175], v[232:235], v[76:79], v[172:175]
    v_exp_f32 v199, v199
    v_add_f32 v38, v184, v185
    v_mfma_f32_16x16x32_bf16 v[176:179], v[232:235], v[80:83], v[176:179]
    v_add_f32 v39, v186, v187
    v_add_f32 v40, v196, v197
    v_mfma_f32_16x16x32_bf16 v[180:183], v[232:235], v[84:87], v[180:183]
    v_add_f32 v41, v198, v199
    v_add_f32 v38, v38, v39
    ds_read_b128 v[228:231], v16 offset:0
    ds_read_b128 v[232:235], v16 offset:8192
    s_waitcnt lgkmcnt(2)
    v_mfma_f32_16x16x32_bf16 v[160:163], v[220:223], v[88:91], v[160:163]
    v_add_f32 v40, v40, v41
    v_mfma_f32_16x16x32_bf16 v[164:167], v[220:223], v[92:95], v[164:167]
    v_add_f32 v245, v245, v38
    v_add_f32 v245, v245, v40
    v_mfma_f32_16x16x32_bf16 v[168:171], v[220:223], v[96:99], v[168:171]
    v_cvt_pk_bf16_f32 v208, v184, v185
    v_cvt_pk_bf16_f32 v209, v186, v187
    v_mfma_f32_16x16x32_bf16 v[172:175], v[224:227], v[88:91], v[172:175]
    v_cvt_pk_bf16_f32 v210, v196, v197
    v_cvt_pk_bf16_f32 v211, v198, v199
    v_mfma_f32_16x16x32_bf16 v[176:179], v[224:227], v[92:95], v[176:179]
    v_fma_f32 v188, v188, s46, -v243
    v_mfma_f32_16x16x32_bf16 v[180:183], v[224:227], v[96:99], v[180:183]
    v_exp_f32 v188, v188
    v_fma_f32 v189, v189, s46, -v243
    ds_read_b128 v[220:223], v13 offset:256
    ds_read_b128 v[224:227], v13 offset:8448
    s_waitcnt lgkmcnt(2)
    v_mfma_f32_16x16x32_bf16 v[160:163], v[228:231], v[100:103], v[160:163]
    v_exp_f32 v189, v189
    v_fma_f32 v190, v190, s46, -v243
    v_mfma_f32_16x16x32_bf16 v[164:167], v[228:231], v[104:107], v[164:167]
    v_exp_f32 v190, v190
    v_fma_f32 v191, v191, s46, -v243
    v_mfma_f32_16x16x32_bf16 v[168:171], v[228:231], v[108:111], v[168:171]
    v_exp_f32 v191, v191
    v_mfma_f32_16x16x32_bf16 v[172:175], v[232:235], v[100:103], v[172:175]
    v_fma_f32 v200, v200, s46, -v243
    v_exp_f32 v200, v200
    v_mfma_f32_16x16x32_bf16 v[176:179], v[232:235], v[104:107], v[176:179]
    v_fma_f32 v201, v201, s46, -v243
    v_exp_f32 v201, v201
    v_mfma_f32_16x16x32_bf16 v[180:183], v[232:235], v[108:111], v[180:183]
    v_fma_f32 v202, v202, s46, -v243
    v_exp_f32 v202, v202
    ds_read_b128 v[228:231], v14 offset:256
    ds_read_b128 v[232:235], v14 offset:8448
    s_waitcnt lgkmcnt(2)
    v_mfma_f32_16x16x32_bf16 v[160:163], v[220:223], v[112:115], v[160:163]
    v_fma_f32 v203, v203, s46, -v243
    v_mfma_f32_16x16x32_bf16 v[164:167], v[220:223], v[116:119], v[164:167]
    v_exp_f32 v203, v203
    v_add_f32 v42, v188, v189
    v_mfma_f32_16x16x32_bf16 v[168:171], v[220:223], v[120:123], v[168:171]
    v_add_f32 v43, v190, v191
    v_add_f32 v44, v200, v201
    v_mfma_f32_16x16x32_bf16 v[172:175], v[224:227], v[112:115], v[172:175]
    v_add_f32 v45, v202, v203
    v_add_f32 v42, v42, v43
    v_mfma_f32_16x16x32_bf16 v[176:179], v[224:227], v[116:119], v[176:179]
    v_add_f32 v44, v44, v45
    v_mfma_f32_16x16x32_bf16 v[180:183], v[224:227], v[120:123], v[180:183]
    v_add_f32 v246, v246, v42
    v_add_f32 v246, v246, v44
    ds_read_b128 v[220:223], v15 offset:256
    ds_read_b128 v[224:227], v15 offset:8448
    s_waitcnt lgkmcnt(2)
    v_mfma_f32_16x16x32_bf16 v[160:163], v[228:231], v[124:127], v[160:163]
    v_cvt_pk_bf16_f32 v212, v188, v189
    v_cvt_pk_bf16_f32 v213, v190, v191
    v_mfma_f32_16x16x32_bf16 v[164:167], v[228:231], v[128:131], v[164:167]
    v_cvt_pk_bf16_f32 v214, v200, v201
    v_cvt_pk_bf16_f32 v215, v202, v203
    v_mfma_f32_16x16x32_bf16 v[168:171], v[228:231], v[132:135], v[168:171]
    v_fma_f32 v192, v192, s46, -v244
    v_mfma_f32_16x16x32_bf16 v[172:175], v[232:235], v[124:127], v[172:175]
    v_exp_f32 v192, v192
    v_fma_f32 v193, v193, s46, -v244
    v_mfma_f32_16x16x32_bf16 v[176:179], v[232:235], v[128:131], v[176:179]
    v_exp_f32 v193, v193
    v_fma_f32 v194, v194, s46, -v244
    v_mfma_f32_16x16x32_bf16 v[180:183], v[232:235], v[132:135], v[180:183]
    v_exp_f32 v194, v194
    v_fma_f32 v195, v195, s46, -v244
    ds_read_b128 v[228:231], v16 offset:256
    ds_read_b128 v[232:235], v16 offset:8448
    s_waitcnt lgkmcnt(2)
    v_mfma_f32_16x16x32_bf16 v[160:163], v[220:223], v[136:139], v[160:163]
    v_exp_f32 v195, v195
    v_mfma_f32_16x16x32_bf16 v[164:167], v[220:223], v[140:143], v[164:167]
    v_fma_f32 v204, v204, s46, -v244
    v_exp_f32 v204, v204
    v_mfma_f32_16x16x32_bf16 v[168:171], v[220:223], v[144:147], v[168:171]
    v_fma_f32 v205, v205, s46, -v244
    v_exp_f32 v205, v205
    v_mfma_f32_16x16x32_bf16 v[172:175], v[224:227], v[136:139], v[172:175]
    v_fma_f32 v206, v206, s46, -v244
    v_exp_f32 v206, v206
    v_mfma_f32_16x16x32_bf16 v[176:179], v[224:227], v[140:143], v[176:179]
    v_fma_f32 v207, v207, s46, -v244
    v_mfma_f32_16x16x32_bf16 v[180:183], v[224:227], v[144:147], v[180:183]
    v_exp_f32 v207, v207
    v_add_f32 v46, v192, v193
    s_waitcnt lgkmcnt(0)
    v_mfma_f32_16x16x32_bf16 v[160:163], v[228:231], v[148:151], v[160:163]
    v_add_f32 v47, v194, v195
    v_add_f32 v48, v204, v205
    v_mfma_f32_16x16x32_bf16 v[164:167], v[228:231], v[152:155], v[164:167]
    v_add_f32 v49, v206, v207
    v_add_f32 v46, v46, v47
    v_mfma_f32_16x16x32_bf16 v[168:171], v[228:231], v[156:159], v[168:171]
    v_add_f32 v48, v48, v49
    v_mfma_f32_16x16x32_bf16 v[172:175], v[232:235], v[148:151], v[172:175]
    v_add_f32 v247, v247, v46
    v_add_f32 v247, v247, v48
    v_mfma_f32_16x16x32_bf16 v[176:179], v[232:235], v[152:155], v[176:179]
    v_cvt_pk_bf16_f32 v216, v192, v193
    v_cvt_pk_bf16_f32 v217, v194, v195
    v_mfma_f32_16x16x32_bf16 v[180:183], v[232:235], v[156:159], v[180:183]
    v_cvt_pk_bf16_f32 v218, v204, v205
    v_cvt_pk_bf16_f32 v219, v206, v207
    s_waitcnt vmcnt(16)
    s_barrier
    ds_read_b64_tr_b16 v[220:221], v17 offset:32768
    ds_read_b64_tr_b16 v[222:223], v17 offset:40960
    ds_read_b64_tr_b16 v[224:225], v18 offset:32768
    ds_read_b64_tr_b16 v[226:227], v18 offset:40960
    ds_read_b64_tr_b16 v[228:229], v19 offset:32768
    ds_read_b64_tr_b16 v[230:231], v19 offset:40960
    s_waitcnt lgkmcnt(4)
    v_mfma_f32_16x16x32_bf16 a[0:3], v[220:223], v[208:211], a[0:3]
    s_lshl_b32 s40, s34, 13
    v_mfma_f32_16x16x32_bf16 a[4:7], v[220:223], v[212:215], a[4:7]
    s_add_u32 s41, s40, s47
    v_mfma_f32_16x16x32_bf16 a[8:11], v[220:223], v[216:219], a[8:11]
    s_add_u32 s40, s40, 0
    ds_read_b64_tr_b16 v[232:233], v20 offset:32768
    ds_read_b64_tr_b16 v[234:235], v20 offset:40960
    s_waitcnt lgkmcnt(4)
    v_mfma_f32_16x16x32_bf16 a[12:15], v[224:227], v[208:211], a[12:15]
    s_mov_b32 m0, s40
    v_mfma_f32_16x16x32_bf16 a[16:19], v[224:227], v[212:215], a[16:19]
    s_nop 0
    v_mfma_f32_16x16x32_bf16 a[20:23], v[224:227], v[216:219], a[20:23]
    buffer_load_dwordx4 v4, s[12:15], s41 offen offset:0 lds
    ds_read_b64_tr_b16 v[220:221], v21 offset:32768
    ds_read_b64_tr_b16 v[222:223], v21 offset:40960
    s_waitcnt lgkmcnt(4)
    v_mfma_f32_16x16x32_bf16 a[24:27], v[228:231], v[208:211], a[24:27]
    buffer_load_dwordx4 v5, s[12:15], s41 offen offset:1024 lds
    v_mfma_f32_16x16x32_bf16 a[28:31], v[228:231], v[212:215], a[28:31]
    buffer_load_dwordx4 v6, s[12:15], s41 offen offset:2048 lds
    v_mfma_f32_16x16x32_bf16 a[32:35], v[228:231], v[216:219], a[32:35]
    buffer_load_dwordx4 v7, s[12:15], s41 offen offset:3072 lds
    ds_read_b64_tr_b16 v[224:225], v22 offset:32768
    ds_read_b64_tr_b16 v[226:227], v22 offset:40960
    s_waitcnt lgkmcnt(4)
    v_mfma_f32_16x16x32_bf16 a[36:39], v[232:235], v[208:211], a[36:39]
    s_add_u32 s40, s40, 4096
    s_add_u32 s41, s41, 4096
    v_mfma_f32_16x16x32_bf16 a[40:43], v[232:235], v[212:215], a[40:43]
    s_mov_b32 m0, s40
    v_mfma_f32_16x16x32_bf16 a[44:47], v[232:235], v[216:219], a[44:47]
    s_nop 0
    ds_read_b64_tr_b16 v[228:229], v23 offset:32768
    ds_read_b64_tr_b16 v[230:231], v23 offset:40960
    s_waitcnt lgkmcnt(4)
    v_mfma_f32_16x16x32_bf16 a[48:51], v[220:223], v[208:211], a[48:51]
    buffer_load_dwordx4 v4, s[12:15], s41 offen offset:0 lds
    v_mfma_f32_16x16x32_bf16 a[52:55], v[220:223], v[212:215], a[52:55]
    buffer_load_dwordx4 v5, s[12:15], s41 offen offset:1024 lds
    v_mfma_f32_16x16x32_bf16 a[56:59], v[220:223], v[216:219], a[56:59]
    buffer_load_dwordx4 v6, s[12:15], s41 offen offset:2048 lds
    ds_read_b64_tr_b16 v[232:233], v24 offset:32768
    ds_read_b64_tr_b16 v[234:235], v24 offset:40960
    s_waitcnt lgkmcnt(4)
    v_mfma_f32_16x16x32_bf16 a[60:63], v[224:227], v[208:211], a[60:63]
    buffer_load_dwordx4 v7, s[12:15], s41 offen offset:3072 lds
    v_mfma_f32_16x16x32_bf16 a[64:67], v[224:227], v[212:215], a[64:67]
    s_nop 4
    v_mfma_f32_16x16x32_bf16 a[68:71], v[224:227], v[216:219], a[68:71]
    v_max3_f32 v248, v160, v161, v162
    ds_read_b64_tr_b16 v[220:221], v17 offset:33024
    ds_read_b64_tr_b16 v[222:223], v17 offset:41216
    s_waitcnt lgkmcnt(4)
    v_mfma_f32_16x16x32_bf16 a[72:75], v[228:231], v[208:211], a[72:75]
    v_max3_f32 v248, v248, v163, v172
    v_mfma_f32_16x16x32_bf16 a[76:79], v[228:231], v[212:215], a[76:79]
    v_max3_f32 v248, v248, v173, v174
    v_max_f32 v248, v248, v175
    v_mfma_f32_16x16x32_bf16 a[80:83], v[228:231], v[216:219], a[80:83]
    v_max3_f32 v249, v164, v165, v166
    ds_read_b64_tr_b16 v[224:225], v18 offset:33024
    ds_read_b64_tr_b16 v[226:227], v18 offset:41216
    s_waitcnt lgkmcnt(4)
    v_mfma_f32_16x16x32_bf16 a[84:87], v[232:235], v[208:211], a[84:87]
    v_max3_f32 v249, v249, v167, v176
    v_mfma_f32_16x16x32_bf16 a[88:91], v[232:235], v[212:215], a[88:91]
    v_max3_f32 v249, v249, v177, v178
    v_mfma_f32_16x16x32_bf16 a[92:95], v[232:235], v[216:219], a[92:95]
    v_max_f32 v249, v249, v179
    ds_read_b64_tr_b16 v[228:229], v19 offset:33024
    ds_read_b64_tr_b16 v[230:231], v19 offset:41216
    s_waitcnt lgkmcnt(4)
    v_mfma_f32_16x16x32_bf16 a[96:99], v[220:223], v[208:211], a[96:99]
    v_max3_f32 v250, v168, v169, v170
    v_mfma_f32_16x16x32_bf16 a[100:103], v[220:223], v[212:215], a[100:103]
    v_max3_f32 v250, v250, v171, v180
    v_mfma_f32_16x16x32_bf16 a[104:107], v[220:223], v[216:219], a[104:107]
    v_max3_f32 v250, v250, v181, v182
    ds_read_b64_tr_b16 v[232:233], v20 offset:33024
    ds_read_b64_tr_b16 v[234:235], v20 offset:41216
    s_waitcnt lgkmcnt(4)
    v_mfma_f32_16x16x32_bf16 a[108:111], v[224:227], v[208:211], a[108:111]
    v_max_f32 v250, v250, v183
    v_mfma_f32_16x16x32_bf16 a[112:115], v[224:227], v[212:215], a[112:115]
    v_mov_b32 v38, v248
    v_mov_b32 v39, v249
    v_mfma_f32_16x16x32_bf16 a[116:119], v[224:227], v[216:219], a[116:119]
    v_mov_b32 v40, v250
    ds_read_b64_tr_b16 v[220:221], v21 offset:33024
    ds_read_b64_tr_b16 v[222:223], v21 offset:41216
    s_waitcnt lgkmcnt(4)
    v_mfma_f32_16x16x32_bf16 a[120:123], v[228:231], v[208:211], a[120:123]
    s_nop 1
    v_mfma_f32_16x16x32_bf16 a[124:127], v[228:231], v[212:215], a[124:127]
    v_permlane16_swap_b32 v248, v38
    v_mfma_f32_16x16x32_bf16 a[128:131], v[228:231], v[216:219], a[128:131]
    v_permlane16_swap_b32 v249, v39
    ds_read_b64_tr_b16 v[224:225], v22 offset:33024
    ds_read_b64_tr_b16 v[226:227], v22 offset:41216
    s_waitcnt lgkmcnt(4)
    v_mfma_f32_16x16x32_bf16 a[132:135], v[232:235], v[208:211], a[132:135]
    v_permlane16_swap_b32 v250, v40
    v_mfma_f32_16x16x32_bf16 a[136:139], v[232:235], v[212:215], a[136:139]
    v_max_f32 v248, v248, v38
    v_mfma_f32_16x16x32_bf16 a[140:143], v[232:235], v[216:219], a[140:143]
    v_max_f32 v249, v249, v39
    ds_read_b64_tr_b16 v[228:229], v23 offset:33024
    ds_read_b64_tr_b16 v[230:231], v23 offset:41216
    s_waitcnt lgkmcnt(4)
    v_mfma_f32_16x16x32_bf16 a[144:147], v[220:223], v[208:211], a[144:147]
    v_max_f32 v250, v250, v40
    v_mfma_f32_16x16x32_bf16 a[148:151], v[220:223], v[212:215], a[148:151]
    v_mov_b32 v38, v248
    v_mfma_f32_16x16x32_bf16 a[152:155], v[220:223], v[216:219], a[152:155]
    v_mov_b32 v39, v249
    v_mov_b32 v40, v250
    ds_read_b64_tr_b16 v[232:233], v24 offset:33024
    ds_read_b64_tr_b16 v[234:235], v24 offset:41216
    s_waitcnt lgkmcnt(4)
    v_mfma_f32_16x16x32_bf16 a[156:159], v[224:227], v[208:211], a[156:159]
    s_nop 1
    v_mfma_f32_16x16x32_bf16 a[160:163], v[224:227], v[212:215], a[160:163]
    v_permlane32_swap_b32 v248, v38
    v_mfma_f32_16x16x32_bf16 a[164:167], v[224:227], v[216:219], a[164:167]
    v_permlane32_swap_b32 v249, v39
    s_waitcnt lgkmcnt(2)
    v_mfma_f32_16x16x32_bf16 a[168:171], v[228:231], v[208:211], a[168:171]
    v_permlane32_swap_b32 v250, v40
    v_mfma_f32_16x16x32_bf16 a[172:175], v[228:231], v[212:215], a[172:175]
    v_max_f32 v248, v248, v38
    v_mfma_f32_16x16x32_bf16 a[176:179], v[228:231], v[216:219], a[176:179]
    v_max_f32 v249, v249, v39
    s_waitcnt lgkmcnt(0)
    v_mfma_f32_16x16x32_bf16 a[180:183], v[232:235], v[208:211], a[180:183]
    v_max_f32 v250, v250, v40
    v_mfma_f32_16x16x32_bf16 a[184:187], v[232:235], v[212:215], a[184:187]
    v_cmp_gt_f32 s[48:49], v248, v239
    v_mfma_f32_16x16x32_bf16 a[188:191], v[232:235], v[216:219], a[188:191]
    v_cmp_gt_f32 s[50:51], v249, v240
    v_cmp_gt_f32 s[52:53], v250, v241
    s_nop 3
    s_or_b64 s[48:49], s[48:49], s[50:51]
    s_or_b64 s[48:49], s[48:49], s[52:53]
    s_cbranch_scc0 L_norescale2
    v_max_f32 v252, v236, v248
    v_sub_f32 v253, v236, v252
    v_mul_f32 v253, s46, v253
    v_exp_f32 v253, v253
    v_mov_b32 v236, v252
    v_add_f32 v239, 0x42b17218, v252
    v_mul_f32 v242, s46, v252
    v_mul_f32 v245, v245, v253
    v_accvgpr_read_b32 v254, a0
    v_mul_f32 v254, v254, v253
    v_accvgpr_write_b32 a0, v254
    v_accvgpr_read_b32 v254, a1
    v_mul_f32 v254, v254, v253
    v_accvgpr_write_b32 a1, v254
    v_accvgpr_read_b32 v254, a2
    v_mul_f32 v254, v254, v253
    v_accvgpr_write_b32 a2, v254
    v_accvgpr_read_b32 v254, a3
    v_mul_f32 v254, v254, v253
    v_accvgpr_write_b32 a3, v254
    v_accvgpr_read_b32 v254, a12
    v_mul_f32 v254, v254, v253
    v_accvgpr_write_b32 a12, v254
    v_accvgpr_read_b32 v254, a13
    v_mul_f32 v254, v254, v253
    v_accvgpr_write_b32 a13, v254
    v_accvgpr_read_b32 v254, a14
    v_mul_f32 v254, v254, v253
    v_accvgpr_write_b32 a14, v254
    v_accvgpr_read_b32 v254, a15
    v_mul_f32 v254, v254, v253
    v_accvgpr_write_b32 a15, v254
    v_accvgpr_read_b32 v254, a24
    v_mul_f32 v254, v254, v253
    v_accvgpr_write_b32 a24, v254
    v_accvgpr_read_b32 v254, a25
    v_mul_f32 v254, v254, v253
    v_accvgpr_write_b32 a25, v254
    v_accvgpr_read_b32 v254, a26
    v_mul_f32 v254, v254, v253
    v_accvgpr_write_b32 a26, v254
    v_accvgpr_read_b32 v254, a27
    v_mul_f32 v254, v254, v253
    v_accvgpr_write_b32 a27, v254
    v_accvgpr_read_b32 v254, a36
    v_mul_f32 v254, v254, v253
    v_accvgpr_write_b32 a36, v254
    v_accvgpr_read_b32 v254, a37
    v_mul_f32 v254, v254, v253
    v_accvgpr_write_b32 a37, v254
    v_accvgpr_read_b32 v254, a38
    v_mul_f32 v254, v254, v253
    v_accvgpr_write_b32 a38, v254
    v_accvgpr_read_b32 v254, a39
    v_mul_f32 v254, v254, v253
    v_accvgpr_write_b32 a39, v254
    v_accvgpr_read_b32 v254, a48
    v_mul_f32 v254, v254, v253
    v_accvgpr_write_b32 a48, v254
    v_accvgpr_read_b32 v254, a49
    v_mul_f32 v254, v254, v253
    v_accvgpr_write_b32 a49, v254
    v_accvgpr_read_b32 v254, a50
    v_mul_f32 v254, v254, v253
    v_accvgpr_write_b32 a50, v254
    v_accvgpr_read_b32 v254, a51
    v_mul_f32 v254, v254, v253
    v_accvgpr_write_b32 a51, v254
    v_accvgpr_read_b32 v254, a60
    v_mul_f32 v254, v254, v253
    v_accvgpr_write_b32 a60, v254
    v_accvgpr_read_b32 v254, a61
    v_mul_f32 v254, v254, v253
    v_accvgpr_write_b32 a61, v254
    v_accvgpr_read_b32 v254, a62
    v_mul_f32 v254, v254, v253
    v_accvgpr_write_b32 a62, v254
    v_accvgpr_read_b32 v254, a63
    v_mul_f32 v254, v254, v253
    v_accvgpr_write_b32 a63, v254
    v_accvgpr_read_b32 v254, a72
    v_mul_f32 v254, v254, v253
    v_accvgpr_write_b32 a72, v254
    v_accvgpr_read_b32 v254, a73
    v_mul_f32 v254, v254, v253
    v_accvgpr_write_b32 a73, v254
    v_accvgpr_read_b32 v254, a74
    v_mul_f32 v254, v254, v253
    v_accvgpr_write_b32 a74, v254
    v_accvgpr_read_b32 v254, a75
    v_mul_f32 v254, v254, v253
    v_accvgpr_write_b32 a75, v254
    v_accvgpr_read_b32 v254, a84
    v_mul_f32 v254, v254, v253
    v_accvgpr_write_b32 a84, v254
    v_accvgpr_read_b32 v254, a85
    v_mul_f32 v254, v254, v253
    v_accvgpr_write_b32 a85, v254
    v_accvgpr_read_b32 v254, a86
    v_mul_f32 v254, v254, v253
    v_accvgpr_write_b32 a86, v254
    v_accvgpr_read_b32 v254, a87
    v_mul_f32 v254, v254, v253
    v_accvgpr_write_b32 a87, v254
    v_accvgpr_read_b32 v254, a96
    v_mul_f32 v254, v254, v253
    v_accvgpr_write_b32 a96, v254
    v_accvgpr_read_b32 v254, a97
    v_mul_f32 v254, v254, v253
    v_accvgpr_write_b32 a97, v254
    v_accvgpr_read_b32 v254, a98
    v_mul_f32 v254, v254, v253
    v_accvgpr_write_b32 a98, v254
    v_accvgpr_read_b32 v254, a99
    v_mul_f32 v254, v254, v253
    v_accvgpr_write_b32 a99, v254
    v_accvgpr_read_b32 v254, a108
    v_mul_f32 v254, v254, v253
    v_accvgpr_write_b32 a108, v254
    v_accvgpr_read_b32 v254, a109
    v_mul_f32 v254, v254, v253
    v_accvgpr_write_b32 a109, v254
    v_accvgpr_read_b32 v254, a110
    v_mul_f32 v254, v254, v253
    v_accvgpr_write_b32 a110, v254
    v_accvgpr_read_b32 v254, a111
    v_mul_f32 v254, v254, v253
    v_accvgpr_write_b32 a111, v254
    v_accvgpr_read_b32 v254, a120
    v_mul_f32 v254, v254, v253
    v_accvgpr_write_b32 a120, v254
    v_accvgpr_read_b32 v254, a121
    v_mul_f32 v254, v254, v253
    v_accvgpr_write_b32 a121, v254
    v_accvgpr_read_b32 v254, a122
    v_mul_f32 v254, v254, v253
    v_accvgpr_write_b32 a122, v254
    v_accvgpr_read_b32 v254, a123
    v_mul_f32 v254, v254, v253
    v_accvgpr_write_b32 a123, v254
    v_accvgpr_read_b32 v254, a132
    v_mul_f32 v254, v254, v253
    v_accvgpr_write_b32 a132, v254
    v_accvgpr_read_b32 v254, a133
    v_mul_f32 v254, v254, v253
    v_accvgpr_write_b32 a133, v254
    v_accvgpr_read_b32 v254, a134
    v_mul_f32 v254, v254, v253
    v_accvgpr_write_b32 a134, v254
    v_accvgpr_read_b32 v254, a135
    v_mul_f32 v254, v254, v253
    v_accvgpr_write_b32 a135, v254
    v_accvgpr_read_b32 v254, a144
    v_mul_f32 v254, v254, v253
    v_accvgpr_write_b32 a144, v254
    v_accvgpr_read_b32 v254, a145
    v_mul_f32 v254, v254, v253
    v_accvgpr_write_b32 a145, v254
    v_accvgpr_read_b32 v254, a146
    v_mul_f32 v254, v254, v253
    v_accvgpr_write_b32 a146, v254
    v_accvgpr_read_b32 v254, a147
    v_mul_f32 v254, v254, v253
    v_accvgpr_write_b32 a147, v254
    v_accvgpr_read_b32 v254, a156
    v_mul_f32 v254, v254, v253
    v_accvgpr_write_b32 a156, v254
    v_accvgpr_read_b32 v254, a157
    v_mul_f32 v254, v254, v253
    v_accvgpr_write_b32 a157, v254
    v_accvgpr_read_b32 v254, a158
    v_mul_f32 v254, v254, v253
    v_accvgpr_write_b32 a158, v254
    v_accvgpr_read_b32 v254, a159
    v_mul_f32 v254, v254, v253
    v_accvgpr_write_b32 a159, v254
    v_accvgpr_read_b32 v254, a168
    v_mul_f32 v254, v254, v253
    v_accvgpr_write_b32 a168, v254
    v_accvgpr_read_b32 v254, a169
    v_mul_f32 v254, v254, v253
    v_accvgpr_write_b32 a169, v254
    v_accvgpr_read_b32 v254, a170
    v_mul_f32 v254, v254, v253
    v_accvgpr_write_b32 a170, v254
    v_accvgpr_read_b32 v254, a171
    v_mul_f32 v254, v254, v253
    v_accvgpr_write_b32 a171, v254
    v_accvgpr_read_b32 v254, a180
    v_mul_f32 v254, v254, v253
    v_accvgpr_write_b32 a180, v254
    v_accvgpr_read_b32 v254, a181
    v_mul_f32 v254, v254, v253
    v_accvgpr_write_b32 a181, v254
    v_accvgpr_read_b32 v254, a182
    v_mul_f32 v254, v254, v253
    v_accvgpr_write_b32 a182, v254
    v_accvgpr_read_b32 v254, a183
    v_mul_f32 v254, v254, v253
    v_accvgpr_write_b32 a183, v254
    v_max_f32 v252, v237, v249
    v_sub_f32 v253, v237, v252
    v_mul_f32 v253, s46, v253
    v_exp_f32 v253, v253
    v_mov_b32 v237, v252
    v_add_f32 v240, 0x42b17218, v252
    v_mul_f32 v243, s46, v252
    v_mul_f32 v246, v246, v253
    v_accvgpr_read_b32 v254, a4
    v_mul_f32 v254, v254, v253
    v_accvgpr_write_b32 a4, v254
    v_accvgpr_read_b32 v254, a5
    v_mul_f32 v254, v254, v253
    v_accvgpr_write_b32 a5, v254
    v_accvgpr_read_b32 v254, a6
    v_mul_f32 v254, v254, v253
    v_accvgpr_write_b32 a6, v254
    v_accvgpr_read_b32 v254, a7
    v_mul_f32 v254, v254, v253
    v_accvgpr_write_b32 a7, v254
    v_accvgpr_read_b32 v254, a16
    v_mul_f32 v254, v254, v253
    v_accvgpr_write_b32 a16, v254
    v_accvgpr_read_b32 v254, a17
    v_mul_f32 v254, v254, v253
    v_accvgpr_write_b32 a17, v254
    v_accvgpr_read_b32 v254, a18
    v_mul_f32 v254, v254, v253
    v_accvgpr_write_b32 a18, v254
    v_accvgpr_read_b32 v254, a19
    v_mul_f32 v254, v254, v253
    v_accvgpr_write_b32 a19, v254
    v_accvgpr_read_b32 v254, a28
    v_mul_f32 v254, v254, v253
    v_accvgpr_write_b32 a28, v254
    v_accvgpr_read_b32 v254, a29
    v_mul_f32 v254, v254, v253
    v_accvgpr_write_b32 a29, v254
    v_accvgpr_read_b32 v254, a30
    v_mul_f32 v254, v254, v253
    v_accvgpr_write_b32 a30, v254
    v_accvgpr_read_b32 v254, a31
    v_mul_f32 v254, v254, v253
    v_accvgpr_write_b32 a31, v254
    v_accvgpr_read_b32 v254, a40
    v_mul_f32 v254, v254, v253
    v_accvgpr_write_b32 a40, v254
    v_accvgpr_read_b32 v254, a41
    v_mul_f32 v254, v254, v253
    v_accvgpr_write_b32 a41, v254
    v_accvgpr_read_b32 v254, a42
    v_mul_f32 v254, v254, v253
    v_accvgpr_write_b32 a42, v254
    v_accvgpr_read_b32 v254, a43
    v_mul_f32 v254, v254, v253
    v_accvgpr_write_b32 a43, v254
    v_accvgpr_read_b32 v254, a52
    v_mul_f32 v254, v254, v253
    v_accvgpr_write_b32 a52, v254
    v_accvgpr_read_b32 v254, a53
    v_mul_f32 v254, v254, v253
    v_accvgpr_write_b32 a53, v254
    v_accvgpr_read_b32 v254, a54
    v_mul_f32 v254, v254, v253
    v_accvgpr_write_b32 a54, v254
    v_accvgpr_read_b32 v254, a55
    v_mul_f32 v254, v254, v253
    v_accvgpr_write_b32 a55, v254
    v_accvgpr_read_b32 v254, a64
    v_mul_f32 v254, v254, v253
    v_accvgpr_write_b32 a64, v254
    v_accvgpr_read_b32 v254, a65
    v_mul_f32 v254, v254, v253
    v_accvgpr_write_b32 a65, v254
    v_accvgpr_read_b32 v254, a66
    v_mul_f32 v254, v254, v253
    v_accvgpr_write_b32 a66, v254
    v_accvgpr_read_b32 v254, a67
    v_mul_f32 v254, v254, v253
    v_accvgpr_write_b32 a67, v254
    v_accvgpr_read_b32 v254, a76
    v_mul_f32 v254, v254, v253
    v_accvgpr_write_b32 a76, v254
    v_accvgpr_read_b32 v254, a77
    v_mul_f32 v254, v254, v253
    v_accvgpr_write_b32 a77, v254
    v_accvgpr_read_b32 v254, a78
    v_mul_f32 v254, v254, v253
    v_accvgpr_write_b32 a78, v254
    v_accvgpr_read_b32 v254, a79
    v_mul_f32 v254, v254, v253
    v_accvgpr_write_b32 a79, v254
    v_accvgpr_read_b32 v254, a88
    v_mul_f32 v254, v254, v253
    v_accvgpr_write_b32 a88, v254
    v_accvgpr_read_b32 v254, a89
    v_mul_f32 v254, v254, v253
    v_accvgpr_write_b32 a89, v254
    v_accvgpr_read_b32 v254, a90
    v_mul_f32 v254, v254, v253
    v_accvgpr_write_b32 a90, v254
    v_accvgpr_read_b32 v254, a91
    v_mul_f32 v254, v254, v253
    v_accvgpr_write_b32 a91, v254
    v_accvgpr_read_b32 v254, a100
    v_mul_f32 v254, v254, v253
    v_accvgpr_write_b32 a100, v254
    v_accvgpr_read_b32 v254, a101
    v_mul_f32 v254, v254, v253
    v_accvgpr_write_b32 a101, v254
    v_accvgpr_read_b32 v254, a102
    v_mul_f32 v254, v254, v253
    v_accvgpr_write_b32 a102, v254
    v_accvgpr_read_b32 v254, a103
    v_mul_f32 v254, v254, v253
    v_accvgpr_write_b32 a103, v254
    v_accvgpr_read_b32 v254, a112
    v_mul_f32 v254, v254, v253
    v_accvgpr_write_b32 a112, v254
    v_accvgpr_read_b32 v254, a113
    v_mul_f32 v254, v254, v253
    v_accvgpr_write_b32 a113, v254
    v_accvgpr_read_b32 v254, a114
    v_mul_f32 v254, v254, v253
    v_accvgpr_write_b32 a114, v254
    v_accvgpr_read_b32 v254, a115
    v_mul_f32 v254, v254, v253
    v_accvgpr_write_b32 a115, v254
    v_accvgpr_read_b32 v254, a124
    v_mul_f32 v254, v254, v253
    v_accvgpr_write_b32 a124, v254
    v_accvgpr_read_b32 v254, a125
    v_mul_f32 v254, v254, v253
    v_accvgpr_write_b32 a125, v254
    v_accvgpr_read_b32 v254, a126
    v_mul_f32 v254, v254, v253
    v_accvgpr_write_b32 a126, v254
    v_accvgpr_read_b32 v254, a127
    v_mul_f32 v254, v254, v253
    v_accvgpr_write_b32 a127, v254
    v_accvgpr_read_b32 v254, a136
    v_mul_f32 v254, v254, v253
    v_accvgpr_write_b32 a136, v254
    v_accvgpr_read_b32 v254, a137
    v_mul_f32 v254, v254, v253
    v_accvgpr_write_b32 a137, v254
    v_accvgpr_read_b32 v254, a138
    v_mul_f32 v254, v254, v253
    v_accvgpr_write_b32 a138, v254
    v_accvgpr_read_b32 v254, a139
    v_mul_f32 v254, v254, v253
    v_accvgpr_write_b32 a139, v254
    v_accvgpr_read_b32 v254, a148
    v_mul_f32 v254, v254, v253
    v_accvgpr_write_b32 a148, v254
    v_accvgpr_read_b32 v254, a149
    v_mul_f32 v254, v254, v253
    v_accvgpr_write_b32 a149, v254
    v_accvgpr_read_b32 v254, a150
    v_mul_f32 v254, v254, v253
    v_accvgpr_write_b32 a150, v254
    v_accvgpr_read_b32 v254, a151
    v_mul_f32 v254, v254, v253
    v_accvgpr_write_b32 a151, v254
    v_accvgpr_read_b32 v254, a160
    v_mul_f32 v254, v254, v253
    v_accvgpr_write_b32 a160, v254
    v_accvgpr_read_b32 v254, a161
    v_mul_f32 v254, v254, v253
    v_accvgpr_write_b32 a161, v254
    v_accvgpr_read_b32 v254, a162
    v_mul_f32 v254, v254, v253
    v_accvgpr_write_b32 a162, v254
    v_accvgpr_read_b32 v254, a163
    v_mul_f32 v254, v254, v253
    v_accvgpr_write_b32 a163, v254
    v_accvgpr_read_b32 v254, a172
    v_mul_f32 v254, v254, v253
    v_accvgpr_write_b32 a172, v254
    v_accvgpr_read_b32 v254, a173
    v_mul_f32 v254, v254, v253
    v_accvgpr_write_b32 a173, v254
    v_accvgpr_read_b32 v254, a174
    v_mul_f32 v254, v254, v253
    v_accvgpr_write_b32 a174, v254
    v_accvgpr_read_b32 v254, a175
    v_mul_f32 v254, v254, v253
    v_accvgpr_write_b32 a175, v254
    v_accvgpr_read_b32 v254, a184
    v_mul_f32 v254, v254, v253
    v_accvgpr_write_b32 a184, v254
    v_accvgpr_read_b32 v254, a185
    v_mul_f32 v254, v254, v253
    v_accvgpr_write_b32 a185, v254
    v_accvgpr_read_b32 v254, a186
    v_mul_f32 v254, v254, v253
    v_accvgpr_write_b32 a186, v254
    v_accvgpr_read_b32 v254, a187
    v_mul_f32 v254, v254, v253
    v_accvgpr_write_b32 a187, v254
    v_max_f32 v252, v238, v250
    v_sub_f32 v253, v238, v252
    v_mul_f32 v253, s46, v253
    v_exp_f32 v253, v253
    v_mov_b32 v238, v252
    v_add_f32 v241, 0x42b17218, v252
    v_mul_f32 v244, s46, v252
    v_mul_f32 v247, v247, v253
    v_accvgpr_read_b32 v254, a8
    v_mul_f32 v254, v254, v253
    v_accvgpr_write_b32 a8, v254
    v_accvgpr_read_b32 v254, a9
    v_mul_f32 v254, v254, v253
    v_accvgpr_write_b32 a9, v254
    v_accvgpr_read_b32 v254, a10
    v_mul_f32 v254, v254, v253
    v_accvgpr_write_b32 a10, v254
    v_accvgpr_read_b32 v254, a11
    v_mul_f32 v254, v254, v253
    v_accvgpr_write_b32 a11, v254
    v_accvgpr_read_b32 v254, a20
    v_mul_f32 v254, v254, v253
    v_accvgpr_write_b32 a20, v254
    v_accvgpr_read_b32 v254, a21
    v_mul_f32 v254, v254, v253
    v_accvgpr_write_b32 a21, v254
    v_accvgpr_read_b32 v254, a22
    v_mul_f32 v254, v254, v253
    v_accvgpr_write_b32 a22, v254
    v_accvgpr_read_b32 v254, a23
    v_mul_f32 v254, v254, v253
    v_accvgpr_write_b32 a23, v254
    v_accvgpr_read_b32 v254, a32
    v_mul_f32 v254, v254, v253
    v_accvgpr_write_b32 a32, v254
    v_accvgpr_read_b32 v254, a33
    v_mul_f32 v254, v254, v253
    v_accvgpr_write_b32 a33, v254
    v_accvgpr_read_b32 v254, a34
    v_mul_f32 v254, v254, v253
    v_accvgpr_write_b32 a34, v254
    v_accvgpr_read_b32 v254, a35
    v_mul_f32 v254, v254, v253
    v_accvgpr_write_b32 a35, v254
    v_accvgpr_read_b32 v254, a44
    v_mul_f32 v254, v254, v253
    v_accvgpr_write_b32 a44, v254
    v_accvgpr_read_b32 v254, a45
    v_mul_f32 v254, v254, v253
    v_accvgpr_write_b32 a45, v254
    v_accvgpr_read_b32 v254, a46
    v_mul_f32 v254, v254, v253
    v_accvgpr_write_b32 a46, v254
    v_accvgpr_read_b32 v254, a47
    v_mul_f32 v254, v254, v253
    v_accvgpr_write_b32 a47, v254
    v_accvgpr_read_b32 v254, a56
    v_mul_f32 v254, v254, v253
    v_accvgpr_write_b32 a56, v254
    v_accvgpr_read_b32 v254, a57
    v_mul_f32 v254, v254, v253
    v_accvgpr_write_b32 a57, v254
    v_accvgpr_read_b32 v254, a58
    v_mul_f32 v254, v254, v253
    v_accvgpr_write_b32 a58, v254
    v_accvgpr_read_b32 v254, a59
    v_mul_f32 v254, v254, v253
    v_accvgpr_write_b32 a59, v254
    v_accvgpr_read_b32 v254, a68
    v_mul_f32 v254, v254, v253
    v_accvgpr_write_b32 a68, v254
    v_accvgpr_read_b32 v254, a69
    v_mul_f32 v254, v254, v253
    v_accvgpr_write_b32 a69, v254
    v_accvgpr_read_b32 v254, a70
    v_mul_f32 v254, v254, v253
    v_accvgpr_write_b32 a70, v254
    v_accvgpr_read_b32 v254, a71
    v_mul_f32 v254, v254, v253
    v_accvgpr_write_b32 a71, v254
    v_accvgpr_read_b32 v254, a80
    v_mul_f32 v254, v254, v253
    v_accvgpr_write_b32 a80, v254
    v_accvgpr_read_b32 v254, a81
    v_mul_f32 v254, v254, v253
    v_accvgpr_write_b32 a81, v254
    v_accvgpr_read_b32 v254, a82
    v_mul_f32 v254, v254, v253
    v_accvgpr_write_b32 a82, v254
    v_accvgpr_read_b32 v254, a83
    v_mul_f32 v254, v254, v253
    v_accvgpr_write_b32 a83, v254
    v_accvgpr_read_b32 v254, a92
    v_mul_f32 v254, v254, v253
    v_accvgpr_write_b32 a92, v254
    v_accvgpr_read_b32 v254, a93
    v_mul_f32 v254, v254, v253
    v_accvgpr_write_b32 a93, v254
    v_accvgpr_read_b32 v254, a94
    v_mul_f32 v254, v254, v253
    v_accvgpr_write_b32 a94, v254
    v_accvgpr_read_b32 v254, a95
    v_mul_f32 v254, v254, v253
    v_accvgpr_write_b32 a95, v254
    v_accvgpr_read_b32 v254, a104
    v_mul_f32 v254, v254, v253
    v_accvgpr_write_b32 a104, v254
    v_accvgpr_read_b32 v254, a105
    v_mul_f32 v254, v254, v253
    v_accvgpr_write_b32 a105, v254
    v_accvgpr_read_b32 v254, a106
    v_mul_f32 v254, v254, v253
    v_accvgpr_write_b32 a106, v254
    v_accvgpr_read_b32 v254, a107
    v_mul_f32 v254, v254, v253
    v_accvgpr_write_b32 a107, v254
    v_accvgpr_read_b32 v254, a116
    v_mul_f32 v254, v254, v253
    v_accvgpr_write_b32 a116, v254
    v_accvgpr_read_b32 v254, a117
    v_mul_f32 v254, v254, v253
    v_accvgpr_write_b32 a117, v254
    v_accvgpr_read_b32 v254, a118
    v_mul_f32 v254, v254, v253
    v_accvgpr_write_b32 a118, v254
    v_accvgpr_read_b32 v254, a119
    v_mul_f32 v254, v254, v253
    v_accvgpr_write_b32 a119, v254
    v_accvgpr_read_b32 v254, a128
    v_mul_f32 v254, v254, v253
    v_accvgpr_write_b32 a128, v254
    v_accvgpr_read_b32 v254, a129
    v_mul_f32 v254, v254, v253
    v_accvgpr_write_b32 a129, v254
    v_accvgpr_read_b32 v254, a130
    v_mul_f32 v254, v254, v253
    v_accvgpr_write_b32 a130, v254
    v_accvgpr_read_b32 v254, a131
    v_mul_f32 v254, v254, v253
    v_accvgpr_write_b32 a131, v254
    v_accvgpr_read_b32 v254, a140
    v_mul_f32 v254, v254, v253
    v_accvgpr_write_b32 a140, v254
    v_accvgpr_read_b32 v254, a141
    v_mul_f32 v254, v254, v253
    v_accvgpr_write_b32 a141, v254
    v_accvgpr_read_b32 v254, a142
    v_mul_f32 v254, v254, v253
    v_accvgpr_write_b32 a142, v254
    v_accvgpr_read_b32 v254, a143
    v_mul_f32 v254, v254, v253
    v_accvgpr_write_b32 a143, v254
    v_accvgpr_read_b32 v254, a152
    v_mul_f32 v254, v254, v253
    v_accvgpr_write_b32 a152, v254
    v_accvgpr_read_b32 v254, a153
    v_mul_f32 v254, v254, v253
    v_accvgpr_write_b32 a153, v254
    v_accvgpr_read_b32 v254, a154
    v_mul_f32 v254, v254, v253
    v_accvgpr_write_b32 a154, v254
    v_accvgpr_read_b32 v254, a155
    v_mul_f32 v254, v254, v253
    v_accvgpr_write_b32 a155, v254
    v_accvgpr_read_b32 v254, a164
    v_mul_f32 v254, v254, v253
    v_accvgpr_write_b32 a164, v254
    v_accvgpr_read_b32 v254, a165
    v_mul_f32 v254, v254, v253
    v_accvgpr_write_b32 a165, v254
    v_accvgpr_read_b32 v254, a166
    v_mul_f32 v254, v254, v253
    v_accvgpr_write_b32 a166, v254
    v_accvgpr_read_b32 v254, a167
    v_mul_f32 v254, v254, v253
    v_accvgpr_write_b32 a167, v254
    v_accvgpr_read_b32 v254, a176
    v_mul_f32 v254, v254, v253
    v_accvgpr_write_b32 a176, v254
    v_accvgpr_read_b32 v254, a177
    v_mul_f32 v254, v254, v253
    v_accvgpr_write_b32 a177, v254
    v_accvgpr_read_b32 v254, a178
    v_mul_f32 v254, v254, v253
    v_accvgpr_write_b32 a178, v254
    v_accvgpr_read_b32 v254, a179
    v_mul_f32 v254, v254, v253
    v_accvgpr_write_b32 a179, v254
    v_accvgpr_read_b32 v254, a188
    v_mul_f32 v254, v254, v253
    v_accvgpr_write_b32 a188, v254
    v_accvgpr_read_b32 v254, a189
    v_mul_f32 v254, v254, v253
    v_accvgpr_write_b32 a189, v254
    v_accvgpr_read_b32 v254, a190
    v_mul_f32 v254, v254, v253
    v_accvgpr_write_b32 a190, v254
    v_accvgpr_read_b32 v254, a191
    v_mul_f32 v254, v254, v253
    v_accvgpr_write_b32 a191, v254
L_norescale2:
    s_waitcnt vmcnt(16)
    s_barrier
    s_lshl_b32 s40, s34, 13
    s_add_u32 s41, s40, s45
    s_add_u32 s40, s40, 98304
    s_mov_b32 m0, s40
    s_nop 0
    buffer_load_dwordx4 v4, s[16:19], s41 offen offset:0 lds
    buffer_load_dwordx4 v5, s[16:19], s41 offen offset:1024 lds
    buffer_load_dwordx4 v6, s[16:19], s41 offen offset:2048 lds
    buffer_load_dwordx4 v7, s[16:19], s41 offen offset:3072 lds
    s_add_u32 s40, s40, 4096
    s_add_u32 s41, s41, 4096
    s_mov_b32 m0, s40
    s_nop 0
    buffer_load_dwordx4 v4, s[16:19], s41 offen offset:0 lds
    buffer_load_dwordx4 v5, s[16:19], s41 offen offset:1024 lds
    buffer_load_dwordx4 v6, s[16:19], s41 offen offset:2048 lds
    buffer_load_dwordx4 v7, s[16:19], s41 offen offset:3072 lds
    s_add_u32 s45, s45, 32768
    s_add_u32 s47, s45, 32768
    s_add_u32 s44, s44, 1
    s_cmp_lt_u32 s44, 7
    s_cbranch_scc1 L_loop
    ds_read_b128 v[220:223], v13 offset:32768
    ds_read_b128 v[224:227], v13 offset:40960
    ds_read_b128 v[228:231], v14 offset:32768
    ds_read_b128 v[232:235], v14 offset:40960
    s_waitcnt lgkmcnt(2)
    v_mfma_f32_16x16x32_bf16 v[184:187], v[220:223], v[64:67], 0
    v_fma_f32 v160, v160, s46, -v242
    v_mfma_f32_16x16x32_bf16 v[188:191], v[220:223], v[68:71], 0
    v_exp_f32 v160, v160
    v_fma_f32 v161, v161, s46, -v242
    v_mfma_f32_16x16x32_bf16 v[192:195], v[220:223], v[72:75], 0
    v_exp_f32 v161, v161
    v_fma_f32 v162, v162, s46, -v242
    v_mfma_f32_16x16x32_bf16 v[196:199], v[224:227], v[64:67], 0
    v_exp_f32 v162, v162
    v_fma_f32 v163, v163, s46, -v242
    v_mfma_f32_16x16x32_bf16 v[200:203], v[224:227], v[68:71], 0
    v_exp_f32 v163, v163
    v_mfma_f32_16x16x32_bf16 v[204:207], v[224:227], v[72:75], 0
    v_fma_f32 v172, v172, s46, -v242
    v_exp_f32 v172, v172
    ds_read_b128 v[220:223], v15 offset:32768
    ds_read_b128 v[224:227], v15 offset:40960
    s_waitcnt lgkmcnt(2)
    v_mfma_f32_16x16x32_bf16 v[184:187], v[228:231], v[76:79], v[184:187]
    v_fma_f32 v173, v173, s46, -v242
    v_exp_f32 v173, v173
    v_mfma_f32_16x16x32_bf16 v[188:191], v[228:231], v[80:83], v[188:191]
    v_fma_f32 v174, v174, s46, -v242
    v_exp_f32 v174, v174
    v_mfma_f32_16x16x32_bf16 v[192:195], v[228:231], v[84:87], v[192:195]
    v_fma_f32 v175, v175, s46, -v242
    v_mfma_f32_16x16x32_bf16 v[196:199], v[232:235], v[76:79], v[196:199]
    v_exp_f32 v175, v175
    v_add_f32 v38, v160, v161
    v_mfma_f32_16x16x32_bf16 v[200:203], v[232:235], v[80:83], v[200:203]
    v_add_f32 v39, v162, v163
    v_add_f32 v40, v172, v173
    v_mfma_f32_16x16x32_bf16 v[204:207], v[232:235], v[84:87], v[204:207]
    v_add_f32 v41, v174, v175
    v_add_f32 v38, v38, v39
    ds_read_b128 v[228:231], v16 offset:32768
    ds_read_b128 v[232:235], v16 offset:40960
    s_waitcnt lgkmcnt(2)
    v_mfma_f32_16x16x32_bf16 v[184:187], v[220:223], v[88:91], v[184:187]
    v_add_f32 v40, v40, v41
    v_mfma_f32_16x16x32_bf16 v[188:191], v[220:223], v[92:95], v[188:191]
    v_add_f32 v245, v245, v38
    v_add_f32 v245, v245, v40
    v_mfma_f32_16x16x32_bf16 v[192:195], v[220:223], v[96:99], v[192:195]
    v_cvt_pk_bf16_f32 v208, v160, v161
    v_cvt_pk_bf16_f32 v209, v162, v163
    v_mfma_f32_16x16x32_bf16 v[196:199], v[224:227], v[88:91], v[196:199]
    v_cvt_pk_bf16_f32 v210, v172, v173
    v_cvt_pk_bf16_f32 v211, v174, v175
    v_mfma_f32_16x16x32_bf16 v[200:203], v[224:227], v[92:95], v[200:203]
    v_fma_f32 v164, v164, s46, -v243
    v_mfma_f32_16x16x32_bf16 v[204:207], v[224:227], v[96:99], v[204:207]
    v_exp_f32 v164, v164
    v_fma_f32 v165, v165, s46, -v243
    ds_read_b128 v[220:223], v13 offset:33024
    ds_read_b128 v[224:227], v13 offset:41216
    s_waitcnt lgkmcnt(2)
    v_mfma_f32_16x16x32_bf16 v[184:187], v[228:231], v[100:103], v[184:187]
    v_exp_f32 v165, v165
    v_fma_f32 v166, v166, s46, -v243
    v_mfma_f32_16x16x32_bf16 v[188:191], v[228:231], v[104:107], v[188:191]
    v_exp_f32 v166, v166
    v_fma_f32 v167, v167, s46, -v243
    v_mfma_f32_16x16x32_bf16 v[192:195], v[228:231], v[108:111], v[192:195]
    v_exp_f32 v167, v167
    v_mfma_f32_16x16x32_bf16 v[196:199], v[232:235], v[100:103], v[196:199]
    v_fma_f32 v176, v176, s46, -v243
    v_exp_f32 v176, v176
    v_mfma_f32_16x16x32_bf16 v[200:203], v[232:235], v[104:107], v[200:203]
    v_fma_f32 v177, v177, s46, -v243
    v_exp_f32 v177, v177
    v_mfma_f32_16x16x32_bf16 v[204:207], v[232:235], v[108:111], v[204:207]
    v_fma_f32 v178, v178, s46, -v243
    v_exp_f32 v178, v178
    ds_read_b128 v[228:231], v14 offset:33024
    ds_read_b128 v[232:235], v14 offset:41216
    s_waitcnt lgkmcnt(2)
    v_mfma_f32_16x16x32_bf16 v[184:187], v[220:223], v[112:115], v[184:187]
    v_fma_f32 v179, v179, s46, -v243
    v_mfma_f32_16x16x32_bf16 v[188:191], v[220:223], v[116:119], v[188:191]
    v_exp_f32 v179, v179
    v_add_f32 v42, v164, v165
    v_mfma_f32_16x16x32_bf16 v[192:195], v[220:223], v[120:123], v[192:195]
    v_add_f32 v43, v166, v167
    v_add_f32 v44, v176, v177
    v_mfma_f32_16x16x32_bf16 v[196:199], v[224:227], v[112:115], v[196:199]
    v_add_f32 v45, v178, v179
    v_add_f32 v42, v42, v43
    v_mfma_f32_16x16x32_bf16 v[200:203], v[224:227], v[116:119], v[200:203]
    v_add_f32 v44, v44, v45
    v_mfma_f32_16x16x32_bf16 v[204:207], v[224:227], v[120:123], v[204:207]
    v_add_f32 v246, v246, v42
    v_add_f32 v246, v246, v44
    ds_read_b128 v[220:223], v15 offset:33024
    ds_read_b128 v[224:227], v15 offset:41216
    s_waitcnt lgkmcnt(2)
    v_mfma_f32_16x16x32_bf16 v[184:187], v[228:231], v[124:127], v[184:187]
    v_cvt_pk_bf16_f32 v212, v164, v165
    v_cvt_pk_bf16_f32 v213, v166, v167
    v_mfma_f32_16x16x32_bf16 v[188:191], v[228:231], v[128:131], v[188:191]
    v_cvt_pk_bf16_f32 v214, v176, v177
    v_cvt_pk_bf16_f32 v215, v178, v179
    v_mfma_f32_16x16x32_bf16 v[192:195], v[228:231], v[132:135], v[192:195]
    v_fma_f32 v168, v168, s46, -v244
    v_mfma_f32_16x16x32_bf16 v[196:199], v[232:235], v[124:127], v[196:199]
    v_exp_f32 v168, v168
    v_fma_f32 v169, v169, s46, -v244
    v_mfma_f32_16x16x32_bf16 v[200:203], v[232:235], v[128:131], v[200:203]
    v_exp_f32 v169, v169
    v_fma_f32 v170, v170, s46, -v244
    v_mfma_f32_16x16x32_bf16 v[204:207], v[232:235], v[132:135], v[204:207]
    v_exp_f32 v170, v170
    v_fma_f32 v171, v171, s46, -v244
    ds_read_b128 v[228:231], v16 offset:33024
    ds_read_b128 v[232:235], v16 offset:41216
    s_waitcnt lgkmcnt(2)
    v_mfma_f32_16x16x32_bf16 v[184:187], v[220:223], v[136:139], v[184:187]
    v_exp_f32 v171, v171
    v_mfma_f32_16x16x32_bf16 v[188:191], v[220:223], v[140:143], v[188:191]
    v_fma_f32 v180, v180, s46, -v244
    v_exp_f32 v180, v180
    v_mfma_f32_16x16x32_bf16 v[192:195], v[220:223], v[144:147], v[192:195]
    v_fma_f32 v181, v181, s46, -v244
    v_exp_f32 v181, v181
    v_mfma_f32_16x16x32_bf16 v[196:199], v[224:227], v[136:139], v[196:199]
    v_fma_f32 v182, v182, s46, -v244
    v_exp_f32 v182, v182
    v_mfma_f32_16x16x32_bf16 v[200:203], v[224:227], v[140:143], v[200:203]
    v_fma_f32 v183, v183, s46, -v244
    v_mfma_f32_16x16x32_bf16 v[204:207], v[224:227], v[144:147], v[204:207]
    v_exp_f32 v183, v183
    v_add_f32 v46, v168, v169
    s_waitcnt lgkmcnt(0)
    v_mfma_f32_16x16x32_bf16 v[184:187], v[228:231], v[148:151], v[184:187]
    v_add_f32 v47, v170, v171
    v_add_f32 v48, v180, v181
    v_mfma_f32_16x16x32_bf16 v[188:191], v[228:231], v[152:155], v[188:191]
    v_add_f32 v49, v182, v183
    v_add_f32 v46, v46, v47
    v_mfma_f32_16x16x32_bf16 v[192:195], v[228:231], v[156:159], v[192:195]
    v_add_f32 v48, v48, v49
    v_mfma_f32_16x16x32_bf16 v[196:199], v[232:235], v[148:151], v[196:199]
    v_add_f32 v247, v247, v46
    v_add_f32 v247, v247, v48
    v_mfma_f32_16x16x32_bf16 v[200:203], v[232:235], v[152:155], v[200:203]
    v_cvt_pk_bf16_f32 v216, v168, v169
    v_cvt_pk_bf16_f32 v217, v170, v171
    v_mfma_f32_16x16x32_bf16 v[204:207], v[232:235], v[156:159], v[204:207]
    v_cvt_pk_bf16_f32 v218, v180, v181
    v_cvt_pk_bf16_f32 v219, v182, v183
    s_waitcnt vmcnt(16)
    s_barrier
    ds_read_b64_tr_b16 v[220:221], v17 offset:0
    ds_read_b64_tr_b16 v[222:223], v17 offset:8192
    ds_read_b64_tr_b16 v[224:225], v18 offset:0
    ds_read_b64_tr_b16 v[226:227], v18 offset:8192
    ds_read_b64_tr_b16 v[228:229], v19 offset:0
    ds_read_b64_tr_b16 v[230:231], v19 offset:8192
    s_waitcnt lgkmcnt(4)
    v_mfma_f32_16x16x32_bf16 a[0:3], v[220:223], v[208:211], a[0:3]
    s_lshl_b32 s40, s34, 13
    v_mfma_f32_16x16x32_bf16 a[4:7], v[220:223], v[212:215], a[4:7]
    s_add_u32 s41, s40, s47
    v_mfma_f32_16x16x32_bf16 a[8:11], v[220:223], v[216:219], a[8:11]
    s_add_u32 s40, s40, 32768
    ds_read_b64_tr_b16 v[232:233], v20 offset:0
    ds_read_b64_tr_b16 v[234:235], v20 offset:8192
    s_waitcnt lgkmcnt(4)
    v_mfma_f32_16x16x32_bf16 a[12:15], v[224:227], v[208:211], a[12:15]
    s_mov_b32 m0, s40
    v_mfma_f32_16x16x32_bf16 a[16:19], v[224:227], v[212:215], a[16:19]
    s_nop 0
    v_mfma_f32_16x16x32_bf16 a[20:23], v[224:227], v[216:219], a[20:23]
    buffer_load_dwordx4 v4, s[12:15], s41 offen offset:0 lds
    ds_read_b64_tr_b16 v[220:221], v21 offset:0
    ds_read_b64_tr_b16 v[222:223], v21 offset:8192
    s_waitcnt lgkmcnt(4)
    v_mfma_f32_16x16x32_bf16 a[24:27], v[228:231], v[208:211], a[24:27]
    buffer_load_dwordx4 v5, s[12:15], s41 offen offset:1024 lds
    v_mfma_f32_16x16x32_bf16 a[28:31], v[228:231], v[212:215], a[28:31]
    buffer_load_dwordx4 v6, s[12:15], s41 offen offset:2048 lds
    v_mfma_f32_16x16x32_bf16 a[32:35], v[228:231], v[216:219], a[32:35]
    buffer_load_dwordx4 v7, s[12:15], s41 offen offset:3072 lds
    ds_read_b64_tr_b16 v[224:225], v22 offset:0
    ds_read_b64_tr_b16 v[226:227], v22 offset:8192
    s_waitcnt lgkmcnt(4)
    v_mfma_f32_16x16x32_bf16 a[36:39], v[232:235], v[208:211], a[36:39]
    s_add_u32 s40, s40, 4096
    s_add_u32 s41, s41, 4096
    v_mfma_f32_16x16x32_bf16 a[40:43], v[232:235], v[212:215], a[40:43]
    s_mov_b32 m0, s40
    v_mfma_f32_16x16x32_bf16 a[44:47], v[232:235], v[216:219], a[44:47]
    s_nop 0
    ds_read_b64_tr_b16 v[228:229], v23 offset:0
    ds_read_b64_tr_b16 v[230:231], v23 offset:8192
    s_waitcnt lgkmcnt(4)
    v_mfma_f32_16x16x32_bf16 a[48:51], v[220:223], v[208:211], a[48:51]
    buffer_load_dwordx4 v4, s[12:15], s41 offen offset:0 lds
    v_mfma_f32_16x16x32_bf16 a[52:55], v[220:223], v[212:215], a[52:55]
    buffer_load_dwordx4 v5, s[12:15], s41 offen offset:1024 lds
    v_mfma_f32_16x16x32_bf16 a[56:59], v[220:223], v[216:219], a[56:59]
    buffer_load_dwordx4 v6, s[12:15], s41 offen offset:2048 lds
    ds_read_b64_tr_b16 v[232:233], v24 offset:0
    ds_read_b64_tr_b16 v[234:235], v24 offset:8192
    s_waitcnt lgkmcnt(4)
    v_mfma_f32_16x16x32_bf16 a[60:63], v[224:227], v[208:211], a[60:63]
    buffer_load_dwordx4 v7, s[12:15], s41 offen offset:3072 lds
    v_mfma_f32_16x16x32_bf16 a[64:67], v[224:227], v[212:215], a[64:67]
    s_nop 4
    v_mfma_f32_16x16x32_bf16 a[68:71], v[224:227], v[216:219], a[68:71]
    v_max3_f32 v248, v184, v185, v186
    ds_read_b64_tr_b16 v[220:221], v17 offset:256
    ds_read_b64_tr_b16 v[222:223], v17 offset:8448
    s_waitcnt lgkmcnt(4)
    v_mfma_f32_16x16x32_bf16 a[72:75], v[228:231], v[208:211], a[72:75]
    v_max3_f32 v248, v248, v187, v196
    v_mfma_f32_16x16x32_bf16 a[76:79], v[228:231], v[212:215], a[76:79]
    v_max3_f32 v248, v248, v197, v198
    v_max_f32 v248, v248, v199
    v_mfma_f32_16x16x32_bf16 a[80:83], v[228:231], v[216:219], a[80:83]
    v_max3_f32 v249, v188, v189, v190
    ds_read_b64_tr_b16 v[224:225], v18 offset:256
    ds_read_b64_tr_b16 v[226:227], v18 offset:8448
    s_waitcnt lgkmcnt(4)
    v_mfma_f32_16x16x32_bf16 a[84:87], v[232:235], v[208:211], a[84:87]
    v_max3_f32 v249, v249, v191, v200
    v_mfma_f32_16x16x32_bf16 a[88:91], v[232:235], v[212:215], a[88:91]
    v_max3_f32 v249, v249, v201, v202
    v_mfma_f32_16x16x32_bf16 a[92:95], v[232:235], v[216:219], a[92:95]
    v_max_f32 v249, v249, v203
    ds_read_b64_tr_b16 v[228:229], v19 offset:256
    ds_read_b64_tr_b16 v[230:231], v19 offset:8448
    s_waitcnt lgkmcnt(4)
    v_mfma_f32_16x16x32_bf16 a[96:99], v[220:223], v[208:211], a[96:99]
    v_max3_f32 v250, v192, v193, v194
    v_mfma_f32_16x16x32_bf16 a[100:103], v[220:223], v[212:215], a[100:103]
    v_max3_f32 v250, v250, v195, v204
    v_mfma_f32_16x16x32_bf16 a[104:107], v[220:223], v[216:219], a[104:107]
    v_max3_f32 v250, v250, v205, v206
    ds_read_b64_tr_b16 v[232:233], v20 offset:256
    ds_read_b64_tr_b16 v[234:235], v20 offset:8448
    s_waitcnt lgkmcnt(4)
    v_mfma_f32_16x16x32_bf16 a[108:111], v[224:227], v[208:211], a[108:111]
    v_max_f32 v250, v250, v207
    v_mfma_f32_16x16x32_bf16 a[112:115], v[224:227], v[212:215], a[112:115]
    v_mov_b32 v38, v248
    v_mov_b32 v39, v249
    v_mfma_f32_16x16x32_bf16 a[116:119], v[224:227], v[216:219], a[116:119]
    v_mov_b32 v40, v250
    ds_read_b64_tr_b16 v[220:221], v21 offset:256
    ds_read_b64_tr_b16 v[222:223], v21 offset:8448
    s_waitcnt lgkmcnt(4)
    v_mfma_f32_16x16x32_bf16 a[120:123], v[228:231], v[208:211], a[120:123]
    s_nop 1
    v_mfma_f32_16x16x32_bf16 a[124:127], v[228:231], v[212:215], a[124:127]
    v_permlane16_swap_b32 v248, v38
    v_mfma_f32_16x16x32_bf16 a[128:131], v[228:231], v[216:219], a[128:131]
    v_permlane16_swap_b32 v249, v39
    ds_read_b64_tr_b16 v[224:225], v22 offset:256
    ds_read_b64_tr_b16 v[226:227], v22 offset:8448
    s_waitcnt lgkmcnt(4)
    v_mfma_f32_16x16x32_bf16 a[132:135], v[232:235], v[208:211], a[132:135]
    v_permlane16_swap_b32 v250, v40
    v_mfma_f32_16x16x32_bf16 a[136:139], v[232:235], v[212:215], a[136:139]
    v_max_f32 v248, v248, v38
    v_mfma_f32_16x16x32_bf16 a[140:143], v[232:235], v[216:219], a[140:143]
    v_max_f32 v249, v249, v39
    ds_read_b64_tr_b16 v[228:229], v23 offset:256
    ds_read_b64_tr_b16 v[230:231], v23 offset:8448
    s_waitcnt lgkmcnt(4)
    v_mfma_f32_16x16x32_bf16 a[144:147], v[220:223], v[208:211], a[144:147]
    v_max_f32 v250, v250, v40
    v_mfma_f32_16x16x32_bf16 a[148:151], v[220:223], v[212:215], a[148:151]
    v_mov_b32 v38, v248
    v_mfma_f32_16x16x32_bf16 a[152:155], v[220:223], v[216:219], a[152:155]
    v_mov_b32 v39, v249
    v_mov_b32 v40, v250
    ds_read_b64_tr_b16 v[232:233], v24 offset:256
    ds_read_b64_tr_b16 v[234:235], v24 offset:8448
    s_waitcnt lgkmcnt(4)
    v_mfma_f32_16x16x32_bf16 a[156:159], v[224:227], v[208:211], a[156:159]
    s_nop 1
    v_mfma_f32_16x16x32_bf16 a[160:163], v[224:227], v[212:215], a[160:163]
    v_permlane32_swap_b32 v248, v38
    v_mfma_f32_16x16x32_bf16 a[164:167], v[224:227], v[216:219], a[164:167]
    v_permlane32_swap_b32 v249, v39
    s_waitcnt lgkmcnt(2)
    v_mfma_f32_16x16x32_bf16 a[168:171], v[228:231], v[208:211], a[168:171]
    v_permlane32_swap_b32 v250, v40
    v_mfma_f32_16x16x32_bf16 a[172:175], v[228:231], v[212:215], a[172:175]
    v_max_f32 v248, v248, v38
    v_mfma_f32_16x16x32_bf16 a[176:179], v[228:231], v[216:219], a[176:179]
    v_max_f32 v249, v249, v39
    s_waitcnt lgkmcnt(0)
    v_mfma_f32_16x16x32_bf16 a[180:183], v[232:235], v[208:211], a[180:183]
    v_max_f32 v250, v250, v40
    v_mfma_f32_16x16x32_bf16 a[184:187], v[232:235], v[212:215], a[184:187]
    v_cmp_gt_f32 s[48:49], v248, v239
    v_mfma_f32_16x16x32_bf16 a[188:191], v[232:235], v[216:219], a[188:191]
    v_cmp_gt_f32 s[50:51], v249, v240
    v_cmp_gt_f32 s[52:53], v250, v241
    s_nop 3
    s_or_b64 s[48:49], s[48:49], s[50:51]
    s_or_b64 s[48:49], s[48:49], s[52:53]
    s_cbranch_scc0 L_norescale3
    v_max_f32 v252, v236, v248
    v_sub_f32 v253, v236, v252
    v_mul_f32 v253, s46, v253
    v_exp_f32 v253, v253
    v_mov_b32 v236, v252
    v_add_f32 v239, 0x42b17218, v252
    v_mul_f32 v242, s46, v252
    v_mul_f32 v245, v245, v253
    v_accvgpr_read_b32 v254, a0
    v_mul_f32 v254, v254, v253
    v_accvgpr_write_b32 a0, v254
    v_accvgpr_read_b32 v254, a1
    v_mul_f32 v254, v254, v253
    v_accvgpr_write_b32 a1, v254
    v_accvgpr_read_b32 v254, a2
    v_mul_f32 v254, v254, v253
    v_accvgpr_write_b32 a2, v254
    v_accvgpr_read_b32 v254, a3
    v_mul_f32 v254, v254, v253
    v_accvgpr_write_b32 a3, v254
    v_accvgpr_read_b32 v254, a12
    v_mul_f32 v254, v254, v253
    v_accvgpr_write_b32 a12, v254
    v_accvgpr_read_b32 v254, a13
    v_mul_f32 v254, v254, v253
    v_accvgpr_write_b32 a13, v254
    v_accvgpr_read_b32 v254, a14
    v_mul_f32 v254, v254, v253
    v_accvgpr_write_b32 a14, v254
    v_accvgpr_read_b32 v254, a15
    v_mul_f32 v254, v254, v253
    v_accvgpr_write_b32 a15, v254
    v_accvgpr_read_b32 v254, a24
    v_mul_f32 v254, v254, v253
    v_accvgpr_write_b32 a24, v254
    v_accvgpr_read_b32 v254, a25
    v_mul_f32 v254, v254, v253
    v_accvgpr_write_b32 a25, v254
    v_accvgpr_read_b32 v254, a26
    v_mul_f32 v254, v254, v253
    v_accvgpr_write_b32 a26, v254
    v_accvgpr_read_b32 v254, a27
    v_mul_f32 v254, v254, v253
    v_accvgpr_write_b32 a27, v254
    v_accvgpr_read_b32 v254, a36
    v_mul_f32 v254, v254, v253
    v_accvgpr_write_b32 a36, v254
    v_accvgpr_read_b32 v254, a37
    v_mul_f32 v254, v254, v253
    v_accvgpr_write_b32 a37, v254
    v_accvgpr_read_b32 v254, a38
    v_mul_f32 v254, v254, v253
    v_accvgpr_write_b32 a38, v254
    v_accvgpr_read_b32 v254, a39
    v_mul_f32 v254, v254, v253
    v_accvgpr_write_b32 a39, v254
    v_accvgpr_read_b32 v254, a48
    v_mul_f32 v254, v254, v253
    v_accvgpr_write_b32 a48, v254
    v_accvgpr_read_b32 v254, a49
    v_mul_f32 v254, v254, v253
    v_accvgpr_write_b32 a49, v254
    v_accvgpr_read_b32 v254, a50
    v_mul_f32 v254, v254, v253
    v_accvgpr_write_b32 a50, v254
    v_accvgpr_read_b32 v254, a51
    v_mul_f32 v254, v254, v253
    v_accvgpr_write_b32 a51, v254
    v_accvgpr_read_b32 v254, a60
    v_mul_f32 v254, v254, v253
    v_accvgpr_write_b32 a60, v254
    v_accvgpr_read_b32 v254, a61
    v_mul_f32 v254, v254, v253
    v_accvgpr_write_b32 a61, v254
    v_accvgpr_read_b32 v254, a62
    v_mul_f32 v254, v254, v253
    v_accvgpr_write_b32 a62, v254
    v_accvgpr_read_b32 v254, a63
    v_mul_f32 v254, v254, v253
    v_accvgpr_write_b32 a63, v254
    v_accvgpr_read_b32 v254, a72
    v_mul_f32 v254, v254, v253
    v_accvgpr_write_b32 a72, v254
    v_accvgpr_read_b32 v254, a73
    v_mul_f32 v254, v254, v253
    v_accvgpr_write_b32 a73, v254
    v_accvgpr_read_b32 v254, a74
    v_mul_f32 v254, v254, v253
    v_accvgpr_write_b32 a74, v254
    v_accvgpr_read_b32 v254, a75
    v_mul_f32 v254, v254, v253
    v_accvgpr_write_b32 a75, v254
    v_accvgpr_read_b32 v254, a84
    v_mul_f32 v254, v254, v253
    v_accvgpr_write_b32 a84, v254
    v_accvgpr_read_b32 v254, a85
    v_mul_f32 v254, v254, v253
    v_accvgpr_write_b32 a85, v254
    v_accvgpr_read_b32 v254, a86
    v_mul_f32 v254, v254, v253
    v_accvgpr_write_b32 a86, v254
    v_accvgpr_read_b32 v254, a87
    v_mul_f32 v254, v254, v253
    v_accvgpr_write_b32 a87, v254
    v_accvgpr_read_b32 v254, a96
    v_mul_f32 v254, v254, v253
    v_accvgpr_write_b32 a96, v254
    v_accvgpr_read_b32 v254, a97
    v_mul_f32 v254, v254, v253
    v_accvgpr_write_b32 a97, v254
    v_accvgpr_read_b32 v254, a98
    v_mul_f32 v254, v254, v253
    v_accvgpr_write_b32 a98, v254
    v_accvgpr_read_b32 v254, a99
    v_mul_f32 v254, v254, v253
    v_accvgpr_write_b32 a99, v254
    v_accvgpr_read_b32 v254, a108
    v_mul_f32 v254, v254, v253
    v_accvgpr_write_b32 a108, v254
    v_accvgpr_read_b32 v254, a109
    v_mul_f32 v254, v254, v253
    v_accvgpr_write_b32 a109, v254
    v_accvgpr_read_b32 v254, a110
    v_mul_f32 v254, v254, v253
    v_accvgpr_write_b32 a110, v254
    v_accvgpr_read_b32 v254, a111
    v_mul_f32 v254, v254, v253
    v_accvgpr_write_b32 a111, v254
    v_accvgpr_read_b32 v254, a120
    v_mul_f32 v254, v254, v253
    v_accvgpr_write_b32 a120, v254
    v_accvgpr_read_b32 v254, a121
    v_mul_f32 v254, v254, v253
    v_accvgpr_write_b32 a121, v254
    v_accvgpr_read_b32 v254, a122
    v_mul_f32 v254, v254, v253
    v_accvgpr_write_b32 a122, v254
    v_accvgpr_read_b32 v254, a123
    v_mul_f32 v254, v254, v253
    v_accvgpr_write_b32 a123, v254
    v_accvgpr_read_b32 v254, a132
    v_mul_f32 v254, v254, v253
    v_accvgpr_write_b32 a132, v254
    v_accvgpr_read_b32 v254, a133
    v_mul_f32 v254, v254, v253
    v_accvgpr_write_b32 a133, v254
    v_accvgpr_read_b32 v254, a134
    v_mul_f32 v254, v254, v253
    v_accvgpr_write_b32 a134, v254
    v_accvgpr_read_b32 v254, a135
    v_mul_f32 v254, v254, v253
    v_accvgpr_write_b32 a135, v254
    v_accvgpr_read_b32 v254, a144
    v_mul_f32 v254, v254, v253
    v_accvgpr_write_b32 a144, v254
    v_accvgpr_read_b32 v254, a145
    v_mul_f32 v254, v254, v253
    v_accvgpr_write_b32 a145, v254
    v_accvgpr_read_b32 v254, a146
    v_mul_f32 v254, v254, v253
    v_accvgpr_write_b32 a146, v254
    v_accvgpr_read_b32 v254, a147
    v_mul_f32 v254, v254, v253
    v_accvgpr_write_b32 a147, v254
    v_accvgpr_read_b32 v254, a156
    v_mul_f32 v254, v254, v253
    v_accvgpr_write_b32 a156, v254
    v_accvgpr_read_b32 v254, a157
    v_mul_f32 v254, v254, v253
    v_accvgpr_write_b32 a157, v254
    v_accvgpr_read_b32 v254, a158
    v_mul_f32 v254, v254, v253
    v_accvgpr_write_b32 a158, v254
    v_accvgpr_read_b32 v254, a159
    v_mul_f32 v254, v254, v253
    v_accvgpr_write_b32 a159, v254
    v_accvgpr_read_b32 v254, a168
    v_mul_f32 v254, v254, v253
    v_accvgpr_write_b32 a168, v254
    v_accvgpr_read_b32 v254, a169
    v_mul_f32 v254, v254, v253
    v_accvgpr_write_b32 a169, v254
    v_accvgpr_read_b32 v254, a170
    v_mul_f32 v254, v254, v253
    v_accvgpr_write_b32 a170, v254
    v_accvgpr_read_b32 v254, a171
    v_mul_f32 v254, v254, v253
    v_accvgpr_write_b32 a171, v254
    v_accvgpr_read_b32 v254, a180
    v_mul_f32 v254, v254, v253
    v_accvgpr_write_b32 a180, v254
    v_accvgpr_read_b32 v254, a181
    v_mul_f32 v254, v254, v253
    v_accvgpr_write_b32 a181, v254
    v_accvgpr_read_b32 v254, a182
    v_mul_f32 v254, v254, v253
    v_accvgpr_write_b32 a182, v254
    v_accvgpr_read_b32 v254, a183
    v_mul_f32 v254, v254, v253
    v_accvgpr_write_b32 a183, v254
    v_max_f32 v252, v237, v249
    v_sub_f32 v253, v237, v252
    v_mul_f32 v253, s46, v253
    v_exp_f32 v253, v253
    v_mov_b32 v237, v252
    v_add_f32 v240, 0x42b17218, v252
    v_mul_f32 v243, s46, v252
    v_mul_f32 v246, v246, v253
    v_accvgpr_read_b32 v254, a4
    v_mul_f32 v254, v254, v253
    v_accvgpr_write_b32 a4, v254
    v_accvgpr_read_b32 v254, a5
    v_mul_f32 v254, v254, v253
    v_accvgpr_write_b32 a5, v254
    v_accvgpr_read_b32 v254, a6
    v_mul_f32 v254, v254, v253
    v_accvgpr_write_b32 a6, v254
    v_accvgpr_read_b32 v254, a7
    v_mul_f32 v254, v254, v253
    v_accvgpr_write_b32 a7, v254
    v_accvgpr_read_b32 v254, a16
    v_mul_f32 v254, v254, v253
    v_accvgpr_write_b32 a16, v254
    v_accvgpr_read_b32 v254, a17
    v_mul_f32 v254, v254, v253
    v_accvgpr_write_b32 a17, v254
    v_accvgpr_read_b32 v254, a18
    v_mul_f32 v254, v254, v253
    v_accvgpr_write_b32 a18, v254
    v_accvgpr_read_b32 v254, a19
    v_mul_f32 v254, v254, v253
    v_accvgpr_write_b32 a19, v254
    v_accvgpr_read_b32 v254, a28
    v_mul_f32 v254, v254, v253
    v_accvgpr_write_b32 a28, v254
    v_accvgpr_read_b32 v254, a29
    v_mul_f32 v254, v254, v253
    v_accvgpr_write_b32 a29, v254
    v_accvgpr_read_b32 v254, a30
    v_mul_f32 v254, v254, v253
    v_accvgpr_write_b32 a30, v254
    v_accvgpr_read_b32 v254, a31
    v_mul_f32 v254, v254, v253
    v_accvgpr_write_b32 a31, v254
    v_accvgpr_read_b32 v254, a40
    v_mul_f32 v254, v254, v253
    v_accvgpr_write_b32 a40, v254
    v_accvgpr_read_b32 v254, a41
    v_mul_f32 v254, v254, v253
    v_accvgpr_write_b32 a41, v254
    v_accvgpr_read_b32 v254, a42
    v_mul_f32 v254, v254, v253
    v_accvgpr_write_b32 a42, v254
    v_accvgpr_read_b32 v254, a43
    v_mul_f32 v254, v254, v253
    v_accvgpr_write_b32 a43, v254
    v_accvgpr_read_b32 v254, a52
    v_mul_f32 v254, v254, v253
    v_accvgpr_write_b32 a52, v254
    v_accvgpr_read_b32 v254, a53
    v_mul_f32 v254, v254, v253
    v_accvgpr_write_b32 a53, v254
    v_accvgpr_read_b32 v254, a54
    v_mul_f32 v254, v254, v253
    v_accvgpr_write_b32 a54, v254
    v_accvgpr_read_b32 v254, a55
    v_mul_f32 v254, v254, v253
    v_accvgpr_write_b32 a55, v254
    v_accvgpr_read_b32 v254, a64
    v_mul_f32 v254, v254, v253
    v_accvgpr_write_b32 a64, v254
    v_accvgpr_read_b32 v254, a65
    v_mul_f32 v254, v254, v253
    v_accvgpr_write_b32 a65, v254
    v_accvgpr_read_b32 v254, a66
    v_mul_f32 v254, v254, v253
    v_accvgpr_write_b32 a66, v254
    v_accvgpr_read_b32 v254, a67
    v_mul_f32 v254, v254, v253
    v_accvgpr_write_b32 a67, v254
    v_accvgpr_read_b32 v254, a76
    v_mul_f32 v254, v254, v253
    v_accvgpr_write_b32 a76, v254
    v_accvgpr_read_b32 v254, a77
    v_mul_f32 v254, v254, v253
    v_accvgpr_write_b32 a77, v254
    v_accvgpr_read_b32 v254, a78
    v_mul_f32 v254, v254, v253
    v_accvgpr_write_b32 a78, v254
    v_accvgpr_read_b32 v254, a79
    v_mul_f32 v254, v254, v253
    v_accvgpr_write_b32 a79, v254
    v_accvgpr_read_b32 v254, a88
    v_mul_f32 v254, v254, v253
    v_accvgpr_write_b32 a88, v254
    v_accvgpr_read_b32 v254, a89
    v_mul_f32 v254, v254, v253
    v_accvgpr_write_b32 a89, v254
    v_accvgpr_read_b32 v254, a90
    v_mul_f32 v254, v254, v253
    v_accvgpr_write_b32 a90, v254
    v_accvgpr_read_b32 v254, a91
    v_mul_f32 v254, v254, v253
    v_accvgpr_write_b32 a91, v254
    v_accvgpr_read_b32 v254, a100
    v_mul_f32 v254, v254, v253
    v_accvgpr_write_b32 a100, v254
    v_accvgpr_read_b32 v254, a101
    v_mul_f32 v254, v254, v253
    v_accvgpr_write_b32 a101, v254
    v_accvgpr_read_b32 v254, a102
    v_mul_f32 v254, v254, v253
    v_accvgpr_write_b32 a102, v254
    v_accvgpr_read_b32 v254, a103
    v_mul_f32 v254, v254, v253
    v_accvgpr_write_b32 a103, v254
    v_accvgpr_read_b32 v254, a112
    v_mul_f32 v254, v254, v253
    v_accvgpr_write_b32 a112, v254
    v_accvgpr_read_b32 v254, a113
    v_mul_f32 v254, v254, v253
    v_accvgpr_write_b32 a113, v254
    v_accvgpr_read_b32 v254, a114
    v_mul_f32 v254, v254, v253
    v_accvgpr_write_b32 a114, v254
    v_accvgpr_read_b32 v254, a115
    v_mul_f32 v254, v254, v253
    v_accvgpr_write_b32 a115, v254
    v_accvgpr_read_b32 v254, a124
    v_mul_f32 v254, v254, v253
    v_accvgpr_write_b32 a124, v254
    v_accvgpr_read_b32 v254, a125
    v_mul_f32 v254, v254, v253
    v_accvgpr_write_b32 a125, v254
    v_accvgpr_read_b32 v254, a126
    v_mul_f32 v254, v254, v253
    v_accvgpr_write_b32 a126, v254
    v_accvgpr_read_b32 v254, a127
    v_mul_f32 v254, v254, v253
    v_accvgpr_write_b32 a127, v254
    v_accvgpr_read_b32 v254, a136
    v_mul_f32 v254, v254, v253
    v_accvgpr_write_b32 a136, v254
    v_accvgpr_read_b32 v254, a137
    v_mul_f32 v254, v254, v253
    v_accvgpr_write_b32 a137, v254
    v_accvgpr_read_b32 v254, a138
    v_mul_f32 v254, v254, v253
    v_accvgpr_write_b32 a138, v254
    v_accvgpr_read_b32 v254, a139
    v_mul_f32 v254, v254, v253
    v_accvgpr_write_b32 a139, v254
    v_accvgpr_read_b32 v254, a148
    v_mul_f32 v254, v254, v253
    v_accvgpr_write_b32 a148, v254
    v_accvgpr_read_b32 v254, a149
    v_mul_f32 v254, v254, v253
    v_accvgpr_write_b32 a149, v254
    v_accvgpr_read_b32 v254, a150
    v_mul_f32 v254, v254, v253
    v_accvgpr_write_b32 a150, v254
    v_accvgpr_read_b32 v254, a151
    v_mul_f32 v254, v254, v253
    v_accvgpr_write_b32 a151, v254
    v_accvgpr_read_b32 v254, a160
    v_mul_f32 v254, v254, v253
    v_accvgpr_write_b32 a160, v254
    v_accvgpr_read_b32 v254, a161
    v_mul_f32 v254, v254, v253
    v_accvgpr_write_b32 a161, v254
    v_accvgpr_read_b32 v254, a162
    v_mul_f32 v254, v254, v253
    v_accvgpr_write_b32 a162, v254
    v_accvgpr_read_b32 v254, a163
    v_mul_f32 v254, v254, v253
    v_accvgpr_write_b32 a163, v254
    v_accvgpr_read_b32 v254, a172
    v_mul_f32 v254, v254, v253
    v_accvgpr_write_b32 a172, v254
    v_accvgpr_read_b32 v254, a173
    v_mul_f32 v254, v254, v253
    v_accvgpr_write_b32 a173, v254
    v_accvgpr_read_b32 v254, a174
    v_mul_f32 v254, v254, v253
    v_accvgpr_write_b32 a174, v254
    v_accvgpr_read_b32 v254, a175
    v_mul_f32 v254, v254, v253
    v_accvgpr_write_b32 a175, v254
    v_accvgpr_read_b32 v254, a184
    v_mul_f32 v254, v254, v253
    v_accvgpr_write_b32 a184, v254
    v_accvgpr_read_b32 v254, a185
    v_mul_f32 v254, v254, v253
    v_accvgpr_write_b32 a185, v254
    v_accvgpr_read_b32 v254, a186
    v_mul_f32 v254, v254, v253
    v_accvgpr_write_b32 a186, v254
    v_accvgpr_read_b32 v254, a187
    v_mul_f32 v254, v254, v253
    v_accvgpr_write_b32 a187, v254
    v_max_f32 v252, v238, v250
    v_sub_f32 v253, v238, v252
    v_mul_f32 v253, s46, v253
    v_exp_f32 v253, v253
    v_mov_b32 v238, v252
    v_add_f32 v241, 0x42b17218, v252
    v_mul_f32 v244, s46, v252
    v_mul_f32 v247, v247, v253
    v_accvgpr_read_b32 v254, a8
    v_mul_f32 v254, v254, v253
    v_accvgpr_write_b32 a8, v254
    v_accvgpr_read_b32 v254, a9
    v_mul_f32 v254, v254, v253
    v_accvgpr_write_b32 a9, v254
    v_accvgpr_read_b32 v254, a10
    v_mul_f32 v254, v254, v253
    v_accvgpr_write_b32 a10, v254
    v_accvgpr_read_b32 v254, a11
    v_mul_f32 v254, v254, v253
    v_accvgpr_write_b32 a11, v254
    v_accvgpr_read_b32 v254, a20
    v_mul_f32 v254, v254, v253
    v_accvgpr_write_b32 a20, v254
    v_accvgpr_read_b32 v254, a21
    v_mul_f32 v254, v254, v253
    v_accvgpr_write_b32 a21, v254
    v_accvgpr_read_b32 v254, a22
    v_mul_f32 v254, v254, v253
    v_accvgpr_write_b32 a22, v254
    v_accvgpr_read_b32 v254, a23
    v_mul_f32 v254, v254, v253
    v_accvgpr_write_b32 a23, v254
    v_accvgpr_read_b32 v254, a32
    v_mul_f32 v254, v254, v253
    v_accvgpr_write_b32 a32, v254
    v_accvgpr_read_b32 v254, a33
    v_mul_f32 v254, v254, v253
    v_accvgpr_write_b32 a33, v254
    v_accvgpr_read_b32 v254, a34
    v_mul_f32 v254, v254, v253
    v_accvgpr_write_b32 a34, v254
    v_accvgpr_read_b32 v254, a35
    v_mul_f32 v254, v254, v253
    v_accvgpr_write_b32 a35, v254
    v_accvgpr_read_b32 v254, a44
    v_mul_f32 v254, v254, v253
    v_accvgpr_write_b32 a44, v254
    v_accvgpr_read_b32 v254, a45
    v_mul_f32 v254, v254, v253
    v_accvgpr_write_b32 a45, v254
    v_accvgpr_read_b32 v254, a46
    v_mul_f32 v254, v254, v253
    v_accvgpr_write_b32 a46, v254
    v_accvgpr_read_b32 v254, a47
    v_mul_f32 v254, v254, v253
    v_accvgpr_write_b32 a47, v254
    v_accvgpr_read_b32 v254, a56
    v_mul_f32 v254, v254, v253
    v_accvgpr_write_b32 a56, v254
    v_accvgpr_read_b32 v254, a57
    v_mul_f32 v254, v254, v253
    v_accvgpr_write_b32 a57, v254
    v_accvgpr_read_b32 v254, a58
    v_mul_f32 v254, v254, v253
    v_accvgpr_write_b32 a58, v254
    v_accvgpr_read_b32 v254, a59
    v_mul_f32 v254, v254, v253
    v_accvgpr_write_b32 a59, v254
    v_accvgpr_read_b32 v254, a68
    v_mul_f32 v254, v254, v253
    v_accvgpr_write_b32 a68, v254
    v_accvgpr_read_b32 v254, a69
    v_mul_f32 v254, v254, v253
    v_accvgpr_write_b32 a69, v254
    v_accvgpr_read_b32 v254, a70
    v_mul_f32 v254, v254, v253
    v_accvgpr_write_b32 a70, v254
    v_accvgpr_read_b32 v254, a71
    v_mul_f32 v254, v254, v253
    v_accvgpr_write_b32 a71, v254
    v_accvgpr_read_b32 v254, a80
    v_mul_f32 v254, v254, v253
    v_accvgpr_write_b32 a80, v254
    v_accvgpr_read_b32 v254, a81
    v_mul_f32 v254, v254, v253
    v_accvgpr_write_b32 a81, v254
    v_accvgpr_read_b32 v254, a82
    v_mul_f32 v254, v254, v253
    v_accvgpr_write_b32 a82, v254
    v_accvgpr_read_b32 v254, a83
    v_mul_f32 v254, v254, v253
    v_accvgpr_write_b32 a83, v254
    v_accvgpr_read_b32 v254, a92
    v_mul_f32 v254, v254, v253
    v_accvgpr_write_b32 a92, v254
    v_accvgpr_read_b32 v254, a93
    v_mul_f32 v254, v254, v253
    v_accvgpr_write_b32 a93, v254
    v_accvgpr_read_b32 v254, a94
    v_mul_f32 v254, v254, v253
    v_accvgpr_write_b32 a94, v254
    v_accvgpr_read_b32 v254, a95
    v_mul_f32 v254, v254, v253
    v_accvgpr_write_b32 a95, v254
    v_accvgpr_read_b32 v254, a104
    v_mul_f32 v254, v254, v253
    v_accvgpr_write_b32 a104, v254
    v_accvgpr_read_b32 v254, a105
    v_mul_f32 v254, v254, v253
    v_accvgpr_write_b32 a105, v254
    v_accvgpr_read_b32 v254, a106
    v_mul_f32 v254, v254, v253
    v_accvgpr_write_b32 a106, v254
    v_accvgpr_read_b32 v254, a107
    v_mul_f32 v254, v254, v253
    v_accvgpr_write_b32 a107, v254
    v_accvgpr_read_b32 v254, a116
    v_mul_f32 v254, v254, v253
    v_accvgpr_write_b32 a116, v254
    v_accvgpr_read_b32 v254, a117
    v_mul_f32 v254, v254, v253
    v_accvgpr_write_b32 a117, v254
    v_accvgpr_read_b32 v254, a118
    v_mul_f32 v254, v254, v253
    v_accvgpr_write_b32 a118, v254
    v_accvgpr_read_b32 v254, a119
    v_mul_f32 v254, v254, v253
    v_accvgpr_write_b32 a119, v254
    v_accvgpr_read_b32 v254, a128
    v_mul_f32 v254, v254, v253
    v_accvgpr_write_b32 a128, v254
    v_accvgpr_read_b32 v254, a129
    v_mul_f32 v254, v254, v253
    v_accvgpr_write_b32 a129, v254
    v_accvgpr_read_b32 v254, a130
    v_mul_f32 v254, v254, v253
    v_accvgpr_write_b32 a130, v254
    v_accvgpr_read_b32 v254, a131
    v_mul_f32 v254, v254, v253
    v_accvgpr_write_b32 a131, v254
    v_accvgpr_read_b32 v254, a140
    v_mul_f32 v254, v254, v253
    v_accvgpr_write_b32 a140, v254
    v_accvgpr_read_b32 v254, a141
    v_mul_f32 v254, v254, v253
    v_accvgpr_write_b32 a141, v254
    v_accvgpr_read_b32 v254, a142
    v_mul_f32 v254, v254, v253
    v_accvgpr_write_b32 a142, v254
    v_accvgpr_read_b32 v254, a143
    v_mul_f32 v254, v254, v253
    v_accvgpr_write_b32 a143, v254
    v_accvgpr_read_b32 v254, a152
    v_mul_f32 v254, v254, v253
    v_accvgpr_write_b32 a152, v254
    v_accvgpr_read_b32 v254, a153
    v_mul_f32 v254, v254, v253
    v_accvgpr_write_b32 a153, v254
    v_accvgpr_read_b32 v254, a154
    v_mul_f32 v254, v254, v253
    v_accvgpr_write_b32 a154, v254
    v_accvgpr_read_b32 v254, a155
    v_mul_f32 v254, v254, v253
    v_accvgpr_write_b32 a155, v254
    v_accvgpr_read_b32 v254, a164
    v_mul_f32 v254, v254, v253
    v_accvgpr_write_b32 a164, v254
    v_accvgpr_read_b32 v254, a165
    v_mul_f32 v254, v254, v253
    v_accvgpr_write_b32 a165, v254
    v_accvgpr_read_b32 v254, a166
    v_mul_f32 v254, v254, v253
    v_accvgpr_write_b32 a166, v254
    v_accvgpr_read_b32 v254, a167
    v_mul_f32 v254, v254, v253
    v_accvgpr_write_b32 a167, v254
    v_accvgpr_read_b32 v254, a176
    v_mul_f32 v254, v254, v253
    v_accvgpr_write_b32 a176, v254
    v_accvgpr_read_b32 v254, a177
    v_mul_f32 v254, v254, v253
    v_accvgpr_write_b32 a177, v254
    v_accvgpr_read_b32 v254, a178
    v_mul_f32 v254, v254, v253
    v_accvgpr_write_b32 a178, v254
    v_accvgpr_read_b32 v254, a179
    v_mul_f32 v254, v254, v253
    v_accvgpr_write_b32 a179, v254
    v_accvgpr_read_b32 v254, a188
    v_mul_f32 v254, v254, v253
    v_accvgpr_write_b32 a188, v254
    v_accvgpr_read_b32 v254, a189
    v_mul_f32 v254, v254, v253
    v_accvgpr_write_b32 a189, v254
    v_accvgpr_read_b32 v254, a190
    v_mul_f32 v254, v254, v253
    v_accvgpr_write_b32 a190, v254
    v_accvgpr_read_b32 v254, a191
    v_mul_f32 v254, v254, v253
    v_accvgpr_write_b32 a191, v254
L_norescale3:
    s_waitcnt vmcnt(16)
    s_barrier
    s_lshl_b32 s40, s34, 13
    s_add_u32 s41, s40, s45
    s_add_u32 s40, s40, 65536
    s_mov_b32 m0, s40
    s_nop 0
    buffer_load_dwordx4 v4, s[16:19], s41 offen offset:0 lds
    buffer_load_dwordx4 v5, s[16:19], s41 offen offset:1024 lds
    buffer_load_dwordx4 v6, s[16:19], s41 offen offset:2048 lds
    buffer_load_dwordx4 v7, s[16:19], s41 offen offset:3072 lds
    s_add_u32 s40, s40, 4096
    s_add_u32 s41, s41, 4096
    s_mov_b32 m0, s40
    s_nop 0
    buffer_load_dwordx4 v4, s[16:19], s41 offen offset:0 lds
    buffer_load_dwordx4 v5, s[16:19], s41 offen offset:1024 lds
    buffer_load_dwordx4 v6, s[16:19], s41 offen offset:2048 lds
    buffer_load_dwordx4 v7, s[16:19], s41 offen offset:3072 lds
    s_add_u32 s45, s45, 32768
    s_add_u32 s47, s45, 32768
    v_fma_f32 v184, v184, s46, -v242
    v_exp_f32 v184, v184
    v_fma_f32 v185, v185, s46, -v242
    v_exp_f32 v185, v185
    v_fma_f32 v186, v186, s46, -v242
    v_exp_f32 v186, v186
    v_fma_f32 v187, v187, s46, -v242
    v_exp_f32 v187, v187
    v_fma_f32 v196, v196, s46, -v242
    v_exp_f32 v196, v196
    v_fma_f32 v197, v197, s46, -v242
    v_exp_f32 v197, v197
    v_fma_f32 v198, v198, s46, -v242
    v_exp_f32 v198, v198
    v_fma_f32 v199, v199, s46, -v242
    v_exp_f32 v199, v199
    v_add_f32 v38, v184, v185
    v_add_f32 v39, v186, v187
    v_add_f32 v40, v196, v197
    v_add_f32 v41, v198, v199
    v_add_f32 v38, v38, v39
    v_add_f32 v40, v40, v41
    v_add_f32 v245, v245, v38
    v_add_f32 v245, v245, v40
    v_cvt_pk_bf16_f32 v208, v184, v185
    v_cvt_pk_bf16_f32 v209, v186, v187
    v_cvt_pk_bf16_f32 v210, v196, v197
    v_cvt_pk_bf16_f32 v211, v198, v199
    v_fma_f32 v188, v188, s46, -v243
    v_exp_f32 v188, v188
    v_fma_f32 v189, v189, s46, -v243
    v_exp_f32 v189, v189
    v_fma_f32 v190, v190, s46, -v243
    v_exp_f32 v190, v190
    v_fma_f32 v191, v191, s46, -v243
    v_exp_f32 v191, v191
    v_fma_f32 v200, v200, s46, -v243
    v_exp_f32 v200, v200
    v_fma_f32 v201, v201, s46, -v243
    v_exp_f32 v201, v201
    v_fma_f32 v202, v202, s46, -v243
    v_exp_f32 v202, v202
    v_fma_f32 v203, v203, s46, -v243
    v_exp_f32 v203, v203
    v_add_f32 v42, v188, v189
    v_add_f32 v43, v190, v191
    v_add_f32 v44, v200, v201
    v_add_f32 v45, v202, v203
    v_add_f32 v42, v42, v43
    v_add_f32 v44, v44, v45
    v_add_f32 v246, v246, v42
    v_add_f32 v246, v246, v44
    v_cvt_pk_bf16_f32 v212, v188, v189
    v_cvt_pk_bf16_f32 v213, v190, v191
    v_cvt_pk_bf16_f32 v214, v200, v201
    v_cvt_pk_bf16_f32 v215, v202, v203
    v_fma_f32 v192, v192, s46, -v244
    v_exp_f32 v192, v192
    v_fma_f32 v193, v193, s46, -v244
    v_exp_f32 v193, v193
    v_fma_f32 v194, v194, s46, -v244
    v_exp_f32 v194, v194
    v_fma_f32 v195, v195, s46, -v244
    v_exp_f32 v195, v195
    v_fma_f32 v204, v204, s46, -v244
    v_exp_f32 v204, v204
    v_fma_f32 v205, v205, s46, -v244
    v_exp_f32 v205, v205
    v_fma_f32 v206, v206, s46, -v244
    v_exp_f32 v206, v206
    v_fma_f32 v207, v207, s46, -v244
    v_exp_f32 v207, v207
    v_add_f32 v46, v192, v193
    v_add_f32 v47, v194, v195
    v_add_f32 v48, v204, v205
    v_add_f32 v49, v206, v207
    v_add_f32 v46, v46, v47
    v_add_f32 v48, v48, v49
    v_add_f32 v247, v247, v46
    v_add_f32 v247, v247, v48
    v_cvt_pk_bf16_f32 v216, v192, v193
    v_cvt_pk_bf16_f32 v217, v194, v195
    v_cvt_pk_bf16_f32 v218, v204, v205
    v_cvt_pk_bf16_f32 v219, v206, v207
    s_waitcnt vmcnt(0)
    s_barrier
    s_nop 1
    ds_read_b64_tr_b16 v[220:221], v17 offset:32768
    ds_read_b64_tr_b16 v[222:223], v17 offset:40960
    ds_read_b64_tr_b16 v[224:225], v18 offset:32768
    ds_read_b64_tr_b16 v[226:227], v18 offset:40960
    ds_read_b64_tr_b16 v[228:229], v19 offset:32768
    ds_read_b64_tr_b16 v[230:231], v19 offset:40960
    s_waitcnt lgkmcnt(4)
    v_mfma_f32_16x16x32_bf16 a[0:3], v[220:223], v[208:211], a[0:3]
    v_mfma_f32_16x16x32_bf16 a[4:7], v[220:223], v[212:215], a[4:7]
    v_mfma_f32_16x16x32_bf16 a[8:11], v[220:223], v[216:219], a[8:11]
    ds_read_b64_tr_b16 v[232:233], v20 offset:32768
    ds_read_b64_tr_b16 v[234:235], v20 offset:40960
    s_waitcnt lgkmcnt(4)
    v_mfma_f32_16x16x32_bf16 a[12:15], v[224:227], v[208:211], a[12:15]
    v_mfma_f32_16x16x32_bf16 a[16:19], v[224:227], v[212:215], a[16:19]
    v_mfma_f32_16x16x32_bf16 a[20:23], v[224:227], v[216:219], a[20:23]
    ds_read_b64_tr_b16 v[220:221], v21 offset:32768
    ds_read_b64_tr_b16 v[222:223], v21 offset:40960
    s_waitcnt lgkmcnt(4)
    v_mfma_f32_16x16x32_bf16 a[24:27], v[228:231], v[208:211], a[24:27]
    v_mfma_f32_16x16x32_bf16 a[28:31], v[228:231], v[212:215], a[28:31]
    v_mfma_f32_16x16x32_bf16 a[32:35], v[228:231], v[216:219], a[32:35]
    ds_read_b64_tr_b16 v[224:225], v22 offset:32768
    ds_read_b64_tr_b16 v[226:227], v22 offset:40960
    s_waitcnt lgkmcnt(4)
    v_mfma_f32_16x16x32_bf16 a[36:39], v[232:235], v[208:211], a[36:39]
    v_mfma_f32_16x16x32_bf16 a[40:43], v[232:235], v[212:215], a[40:43]
    v_mfma_f32_16x16x32_bf16 a[44:47], v[232:235], v[216:219], a[44:47]
    ds_read_b64_tr_b16 v[228:229], v23 offset:32768
    ds_read_b64_tr_b16 v[230:231], v23 offset:40960
    s_waitcnt lgkmcnt(4)
    v_mfma_f32_16x16x32_bf16 a[48:51], v[220:223], v[208:211], a[48:51]
    v_mfma_f32_16x16x32_bf16 a[52:55], v[220:223], v[212:215], a[52:55]
    v_mfma_f32_16x16x32_bf16 a[56:59], v[220:223], v[216:219], a[56:59]
    ds_read_b64_tr_b16 v[232:233], v24 offset:32768
    ds_read_b64_tr_b16 v[234:235], v24 offset:40960
    s_waitcnt lgkmcnt(4)
    v_mfma_f32_16x16x32_bf16 a[60:63], v[224:227], v[208:211], a[60:63]
    v_mfma_f32_16x16x32_bf16 a[64:67], v[224:227], v[212:215], a[64:67]
    v_mfma_f32_16x16x32_bf16 a[68:71], v[224:227], v[216:219], a[68:71]
    ds_read_b64_tr_b16 v[220:221], v17 offset:33024
    ds_read_b64_tr_b16 v[222:223], v17 offset:41216
    s_waitcnt lgkmcnt(4)
    v_mfma_f32_16x16x32_bf16 a[72:75], v[228:231], v[208:211], a[72:75]
    v_mfma_f32_16x16x32_bf16 a[76:79], v[228:231], v[212:215], a[76:79]
    v_mfma_f32_16x16x32_bf16 a[80:83], v[228:231], v[216:219], a[80:83]
    ds_read_b64_tr_b16 v[224:225], v18 offset:33024
    ds_read_b64_tr_b16 v[226:227], v18 offset:41216
    s_waitcnt lgkmcnt(4)
    v_mfma_f32_16x16x32_bf16 a[84:87], v[232:235], v[208:211], a[84:87]
    v_mfma_f32_16x16x32_bf16 a[88:91], v[232:235], v[212:215], a[88:91]
    v_mfma_f32_16x16x32_bf16 a[92:95], v[232:235], v[216:219], a[92:95]
    ds_read_b64_tr_b16 v[228:229], v19 offset:33024
    ds_read_b64_tr_b16 v[230:231], v19 offset:41216
    s_waitcnt lgkmcnt(4)
    v_mfma_f32_16x16x32_bf16 a[96:99], v[220:223], v[208:211], a[96:99]
    v_mfma_f32_16x16x32_bf16 a[100:103], v[220:223], v[212:215], a[100:103]
    v_mfma_f32_16x16x32_bf16 a[104:107], v[220:223], v[216:219], a[104:107]
    ds_read_b64_tr_b16 v[232:233], v20 offset:33024
    ds_read_b64_tr_b16 v[234:235], v20 offset:41216
    s_waitcnt lgkmcnt(4)
    v_mfma_f32_16x16x32_bf16 a[108:111], v[224:227], v[208:211], a[108:111]
    v_mfma_f32_16x16x32_bf16 a[112:115], v[224:227], v[212:215], a[112:115]
    v_mfma_f32_16x16x32_bf16 a[116:119], v[224:227], v[216:219], a[116:119]
    ds_read_b64_tr_b16 v[220:221], v21 offset:33024
    ds_read_b64_tr_b16 v[222:223], v21 offset:41216
    s_waitcnt lgkmcnt(4)
    v_mfma_f32_16x16x32_bf16 a[120:123], v[228:231], v[208:211], a[120:123]
    v_mfma_f32_16x16x32_bf16 a[124:127], v[228:231], v[212:215], a[124:127]
    v_mfma_f32_16x16x32_bf16 a[128:131], v[228:231], v[216:219], a[128:131]
    ds_read_b64_tr_b16 v[224:225], v22 offset:33024
    ds_read_b64_tr_b16 v[226:227], v22 offset:41216
    s_waitcnt lgkmcnt(4)
    v_mfma_f32_16x16x32_bf16 a[132:135], v[232:235], v[208:211], a[132:135]
    v_mfma_f32_16x16x32_bf16 a[136:139], v[232:235], v[212:215], a[136:139]
    v_mfma_f32_16x16x32_bf16 a[140:143], v[232:235], v[216:219], a[140:143]
    ds_read_b64_tr_b16 v[228:229], v23 offset:33024
    ds_read_b64_tr_b16 v[230:231], v23 offset:41216
    s_waitcnt lgkmcnt(4)
    v_mfma_f32_16x16x32_bf16 a[144:147], v[220:223], v[208:211], a[144:147]
    v_mfma_f32_16x16x32_bf16 a[148:151], v[220:223], v[212:215], a[148:151]
    v_mfma_f32_16x16x32_bf16 a[152:155], v[220:223], v[216:219], a[152:155]
    ds_read_b64_tr_b16 v[232:233], v24 offset:33024
    ds_read_b64_tr_b16 v[234:235], v24 offset:41216
    s_waitcnt lgkmcnt(4)
    v_mfma_f32_16x16x32_bf16 a[156:159], v[224:227], v[208:211], a[156:159]
    v_mfma_f32_16x16x32_bf16 a[160:163], v[224:227], v[212:215], a[160:163]
    v_mfma_f32_16x16x32_bf16 a[164:167], v[224:227], v[216:219], a[164:167]
    s_waitcnt lgkmcnt(2)
    v_mfma_f32_16x16x32_bf16 a[168:171], v[228:231], v[208:211], a[168:171]
    v_mfma_f32_16x16x32_bf16 a[172:175], v[228:231], v[212:215], a[172:175]
    v_mfma_f32_16x16x32_bf16 a[176:179], v[228:231], v[216:219], a[176:179]
    s_waitcnt lgkmcnt(0)
    v_mfma_f32_16x16x32_bf16 a[180:183], v[232:235], v[208:211], a[180:183]
    v_mfma_f32_16x16x32_bf16 a[184:187], v[232:235], v[212:215], a[184:187]
    v_mfma_f32_16x16x32_bf16 a[188:191], v[232:235], v[216:219], a[188:191]
    s_waitcnt vmcnt(0)
    s_barrier
    s_lshl_b32 s40, s38, 16
    v_add_u32 v32, s40, v29
    s_cmp_eq_u32 s39, 0
    s_cbranch_scc1 L_ep_recv
    ds_write_b128 v32, a[0:3] offset:0
    ds_write_b128 v32, a[4:7] offset:1024
    ds_write_b128 v32, a[8:11] offset:2048
    ds_write_b128 v32, a[12:15] offset:3072
    ds_write_b128 v32, a[16:19] offset:4096
    ds_write_b128 v32, a[20:23] offset:5120
    ds_write_b128 v32, a[24:27] offset:6144
    ds_write_b128 v32, a[28:31] offset:7168
    ds_write_b128 v32, a[32:35] offset:8192
    ds_write_b128 v32, a[36:39] offset:9216
    ds_write_b128 v32, a[40:43] offset:10240
    ds_write_b128 v32, a[44:47] offset:11264
    ds_write_b128 v32, a[48:51] offset:12288
    ds_write_b128 v32, a[52:55] offset:13312
    ds_write_b128 v32, a[56:59] offset:14336
    ds_write_b128 v32, a[60:63] offset:15360
    ds_write_b128 v32, a[64:67] offset:16384
    ds_write_b128 v32, a[68:71] offset:17408
    ds_write_b128 v32, a[72:75] offset:18432
    ds_write_b128 v32, a[76:79] offset:19456
    ds_write_b128 v32, a[80:83] offset:20480
    ds_write_b128 v32, a[84:87] offset:21504
    ds_write_b128 v32, a[88:91] offset:22528
    ds_write_b128 v32, a[92:95] offset:23552
    ds_write_b128 v32, a[96:99] offset:24576
    ds_write_b128 v32, a[100:103] offset:25600
    ds_write_b128 v32, a[104:107] offset:26624
    ds_write_b128 v32, a[108:111] offset:27648
    ds_write_b128 v32, a[112:115] offset:28672
    ds_write_b128 v32, a[116:119] offset:29696
    ds_write_b128 v32, a[120:123] offset:30720
    ds_write_b128 v32, a[124:127] offset:31744
    ds_write_b128 v32, a[128:131] offset:32768
    ds_write_b128 v32, a[132:135] offset:33792
    ds_write_b128 v32, a[136:139] offset:34816
    ds_write_b128 v32, a[140:143] offset:35840
    ds_write_b128 v32, a[144:147] offset:36864
    ds_write_b128 v32, a[148:151] offset:37888
    ds_write_b128 v32, a[152:155] offset:38912
    ds_write_b128 v32, a[156:159] offset:39936
    ds_write_b128 v32, a[160:163] offset:40960
    ds_write_b128 v32, a[164:167] offset:41984
    ds_write_b128 v32, a[168:171] offset:43008
    ds_write_b128 v32, a[172:175] offset:44032
    ds_write_b128 v32, a[176:179] offset:45056
    ds_write_b128 v32, a[180:183] offset:46080
    ds_write_b128 v32, a[184:187] offset:47104
    ds_write_b128 v32, a[188:191] offset:48128
    v_mov_b32 v38, v236
    v_mov_b32 v39, v245
    ds_write_b64 v32, v[38:39] offset:49152
    v_mov_b32 v38, v237
    v_mov_b32 v39, v246
    ds_write_b64 v32, v[38:39] offset:50176
    v_mov_b32 v38, v238
    v_mov_b32 v39, v247
    ds_write_b64 v32, v[38:39] offset:51200
    s_waitcnt lgkmcnt(0)
    s_barrier
    s_branch L_attn_end
L_ep_recv:
    s_barrier
    ds_read_b64 v[38:39], v32 offset:49152
    s_waitcnt lgkmcnt(0)
    v_max_f32 v40, v236, v38
    v_sub_f32 v41, v236, v40
    v_mul_f32 v41, s46, v41
    v_exp_f32 v226, v41
    v_sub_f32 v41, v38, v40
    v_mul_f32 v41, s46, v41
    v_exp_f32 v229, v41
    s_nop 0
    v_mul_f32 v42, v245, v226
    v_fma_f32 v42, v39, v229, v42
    v_mov_b32 v43, v42
    s_nop 1
    v_permlane16_swap_b32 v42, v43
    v_add_f32 v42, v42, v43
    v_mov_b32 v43, v42
    s_nop 1
    v_permlane32_swap_b32 v42, v43
    v_add_f32 v42, v42, v43
    v_rcp_f32 v223, v42
    s_nop 0
    v_mul_f32 v226, v226, v223
    v_mul_f32 v229, v229, v223
    ds_read_b64 v[38:39], v32 offset:50176
    s_waitcnt lgkmcnt(0)
    v_max_f32 v40, v237, v38
    v_sub_f32 v41, v237, v40
    v_mul_f32 v41, s46, v41
    v_exp_f32 v227, v41
    v_sub_f32 v41, v38, v40
    v_mul_f32 v41, s46, v41
    v_exp_f32 v230, v41
    s_nop 0
    v_mul_f32 v42, v246, v227
    v_fma_f32 v42, v39, v230, v42
    v_mov_b32 v43, v42
    s_nop 1
    v_permlane16_swap_b32 v42, v43
    v_add_f32 v42, v42, v43
    v_mov_b32 v43, v42
    s_nop 1
    v_permlane32_swap_b32 v42, v43
    v_add_f32 v42, v42, v43
    v_rcp_f32 v224, v42
    s_nop 0
    v_mul_f32 v227, v227, v224
    v_mul_f32 v230, v230, v224
    ds_read_b64 v[38:39], v32 offset:51200
    s_waitcnt lgkmcnt(0)
    v_max_f32 v40, v238, v38
    v_sub_f32 v41, v238, v40
    v_mul_f32 v41, s46, v41
    v_exp_f32 v228, v41
    v_sub_f32 v41, v38, v40
    v_mul_f32 v41, s46, v41
    v_exp_f32 v231, v41
    s_nop 0
    v_mul_f32 v42, v247, v228
    v_fma_f32 v42, v39, v231, v42
    v_mov_b32 v43, v42
    s_nop 1
    v_permlane16_swap_b32 v42, v43
    v_add_f32 v42, v42, v43
    v_mov_b32 v43, v42
    s_nop 1
    v_permlane32_swap_b32 v42, v43
    v_add_f32 v42, v42, v43
    v_rcp_f32 v225, v42
    s_nop 0
    v_mul_f32 v228, v228, v225
    v_mul_f32 v231, v231, v225
    s_mul_i32 s40, s38, 393216
    v_add_u32 v33, s40, v29
    ds_read_b128 v[40:43], v32 offset:0
    v_accvgpr_read_b32 v50, a0
    v_accvgpr_read_b32 v51, a1
    v_accvgpr_read_b32 v52, a2
    v_accvgpr_read_b32 v53, a3
    ds_read_b128 v[44:47], v32 offset:3072
    v_accvgpr_read_b32 v54, a12
    v_accvgpr_read_b32 v55, a13
    v_accvgpr_read_b32 v56, a14
    v_accvgpr_read_b32 v57, a15
    s_waitcnt lgkmcnt(0)
    v_mul_f32 v50, v50, v226
    v_fma_f32 v50, v40, v229, v50
    v_mul_f32 v51, v51, v226
    v_fma_f32 v51, v41, v229, v51
    v_mul_f32 v52, v52, v226
    v_fma_f32 v52, v42, v229, v52
    v_mul_f32 v53, v53, v226
    v_fma_f32 v53, v43, v229, v53
    v_cvt_pk_bf16_f32 v58, v50, v51
    v_cvt_pk_bf16_f32 v59, v52, v53
    v_mul_f32 v54, v54, v226
    v_fma_f32 v54, v44, v229, v54
    v_mul_f32 v55, v55, v226
    v_fma_f32 v55, v45, v229, v55
    v_mul_f32 v56, v56, v226
    v_fma_f32 v56, v46, v229, v56
    v_mul_f32 v57, v57, v226
    v_fma_f32 v57, v47, v229, v57
    v_cvt_pk_bf16_f32 v60, v54, v55
    v_cvt_pk_bf16_f32 v61, v56, v57
    v_add_u32 v34, 0, v33
    buffer_store_dwordx4 v[58:61], v34, s[20:23], 0 offen
    ds_read_b128 v[40:43], v32 offset:1024
    v_accvgpr_read_b32 v50, a4
    v_accvgpr_read_b32 v51, a5
    v_accvgpr_read_b32 v52, a6
    v_accvgpr_read_b32 v53, a7
    ds_read_b128 v[44:47], v32 offset:4096
    v_accvgpr_read_b32 v54, a16
    v_accvgpr_read_b32 v55, a17
    v_accvgpr_read_b32 v56, a18
    v_accvgpr_read_b32 v57, a19
    s_waitcnt lgkmcnt(0)
    v_mul_f32 v50, v50, v227
    v_fma_f32 v50, v40, v230, v50
    v_mul_f32 v51, v51, v227
    v_fma_f32 v51, v41, v230, v51
    v_mul_f32 v52, v52, v227
    v_fma_f32 v52, v42, v230, v52
    v_mul_f32 v53, v53, v227
    v_fma_f32 v53, v43, v230, v53
    v_cvt_pk_bf16_f32 v58, v50, v51
    v_cvt_pk_bf16_f32 v59, v52, v53
    v_mul_f32 v54, v54, v227
    v_fma_f32 v54, v44, v230, v54
    v_mul_f32 v55, v55, v227
    v_fma_f32 v55, v45, v230, v55
    v_mul_f32 v56, v56, v227
    v_fma_f32 v56, v46, v230, v56
    v_mul_f32 v57, v57, v227
    v_fma_f32 v57, v47, v230, v57
    v_cvt_pk_bf16_f32 v60, v54, v55
    v_cvt_pk_bf16_f32 v61, v56, v57
    v_add_u32 v34, 131072, v33
    buffer_store_dwordx4 v[58:61], v34, s[20:23], 0 offen
    ds_read_b128 v[40:43], v32 offset:2048
    v_accvgpr_read_b32 v50, a8
    v_accvgpr_read_b32 v51, a9
    v_accvgpr_read_b32 v52, a10
    v_accvgpr_read_b32 v53, a11
    ds_read_b128 v[44:47], v32 offset:5120
    v_accvgpr_read_b32 v54, a20
    v_accvgpr_read_b32 v55, a21
    v_accvgpr_read_b32 v56, a22
    v_accvgpr_read_b32 v57, a23
    s_waitcnt lgkmcnt(0)
    v_mul_f32 v50, v50, v228
    v_fma_f32 v50, v40, v231, v50
    v_mul_f32 v51, v51, v228
    v_fma_f32 v51, v41, v231, v51
    v_mul_f32 v52, v52, v228
    v_fma_f32 v52, v42, v231, v52
    v_mul_f32 v53, v53, v228
    v_fma_f32 v53, v43, v231, v53
    v_cvt_pk_bf16_f32 v58, v50, v51
    v_cvt_pk_bf16_f32 v59, v52, v53
    v_mul_f32 v54, v54, v228
    v_fma_f32 v54, v44, v231, v54
    v_mul_f32 v55, v55, v228
    v_fma_f32 v55, v45, v231, v55
    v_mul_f32 v56, v56, v228
    v_fma_f32 v56, v46, v231, v56
    v_mul_f32 v57, v57, v228
    v_fma_f32 v57, v47, v231, v57
    v_cvt_pk_bf16_f32 v60, v54, v55
    v_cvt_pk_bf16_f32 v61, v56, v57
    v_add_u32 v34, 262144, v33
    buffer_store_dwordx4 v[58:61], v34, s[20:23], 0 offen
    ds_read_b128 v[40:43], v32 offset:6144
    v_accvgpr_read_b32 v50, a24
    v_accvgpr_read_b32 v51, a25
    v_accvgpr_read_b32 v52, a26
    v_accvgpr_read_b32 v53, a27
    ds_read_b128 v[44:47], v32 offset:9216
    v_accvgpr_read_b32 v54, a36
    v_accvgpr_read_b32 v55, a37
    v_accvgpr_read_b32 v56, a38
    v_accvgpr_read_b32 v57, a39
    s_waitcnt lgkmcnt(0)
    v_mul_f32 v50, v50, v226
    v_fma_f32 v50, v40, v229, v50
    v_mul_f32 v51, v51, v226
    v_fma_f32 v51, v41, v229, v51
    v_mul_f32 v52, v52, v226
    v_fma_f32 v52, v42, v229, v52
    v_mul_f32 v53, v53, v226
    v_fma_f32 v53, v43, v229, v53
    v_cvt_pk_bf16_f32 v58, v50, v51
    v_cvt_pk_bf16_f32 v59, v52, v53
    v_mul_f32 v54, v54, v226
    v_fma_f32 v54, v44, v229, v54
    v_mul_f32 v55, v55, v226
    v_fma_f32 v55, v45, v229, v55
    v_mul_f32 v56, v56, v226
    v_fma_f32 v56, v46, v229, v56
    v_mul_f32 v57, v57, v226
    v_fma_f32 v57, v47, v229, v57
    v_cvt_pk_bf16_f32 v60, v54, v55
    v_cvt_pk_bf16_f32 v61, v56, v57
    v_add_u32 v34, 1024, v33
    buffer_store_dwordx4 v[58:61], v34, s[20:23], 0 offen
    ds_read_b128 v[40:43], v32 offset:7168
    v_accvgpr_read_b32 v50, a28
    v_accvgpr_read_b32 v51, a29
    v_accvgpr_read_b32 v52, a30
    v_accvgpr_read_b32 v53, a31
    ds_read_b128 v[44:47], v32 offset:10240
    v_accvgpr_read_b32 v54, a40
    v_accvgpr_read_b32 v55, a41
    v_accvgpr_read_b32 v56, a42
    v_accvgpr_read_b32 v57, a43
    s_waitcnt lgkmcnt(0)
    v_mul_f32 v50, v50, v227
    v_fma_f32 v50, v40, v230, v50
    v_mul_f32 v51, v51, v227
    v_fma_f32 v51, v41, v230, v51
    v_mul_f32 v52, v52, v227
    v_fma_f32 v52, v42, v230, v52
    v_mul_f32 v53, v53, v227
    v_fma_f32 v53, v43, v230, v53
    v_cvt_pk_bf16_f32 v58, v50, v51
    v_cvt_pk_bf16_f32 v59, v52, v53
    v_mul_f32 v54, v54, v227
    v_fma_f32 v54, v44, v230, v54
    v_mul_f32 v55, v55, v227
    v_fma_f32 v55, v45, v230, v55
    v_mul_f32 v56, v56, v227
    v_fma_f32 v56, v46, v230, v56
    v_mul_f32 v57, v57, v227
    v_fma_f32 v57, v47, v230, v57
    v_cvt_pk_bf16_f32 v60, v54, v55
    v_cvt_pk_bf16_f32 v61, v56, v57
    v_add_u32 v34, 132096, v33
    buffer_store_dwordx4 v[58:61], v34, s[20:23], 0 offen
    ds_read_b128 v[40:43], v32 offset:8192
    v_accvgpr_read_b32 v50, a32
    v_accvgpr_read_b32 v51, a33
    v_accvgpr_read_b32 v52, a34
    v_accvgpr_read_b32 v53, a35
    ds_read_b128 v[44:47], v32 offset:11264
    v_accvgpr_read_b32 v54, a44
    v_accvgpr_read_b32 v55, a45
    v_accvgpr_read_b32 v56, a46
    v_accvgpr_read_b32 v57, a47
    s_waitcnt lgkmcnt(0)
    v_mul_f32 v50, v50, v228
    v_fma_f32 v50, v40, v231, v50
    v_mul_f32 v51, v51, v228
    v_fma_f32 v51, v41, v231, v51
    v_mul_f32 v52, v52, v228
    v_fma_f32 v52, v42, v231, v52
    v_mul_f32 v53, v53, v228
    v_fma_f32 v53, v43, v231, v53
    v_cvt_pk_bf16_f32 v58, v50, v51
    v_cvt_pk_bf16_f32 v59, v52, v53
    v_mul_f32 v54, v54, v228
    v_fma_f32 v54, v44, v231, v54
    v_mul_f32 v55, v55, v228
    v_fma_f32 v55, v45, v231, v55
    v_mul_f32 v56, v56, v228
    v_fma_f32 v56, v46, v231, v56
    v_mul_f32 v57, v57, v228
    v_fma_f32 v57, v47, v231, v57
    v_cvt_pk_bf16_f32 v60, v54, v55
    v_cvt_pk_bf16_f32 v61, v56, v57
    v_add_u32 v34, 263168, v33
    buffer_store_dwordx4 v[58:61], v34, s[20:23], 0 offen
    ds_read_b128 v[40:43], v32 offset:12288
    v_accvgpr_read_b32 v50, a48
    v_accvgpr_read_b32 v51, a49
    v_accvgpr_read_b32 v52, a50
    v_accvgpr_read_b32 v53, a51
    ds_read_b128 v[44:47], v32 offset:15360
    v_accvgpr_read_b32 v54, a60
    v_accvgpr_read_b32 v55, a61
    v_accvgpr_read_b32 v56, a62
    v_accvgpr_read_b32 v57, a63
    s_waitcnt lgkmcnt(0)
    v_mul_f32 v50, v50, v226
    v_fma_f32 v50, v40, v229, v50
    v_mul_f32 v51, v51, v226
    v_fma_f32 v51, v41, v229, v51
    v_mul_f32 v52, v52, v226
    v_fma_f32 v52, v42, v229, v52
    v_mul_f32 v53, v53, v226
    v_fma_f32 v53, v43, v229, v53
    v_cvt_pk_bf16_f32 v58, v50, v51
    v_cvt_pk_bf16_f32 v59, v52, v53
    v_mul_f32 v54, v54, v226
    v_fma_f32 v54, v44, v229, v54
    v_mul_f32 v55, v55, v226
    v_fma_f32 v55, v45, v229, v55
    v_mul_f32 v56, v56, v226
    v_fma_f32 v56, v46, v229, v56
    v_mul_f32 v57, v57, v226
    v_fma_f32 v57, v47, v229, v57
    v_cvt_pk_bf16_f32 v60, v54, v55
    v_cvt_pk_bf16_f32 v61, v56, v57
    v_add_u32 v34, 2048, v33
    buffer_store_dwordx4 v[58:61], v34, s[20:23], 0 offen
    ds_read_b128 v[40:43], v32 offset:13312
    v_accvgpr_read_b32 v50, a52
    v_accvgpr_read_b32 v51, a53
    v_accvgpr_read_b32 v52, a54
    v_accvgpr_read_b32 v53, a55
    ds_read_b128 v[44:47], v32 offset:16384
    v_accvgpr_read_b32 v54, a64
    v_accvgpr_read_b32 v55, a65
    v_accvgpr_read_b32 v56, a66
    v_accvgpr_read_b32 v57, a67
    s_waitcnt lgkmcnt(0)
    v_mul_f32 v50, v50, v227
    v_fma_f32 v50, v40, v230, v50
    v_mul_f32 v51, v51, v227
    v_fma_f32 v51, v41, v230, v51
    v_mul_f32 v52, v52, v227
    v_fma_f32 v52, v42, v230, v52
    v_mul_f32 v53, v53, v227
    v_fma_f32 v53, v43, v230, v53
    v_cvt_pk_bf16_f32 v58, v50, v51
    v_cvt_pk_bf16_f32 v59, v52, v53
    v_mul_f32 v54, v54, v227
    v_fma_f32 v54, v44, v230, v54
    v_mul_f32 v55, v55, v227
    v_fma_f32 v55, v45, v230, v55
    v_mul_f32 v56, v56, v227
    v_fma_f32 v56, v46, v230, v56
    v_mul_f32 v57, v57, v227
    v_fma_f32 v57, v47, v230, v57
    v_cvt_pk_bf16_f32 v60, v54, v55
    v_cvt_pk_bf16_f32 v61, v56, v57
    v_add_u32 v34, 133120, v33
    buffer_store_dwordx4 v[58:61], v34, s[20:23], 0 offen
    ds_read_b128 v[40:43], v32 offset:14336
    v_accvgpr_read_b32 v50, a56
    v_accvgpr_read_b32 v51, a57
    v_accvgpr_read_b32 v52, a58
    v_accvgpr_read_b32 v53, a59
    ds_read_b128 v[44:47], v32 offset:17408
    v_accvgpr_read_b32 v54, a68
    v_accvgpr_read_b32 v55, a69
    v_accvgpr_read_b32 v56, a70
    v_accvgpr_read_b32 v57, a71
    s_waitcnt lgkmcnt(0)
    v_mul_f32 v50, v50, v228
    v_fma_f32 v50, v40, v231, v50
    v_mul_f32 v51, v51, v228
    v_fma_f32 v51, v41, v231, v51
    v_mul_f32 v52, v52, v228
    v_fma_f32 v52, v42, v231, v52
    v_mul_f32 v53, v53, v228
    v_fma_f32 v53, v43, v231, v53
    v_cvt_pk_bf16_f32 v58, v50, v51
    v_cvt_pk_bf16_f32 v59, v52, v53
    v_mul_f32 v54, v54, v228
    v_fma_f32 v54, v44, v231, v54
    v_mul_f32 v55, v55, v228
    v_fma_f32 v55, v45, v231, v55
    v_mul_f32 v56, v56, v228
    v_fma_f32 v56, v46, v231, v56
    v_mul_f32 v57, v57, v228
    v_fma_f32 v57, v47, v231, v57
    v_cvt_pk_bf16_f32 v60, v54, v55
    v_cvt_pk_bf16_f32 v61, v56, v57
    v_add_u32 v34, 264192, v33
    buffer_store_dwordx4 v[58:61], v34, s[20:23], 0 offen
    ds_read_b128 v[40:43], v32 offset:18432
    v_accvgpr_read_b32 v50, a72
    v_accvgpr_read_b32 v51, a73
    v_accvgpr_read_b32 v52, a74
    v_accvgpr_read_b32 v53, a75
    ds_read_b128 v[44:47], v32 offset:21504
    v_accvgpr_read_b32 v54, a84
    v_accvgpr_read_b32 v55, a85
    v_accvgpr_read_b32 v56, a86
    v_accvgpr_read_b32 v57, a87
    s_waitcnt lgkmcnt(0)
    v_mul_f32 v50, v50, v226
    v_fma_f32 v50, v40, v229, v50
    v_mul_f32 v51, v51, v226
    v_fma_f32 v51, v41, v229, v51
    v_mul_f32 v52, v52, v226
    v_fma_f32 v52, v42, v229, v52
    v_mul_f32 v53, v53, v226
    v_fma_f32 v53, v43, v229, v53
    v_cvt_pk_bf16_f32 v58, v50, v51
    v_cvt_pk_bf16_f32 v59, v52, v53
    v_mul_f32 v54, v54, v226
    v_fma_f32 v54, v44, v229, v54
    v_mul_f32 v55, v55, v226
    v_fma_f32 v55, v45, v229, v55
    v_mul_f32 v56, v56, v226
    v_fma_f32 v56, v46, v229, v56
    v_mul_f32 v57, v57, v226
    v_fma_f32 v57, v47, v229, v57
    v_cvt_pk_bf16_f32 v60, v54, v55
    v_cvt_pk_bf16_f32 v61, v56, v57
    v_add_u32 v34, 3072, v33
    buffer_store_dwordx4 v[58:61], v34, s[20:23], 0 offen
    ds_read_b128 v[40:43], v32 offset:19456
    v_accvgpr_read_b32 v50, a76
    v_accvgpr_read_b32 v51, a77
    v_accvgpr_read_b32 v52, a78
    v_accvgpr_read_b32 v53, a79
    ds_read_b128 v[44:47], v32 offset:22528
    v_accvgpr_read_b32 v54, a88
    v_accvgpr_read_b32 v55, a89
    v_accvgpr_read_b32 v56, a90
    v_accvgpr_read_b32 v57, a91
    s_waitcnt lgkmcnt(0)
    v_mul_f32 v50, v50, v227
    v_fma_f32 v50, v40, v230, v50
    v_mul_f32 v51, v51, v227
    v_fma_f32 v51, v41, v230, v51
    v_mul_f32 v52, v52, v227
    v_fma_f32 v52, v42, v230, v52
    v_mul_f32 v53, v53, v227
    v_fma_f32 v53, v43, v230, v53
    v_cvt_pk_bf16_f32 v58, v50, v51
    v_cvt_pk_bf16_f32 v59, v52, v53
    v_mul_f32 v54, v54, v227
    v_fma_f32 v54, v44, v230, v54
    v_mul_f32 v55, v55, v227
    v_fma_f32 v55, v45, v230, v55
    v_mul_f32 v56, v56, v227
    v_fma_f32 v56, v46, v230, v56
    v_mul_f32 v57, v57, v227
    v_fma_f32 v57, v47, v230, v57
    v_cvt_pk_bf16_f32 v60, v54, v55
    v_cvt_pk_bf16_f32 v61, v56, v57
    v_add_u32 v34, 134144, v33
    buffer_store_dwordx4 v[58:61], v34, s[20:23], 0 offen
    ds_read_b128 v[40:43], v32 offset:20480
    v_accvgpr_read_b32 v50, a80
    v_accvgpr_read_b32 v51, a81
    v_accvgpr_read_b32 v52, a82
    v_accvgpr_read_b32 v53, a83
    ds_read_b128 v[44:47], v32 offset:23552
    v_accvgpr_read_b32 v54, a92
    v_accvgpr_read_b32 v55, a93
    v_accvgpr_read_b32 v56, a94
    v_accvgpr_read_b32 v57, a95
    s_waitcnt lgkmcnt(0)
    v_mul_f32 v50, v50, v228
    v_fma_f32 v50, v40, v231, v50
    v_mul_f32 v51, v51, v228
    v_fma_f32 v51, v41, v231, v51
    v_mul_f32 v52, v52, v228
    v_fma_f32 v52, v42, v231, v52
    v_mul_f32 v53, v53, v228
    v_fma_f32 v53, v43, v231, v53
    v_cvt_pk_bf16_f32 v58, v50, v51
    v_cvt_pk_bf16_f32 v59, v52, v53
    v_mul_f32 v54, v54, v228
    v_fma_f32 v54, v44, v231, v54
    v_mul_f32 v55, v55, v228
    v_fma_f32 v55, v45, v231, v55
    v_mul_f32 v56, v56, v228
    v_fma_f32 v56, v46, v231, v56
    v_mul_f32 v57, v57, v228
    v_fma_f32 v57, v47, v231, v57
    v_cvt_pk_bf16_f32 v60, v54, v55
    v_cvt_pk_bf16_f32 v61, v56, v57
    v_add_u32 v34, 265216, v33
    buffer_store_dwordx4 v[58:61], v34, s[20:23], 0 offen
    ds_read_b128 v[40:43], v32 offset:24576
    v_accvgpr_read_b32 v50, a96
    v_accvgpr_read_b32 v51, a97
    v_accvgpr_read_b32 v52, a98
    v_accvgpr_read_b32 v53, a99
    ds_read_b128 v[44:47], v32 offset:27648
    v_accvgpr_read_b32 v54, a108
    v_accvgpr_read_b32 v55, a109
    v_accvgpr_read_b32 v56, a110
    v_accvgpr_read_b32 v57, a111
    s_waitcnt lgkmcnt(0)
    v_mul_f32 v50, v50, v226
    v_fma_f32 v50, v40, v229, v50
    v_mul_f32 v51, v51, v226
    v_fma_f32 v51, v41, v229, v51
    v_mul_f32 v52, v52, v226
    v_fma_f32 v52, v42, v229, v52
    v_mul_f32 v53, v53, v226
    v_fma_f32 v53, v43, v229, v53
    v_cvt_pk_bf16_f32 v58, v50, v51
    v_cvt_pk_bf16_f32 v59, v52, v53
    v_mul_f32 v54, v54, v226
    v_fma_f32 v54, v44, v229, v54
    v_mul_f32 v55, v55, v226
    v_fma_f32 v55, v45, v229, v55
    v_mul_f32 v56, v56, v226
    v_fma_f32 v56, v46, v229, v56
    v_mul_f32 v57, v57, v226
    v_fma_f32 v57, v47, v229, v57
    v_cvt_pk_bf16_f32 v60, v54, v55
    v_cvt_pk_bf16_f32 v61, v56, v57
    v_add_u32 v34, 4096, v33
    buffer_store_dwordx4 v[58:61], v34, s[20:23], 0 offen
    ds_read_b128 v[40:43], v32 offset:25600
    v_accvgpr_read_b32 v50, a100
    v_accvgpr_read_b32 v51, a101
    v_accvgpr_read_b32 v52, a102
    v_accvgpr_read_b32 v53, a103
    ds_read_b128 v[44:47], v32 offset:28672
    v_accvgpr_read_b32 v54, a112
    v_accvgpr_read_b32 v55, a113
    v_accvgpr_read_b32 v56, a114
    v_accvgpr_read_b32 v57, a115
    s_waitcnt lgkmcnt(0)
    v_mul_f32 v50, v50, v227
    v_fma_f32 v50, v40, v230, v50
    v_mul_f32 v51, v51, v227
    v_fma_f32 v51, v41, v230, v51
    v_mul_f32 v52, v52, v227
    v_fma_f32 v52, v42, v230, v52
    v_mul_f32 v53, v53, v227
    v_fma_f32 v53, v43, v230, v53
    v_cvt_pk_bf16_f32 v58, v50, v51
    v_cvt_pk_bf16_f32 v59, v52, v53
    v_mul_f32 v54, v54, v227
    v_fma_f32 v54, v44, v230, v54
    v_mul_f32 v55, v55, v227
    v_fma_f32 v55, v45, v230, v55
    v_mul_f32 v56, v56, v227
    v_fma_f32 v56, v46, v230, v56
    v_mul_f32 v57, v57, v227
    v_fma_f32 v57, v47, v230, v57
    v_cvt_pk_bf16_f32 v60, v54, v55
    v_cvt_pk_bf16_f32 v61, v56, v57
    v_add_u32 v34, 135168, v33
    buffer_store_dwordx4 v[58:61], v34, s[20:23], 0 offen
    ds_read_b128 v[40:43], v32 offset:26624
    v_accvgpr_read_b32 v50, a104
    v_accvgpr_read_b32 v51, a105
    v_accvgpr_read_b32 v52, a106
    v_accvgpr_read_b32 v53, a107
    ds_read_b128 v[44:47], v32 offset:29696
    v_accvgpr_read_b32 v54, a116
    v_accvgpr_read_b32 v55, a117
    v_accvgpr_read_b32 v56, a118
    v_accvgpr_read_b32 v57, a119
    s_waitcnt lgkmcnt(0)
    v_mul_f32 v50, v50, v228
    v_fma_f32 v50, v40, v231, v50
    v_mul_f32 v51, v51, v228
    v_fma_f32 v51, v41, v231, v51
    v_mul_f32 v52, v52, v228
    v_fma_f32 v52, v42, v231, v52
    v_mul_f32 v53, v53, v228
    v_fma_f32 v53, v43, v231, v53
    v_cvt_pk_bf16_f32 v58, v50, v51
    v_cvt_pk_bf16_f32 v59, v52, v53
    v_mul_f32 v54, v54, v228
    v_fma_f32 v54, v44, v231, v54
    v_mul_f32 v55, v55, v228
    v_fma_f32 v55, v45, v231, v55
    v_mul_f32 v56, v56, v228
    v_fma_f32 v56, v46, v231, v56
    v_mul_f32 v57, v57, v228
    v_fma_f32 v57, v47, v231, v57
    v_cvt_pk_bf16_f32 v60, v54, v55
    v_cvt_pk_bf16_f32 v61, v56, v57
    v_add_u32 v34, 266240, v33
    buffer_store_dwordx4 v[58:61], v34, s[20:23], 0 offen
    ds_read_b128 v[40:43], v32 offset:30720
    v_accvgpr_read_b32 v50, a120
    v_accvgpr_read_b32 v51, a121
    v_accvgpr_read_b32 v52, a122
    v_accvgpr_read_b32 v53, a123
    ds_read_b128 v[44:47], v32 offset:33792
    v_accvgpr_read_b32 v54, a132
    v_accvgpr_read_b32 v55, a133
    v_accvgpr_read_b32 v56, a134
    v_accvgpr_read_b32 v57, a135
    s_waitcnt lgkmcnt(0)
    v_mul_f32 v50, v50, v226
    v_fma_f32 v50, v40, v229, v50
    v_mul_f32 v51, v51, v226
    v_fma_f32 v51, v41, v229, v51
    v_mul_f32 v52, v52, v226
    v_fma_f32 v52, v42, v229, v52
    v_mul_f32 v53, v53, v226
    v_fma_f32 v53, v43, v229, v53
    v_cvt_pk_bf16_f32 v58, v50, v51
    v_cvt_pk_bf16_f32 v59, v52, v53
    v_mul_f32 v54, v54, v226
    v_fma_f32 v54, v44, v229, v54
    v_mul_f32 v55, v55, v226
    v_fma_f32 v55, v45, v229, v55
    v_mul_f32 v56, v56, v226
    v_fma_f32 v56, v46, v229, v56
    v_mul_f32 v57, v57, v226
    v_fma_f32 v57, v47, v229, v57
    v_cvt_pk_bf16_f32 v60, v54, v55
    v_cvt_pk_bf16_f32 v61, v56, v57
    v_add_u32 v34, 5120, v33
    buffer_store_dwordx4 v[58:61], v34, s[20:23], 0 offen
    ds_read_b128 v[40:43], v32 offset:31744
    v_accvgpr_read_b32 v50, a124
    v_accvgpr_read_b32 v51, a125
    v_accvgpr_read_b32 v52, a126
    v_accvgpr_read_b32 v53, a127
    ds_read_b128 v[44:47], v32 offset:34816
    v_accvgpr_read_b32 v54, a136
    v_accvgpr_read_b32 v55, a137
    v_accvgpr_read_b32 v56, a138
    v_accvgpr_read_b32 v57, a139
    s_waitcnt lgkmcnt(0)
    v_mul_f32 v50, v50, v227
    v_fma_f32 v50, v40, v230, v50
    v_mul_f32 v51, v51, v227
    v_fma_f32 v51, v41, v230, v51
    v_mul_f32 v52, v52, v227
    v_fma_f32 v52, v42, v230, v52
    v_mul_f32 v53, v53, v227
    v_fma_f32 v53, v43, v230, v53
    v_cvt_pk_bf16_f32 v58, v50, v51
    v_cvt_pk_bf16_f32 v59, v52, v53
    v_mul_f32 v54, v54, v227
    v_fma_f32 v54, v44, v230, v54
    v_mul_f32 v55, v55, v227
    v_fma_f32 v55, v45, v230, v55
    v_mul_f32 v56, v56, v227
    v_fma_f32 v56, v46, v230, v56
    v_mul_f32 v57, v57, v227
    v_fma_f32 v57, v47, v230, v57
    v_cvt_pk_bf16_f32 v60, v54, v55
    v_cvt_pk_bf16_f32 v61, v56, v57
    v_add_u32 v34, 136192, v33
    buffer_store_dwordx4 v[58:61], v34, s[20:23], 0 offen
    ds_read_b128 v[40:43], v32 offset:32768
    v_accvgpr_read_b32 v50, a128
    v_accvgpr_read_b32 v51, a129
    v_accvgpr_read_b32 v52, a130
    v_accvgpr_read_b32 v53, a131
    ds_read_b128 v[44:47], v32 offset:35840
    v_accvgpr_read_b32 v54, a140
    v_accvgpr_read_b32 v55, a141
    v_accvgpr_read_b32 v56, a142
    v_accvgpr_read_b32 v57, a143
    s_waitcnt lgkmcnt(0)
    v_mul_f32 v50, v50, v228
    v_fma_f32 v50, v40, v231, v50
    v_mul_f32 v51, v51, v228
    v_fma_f32 v51, v41, v231, v51
    v_mul_f32 v52, v52, v228
    v_fma_f32 v52, v42, v231, v52
    v_mul_f32 v53, v53, v228
    v_fma_f32 v53, v43, v231, v53
    v_cvt_pk_bf16_f32 v58, v50, v51
    v_cvt_pk_bf16_f32 v59, v52, v53
    v_mul_f32 v54, v54, v228
    v_fma_f32 v54, v44, v231, v54
    v_mul_f32 v55, v55, v228
    v_fma_f32 v55, v45, v231, v55
    v_mul_f32 v56, v56, v228
    v_fma_f32 v56, v46, v231, v56
    v_mul_f32 v57, v57, v228
    v_fma_f32 v57, v47, v231, v57
    v_cvt_pk_bf16_f32 v60, v54, v55
    v_cvt_pk_bf16_f32 v61, v56, v57
    v_add_u32 v34, 267264, v33
    buffer_store_dwordx4 v[58:61], v34, s[20:23], 0 offen
    ds_read_b128 v[40:43], v32 offset:36864
    v_accvgpr_read_b32 v50, a144
    v_accvgpr_read_b32 v51, a145
    v_accvgpr_read_b32 v52, a146
    v_accvgpr_read_b32 v53, a147
    ds_read_b128 v[44:47], v32 offset:39936
    v_accvgpr_read_b32 v54, a156
    v_accvgpr_read_b32 v55, a157
    v_accvgpr_read_b32 v56, a158
    v_accvgpr_read_b32 v57, a159
    s_waitcnt lgkmcnt(0)
    v_mul_f32 v50, v50, v226
    v_fma_f32 v50, v40, v229, v50
    v_mul_f32 v51, v51, v226
    v_fma_f32 v51, v41, v229, v51
    v_mul_f32 v52, v52, v226
    v_fma_f32 v52, v42, v229, v52
    v_mul_f32 v53, v53, v226
    v_fma_f32 v53, v43, v229, v53
    v_cvt_pk_bf16_f32 v58, v50, v51
    v_cvt_pk_bf16_f32 v59, v52, v53
    v_mul_f32 v54, v54, v226
    v_fma_f32 v54, v44, v229, v54
    v_mul_f32 v55, v55, v226
    v_fma_f32 v55, v45, v229, v55
    v_mul_f32 v56, v56, v226
    v_fma_f32 v56, v46, v229, v56
    v_mul_f32 v57, v57, v226
    v_fma_f32 v57, v47, v229, v57
    v_cvt_pk_bf16_f32 v60, v54, v55
    v_cvt_pk_bf16_f32 v61, v56, v57
    v_add_u32 v34, 6144, v33
    buffer_store_dwordx4 v[58:61], v34, s[20:23], 0 offen
    ds_read_b128 v[40:43], v32 offset:37888
    v_accvgpr_read_b32 v50, a148
    v_accvgpr_read_b32 v51, a149
    v_accvgpr_read_b32 v52, a150
    v_accvgpr_read_b32 v53, a151
    ds_read_b128 v[44:47], v32 offset:40960
    v_accvgpr_read_b32 v54, a160
    v_accvgpr_read_b32 v55, a161
    v_accvgpr_read_b32 v56, a162
    v_accvgpr_read_b32 v57, a163
    s_waitcnt lgkmcnt(0)
    v_mul_f32 v50, v50, v227
    v_fma_f32 v50, v40, v230, v50
    v_mul_f32 v51, v51, v227
    v_fma_f32 v51, v41, v230, v51
    v_mul_f32 v52, v52, v227
    v_fma_f32 v52, v42, v230, v52
    v_mul_f32 v53, v53, v227
    v_fma_f32 v53, v43, v230, v53
    v_cvt_pk_bf16_f32 v58, v50, v51
    v_cvt_pk_bf16_f32 v59, v52, v53
    v_mul_f32 v54, v54, v227
    v_fma_f32 v54, v44, v230, v54
    v_mul_f32 v55, v55, v227
    v_fma_f32 v55, v45, v230, v55
    v_mul_f32 v56, v56, v227
    v_fma_f32 v56, v46, v230, v56
    v_mul_f32 v57, v57, v227
    v_fma_f32 v57, v47, v230, v57
    v_cvt_pk_bf16_f32 v60, v54, v55
    v_cvt_pk_bf16_f32 v61, v56, v57
    v_add_u32 v34, 137216, v33
    buffer_store_dwordx4 v[58:61], v34, s[20:23], 0 offen
    ds_read_b128 v[40:43], v32 offset:38912
    v_accvgpr_read_b32 v50, a152
    v_accvgpr_read_b32 v51, a153
    v_accvgpr_read_b32 v52, a154
    v_accvgpr_read_b32 v53, a155
    ds_read_b128 v[44:47], v32 offset:41984
    v_accvgpr_read_b32 v54, a164
    v_accvgpr_read_b32 v55, a165
    v_accvgpr_read_b32 v56, a166
    v_accvgpr_read_b32 v57, a167
    s_waitcnt lgkmcnt(0)
    v_mul_f32 v50, v50, v228
    v_fma_f32 v50, v40, v231, v50
    v_mul_f32 v51, v51, v228
    v_fma_f32 v51, v41, v231, v51
    v_mul_f32 v52, v52, v228
    v_fma_f32 v52, v42, v231, v52
    v_mul_f32 v53, v53, v228
    v_fma_f32 v53, v43, v231, v53
    v_cvt_pk_bf16_f32 v58, v50, v51
    v_cvt_pk_bf16_f32 v59, v52, v53
    v_mul_f32 v54, v54, v228
    v_fma_f32 v54, v44, v231, v54
    v_mul_f32 v55, v55, v228
    v_fma_f32 v55, v45, v231, v55
    v_mul_f32 v56, v56, v228
    v_fma_f32 v56, v46, v231, v56
    v_mul_f32 v57, v57, v228
    v_fma_f32 v57, v47, v231, v57
    v_cvt_pk_bf16_f32 v60, v54, v55
    v_cvt_pk_bf16_f32 v61, v56, v57
    v_add_u32 v34, 268288, v33
    buffer_store_dwordx4 v[58:61], v34, s[20:23], 0 offen
    ds_read_b128 v[40:43], v32 offset:43008
    v_accvgpr_read_b32 v50, a168
    v_accvgpr_read_b32 v51, a169
    v_accvgpr_read_b32 v52, a170
    v_accvgpr_read_b32 v53, a171
    ds_read_b128 v[44:47], v32 offset:46080
    v_accvgpr_read_b32 v54, a180
    v_accvgpr_read_b32 v55, a181
    v_accvgpr_read_b32 v56, a182
    v_accvgpr_read_b32 v57, a183
    s_waitcnt lgkmcnt(0)
    v_mul_f32 v50, v50, v226
    v_fma_f32 v50, v40, v229, v50
    v_mul_f32 v51, v51, v226
    v_fma_f32 v51, v41, v229, v51
    v_mul_f32 v52, v52, v226
    v_fma_f32 v52, v42, v229, v52
    v_mul_f32 v53, v53, v226
    v_fma_f32 v53, v43, v229, v53
    v_cvt_pk_bf16_f32 v58, v50, v51
    v_cvt_pk_bf16_f32 v59, v52, v53
    v_mul_f32 v54, v54, v226
    v_fma_f32 v54, v44, v229, v54
    v_mul_f32 v55, v55, v226
    v_fma_f32 v55, v45, v229, v55
    v_mul_f32 v56, v56, v226
    v_fma_f32 v56, v46, v229, v56
    v_mul_f32 v57, v57, v226
    v_fma_f32 v57, v47, v229, v57
    v_cvt_pk_bf16_f32 v60, v54, v55
    v_cvt_pk_bf16_f32 v61, v56, v57
    v_add_u32 v34, 7168, v33
    buffer_store_dwordx4 v[58:61], v34, s[20:23], 0 offen
    ds_read_b128 v[40:43], v32 offset:44032
    v_accvgpr_read_b32 v50, a172
    v_accvgpr_read_b32 v51, a173
    v_accvgpr_read_b32 v52, a174
    v_accvgpr_read_b32 v53, a175
    ds_read_b128 v[44:47], v32 offset:47104
    v_accvgpr_read_b32 v54, a184
    v_accvgpr_read_b32 v55, a185
    v_accvgpr_read_b32 v56, a186
    v_accvgpr_read_b32 v57, a187
    s_waitcnt lgkmcnt(0)
    v_mul_f32 v50, v50, v227
    v_fma_f32 v50, v40, v230, v50
    v_mul_f32 v51, v51, v227
    v_fma_f32 v51, v41, v230, v51
    v_mul_f32 v52, v52, v227
    v_fma_f32 v52, v42, v230, v52
    v_mul_f32 v53, v53, v227
    v_fma_f32 v53, v43, v230, v53
    v_cvt_pk_bf16_f32 v58, v50, v51
    v_cvt_pk_bf16_f32 v59, v52, v53
    v_mul_f32 v54, v54, v227
    v_fma_f32 v54, v44, v230, v54
    v_mul_f32 v55, v55, v227
    v_fma_f32 v55, v45, v230, v55
    v_mul_f32 v56, v56, v227
    v_fma_f32 v56, v46, v230, v56
    v_mul_f32 v57, v57, v227
    v_fma_f32 v57, v47, v230, v57
    v_cvt_pk_bf16_f32 v60, v54, v55
    v_cvt_pk_bf16_f32 v61, v56, v57
    v_add_u32 v34, 138240, v33
    buffer_store_dwordx4 v[58:61], v34, s[20:23], 0 offen
    ds_read_b128 v[40:43], v32 offset:45056
    v_accvgpr_read_b32 v50, a176
    v_accvgpr_read_b32 v51, a177
    v_accvgpr_read_b32 v52, a178
    v_accvgpr_read_b32 v53, a179
    ds_read_b128 v[44:47], v32 offset:48128
    v_accvgpr_read_b32 v54, a188
    v_accvgpr_read_b32 v55, a189
    v_accvgpr_read_b32 v56, a190
    v_accvgpr_read_b32 v57, a191
    s_waitcnt lgkmcnt(0)
    v_mul_f32 v50, v50, v228
    v_fma_f32 v50, v40, v231, v50
    v_mul_f32 v51, v51, v228
    v_fma_f32 v51, v41, v231, v51
    v_mul_f32 v52, v52, v228
    v_fma_f32 v52, v42, v231, v52
    v_mul_f32 v53, v53, v228
    v_fma_f32 v53, v43, v231, v53
    v_cvt_pk_bf16_f32 v58, v50, v51
    v_cvt_pk_bf16_f32 v59, v52, v53
    v_mul_f32 v54, v54, v228
    v_fma_f32 v54, v44, v231, v54
    v_mul_f32 v55, v55, v228
    v_fma_f32 v55, v45, v231, v55
    v_mul_f32 v56, v56, v228
    v_fma_f32 v56, v46, v231, v56
    v_mul_f32 v57, v57, v228
    v_fma_f32 v57, v47, v231, v57
    v_cvt_pk_bf16_f32 v60, v54, v55
    v_cvt_pk_bf16_f32 v61, v56, v57
    v_add_u32 v34, 269312, v33
    buffer_store_dwordx4 v[58:61], v34, s[20:23], 0 offen
    s_waitcnt vmcnt(0)
L_attn_end:
    s_endpgm
.section .rodata,"a"
.p2align 6
.amdhsa_kernel attn_kernel
  .amdhsa_next_free_vgpr 512
  .amdhsa_next_free_sgpr 102
  .amdhsa_accum_offset 256
  .amdhsa_group_segment_fixed_size 0
  .amdhsa_kernarg_size 104
  .amdhsa_user_sgpr_count 2
  .amdhsa_user_sgpr_kernarg_segment_ptr 1
  .amdhsa_system_sgpr_workgroup_id_x 1
.end_amdhsa_kernel
.text
.globl oproj_kernel
.p2align 8
.type oproj_kernel,@function
oproj_kernel:
    s_cmp_ge_u32 s2, 224
    s_cbranch_scc1 L_op_end
    s_and_b32 s24, s2, 7
    s_lshr_b32 s25, s2, 3
    s_mul_i32 s26, s25, 9363
    s_lshr_b32 s26, s26, 16
    s_mul_i32 s27, s26, 7
    s_sub_u32 s27, s25, s27
    s_lshl_b32 s24, s24, 2
    s_add_u32 s24, s24, s26
    s_and_b32 s26, s24, 15
    s_lshr_b32 s24, s24, 4
    s_mul_i32 s31, s24, 40
    s_add_u32 s32, s0, s31
    s_addc_u32 s33, s1, 0
    s_load_dwordx2 s[4:5], s[32:33], 32
    s_load_dwordx2 s[8:9], s[0:1], 96
    s_load_dwordx2 s[12:13], s[0:1], 80
    v_lshrrev_b32 v1, 6, v0
    s_nop 0
    v_readfirstlane_b32 s34, v1
    s_waitcnt lgkmcnt(0)
    s_lshl_b32 s35, s27, 7
    s_add_u32 s4, s4, s35
    s_addc_u32 s5, s5, 0
    s_and_b32 s5, s5, 0xffff
    s_sub_u32 s6, 3670016, s35
    s_mov_b32 s7, 0x00020000
    s_mul_i32 s36, s24, 6291456
    s_mul_i32 s37, s26, 393216
    s_add_u32 s36, s36, s37
    s_add_u32 s8, s8, s36
    s_addc_u32 s9, s9, 0
    s_and_b32 s9, s9, 0xffff
    s_mov_b32 s10, 393216
    s_mov_b32 s11, 0x00020000
    s_mul_i32 s36, s26, 86016
    s_mul_i32 s37, s24, 896
    s_add_u32 s36, s36, s37
    s_add_u32 s36, s36, s35
    s_add_u32 s12, s12, s36
    s_addc_u32 s13, s13, 0
    s_and_b32 s13, s13, 0xffff
    s_sub_u32 s14, 1376256, s36
    s_mov_b32 s15, 0x00020000
    v_and_b32 v1, 63, v0
    v_and_b32 v2, 15, v1
    v_lshrrev_b32 v3, 4, v1
    v_lshrrev_b32 v30, 3, v1
    v_and_b32 v31, 7, v1
    v_lshrrev_b32 v32, 1, v30
    v_and_b32 v32, 3, v32
    v_lshlrev_b32 v32, 1, v32
    v_xor_b32 v32, v31, v32
    v_lshlrev_b32 v32, 4, v32
    v_mul_u32_u24 v33, 896, v30
    v_add_u32 v4, v32, v33
    v_lshrrev_b32 v32, 1, v30
    v_and_b32 v32, 3, v32
    v_lshlrev_b32 v32, 1, v32
    v_xor_b32 v32, v31, v32
    v_lshlrev_b32 v32, 4, v32
    v_mul_u32_u24 v33, 896, v30
    v_add_u32 v5, v32, v33
    v_lshrrev_b32 v32, 1, v30
    v_and_b32 v32, 3, v32
    v_lshlrev_b32 v32, 1, v32
    v_xor_b32 v32, v31, v32
    v_lshlrev_b32 v32, 4, v32
    v_mul_u32_u24 v33, 896, v30
    v_add_u32 v6, v32, v33
    v_lshrrev_b32 v32, 1, v30
    v_and_b32 v32, 3, v32
    v_lshlrev_b32 v32, 1, v32
    v_xor_b32 v32, v31, v32
    v_lshlrev_b32 v32, 4, v32
    v_mul_u32_u24 v33, 896, v30
    v_add_u32 v7, v32, v33
    v_lshrrev_b32 v33, 2, v2
    v_lshl_add_u32 v34, v3, 2, v33
    v_lshrrev_b32 v35, 1, v34
    v_and_b32 v35, 3, v35
    v_lshlrev_b32 v34, 7, v34
    s_lshl_b32 s40, s34, 15
    v_add_u32 v34, s40, v34
    v_and_b32 v36, 3, v2
    v_lshl_add_u32 v34, v36, 3, v34
    v_xor_b32 v36, 0, v35
    v_lshl_add_u32 v8, v36, 5, v34
    v_xor_b32 v36, 1, v35
    v_lshl_add_u32 v9, v36, 5, v34
    v_xor_b32 v36, 2, v35
    v_lshl_add_u32 v10, v36, 5, v34
    v_xor_b32 v36, 3, v35
    v_lshl_add_u32 v11, v36, 5, v34
    v_lshlrev_b32 v12, 4, v1
    s_lshl_b32 s41, s34, 15
    v_add_u32 v12, s41, v12
    s_mul_i32 s42, s34, 917504
    v_mov_b32 v64, 0
    v_mov_b32 v65, 0
    v_mov_b32 v66, 0
    v_mov_b32 v67, 0
    v_mov_b32 v68, 0
    v_mov_b32 v69, 0
    v_mov_b32 v70, 0
    v_mov_b32 v71, 0
    v_mov_b32 v72, 0
    v_mov_b32 v73, 0
    v_mov_b32 v74, 0
    v_mov_b32 v75, 0
    v_mov_b32 v76, 0
    v_mov_b32 v77, 0
    v_mov_b32 v78, 0
    v_mov_b32 v79, 0
    v_mov_b32 v80, 0
    v_mov_b32 v81, 0
    v_mov_b32 v82, 0
    v_mov_b32 v83, 0
    v_mov_b32 v84, 0
    v_mov_b32 v85, 0
    v_mov_b32 v86, 0
    v_mov_b32 v87, 0
    v_mov_b32 v88, 0
    v_mov_b32 v89, 0
    v_mov_b32 v90, 0
    v_mov_b32 v91, 0
    v_mov_b32 v92, 0
    v_mov_b32 v93, 0
    v_mov_b32 v94, 0
    v_mov_b32 v95, 0
    v_mov_b32 v96, 0
    v_mov_b32 v97, 0
    v_mov_b32 v98, 0
    v_mov_b32 v99, 0
    v_mov_b32 v100, 0
    v_mov_b32 v101, 0
    v_mov_b32 v102, 0
    v_mov_b32 v103, 0
    v_mov_b32 v104, 0
    v_mov_b32 v105, 0
    v_mov_b32 v106, 0
    v_mov_b32 v107, 0
    v_mov_b32 v108, 0
    v_mov_b32 v109, 0
    v_mov_b32 v110, 0
    v_mov_b32 v111, 0
    v_add_u32 v13, 131072, v12
    v_add_u32 v14, 262144, v12
    s_add_u32 s43, s40, 0
    s_add_u32 s44, s42, 0
    s_mov_b32 m0, s43
    s_nop 0
    buffer_load_dwordx4 v4, s[4:7], s44 offen lds
    s_add_u32 s43, s43, 1024
    s_add_u32 s44, s44, 7168
    s_mov_b32 m0, s43
    s_nop 0
    buffer_load_dwordx4 v5, s[4:7], s44 offen lds
    s_add_u32 s43, s43, 1024
    s_add_u32 s44, s44, 7168
    s_mov_b32 m0, s43
    s_nop 0
    buffer_load_dwordx4 v6, s[4:7], s44 offen lds
    s_add_u32 s43, s43, 1024
    s_add_u32 s44, s44, 7168
    s_mov_b32 m0, s43
    s_nop 0
    buffer_load_dwordx4 v7, s[4:7], s44 offen lds
    s_mov_b32 s45, 0
    buffer_load_dwordx4 v[144:147], v12, s[8:11], s45 offen offset:0
    buffer_load_dwordx4 v[148:151], v13, s[8:11], s45 offen offset:0
    buffer_load_dwordx4 v[152:155], v14, s[8:11], s45 offen offset:0
    s_add_u32 s43, s40, 4096
    s_add_u32 s44, s42, 28672
    s_mov_b32 m0, s43
    s_nop 0
    buffer_load_dwordx4 v4, s[4:7], s44 offen lds
    s_add_u32 s43, s43, 1024
    s_add_u32 s44, s44, 7168
    s_mov_b32 m0, s43
    s_nop 0
    buffer_load_dwordx4 v5, s[4:7], s44 offen lds
    s_add_u32 s43, s43, 1024
    s_add_u32 s44, s44, 7168
    s_mov_b32 m0, s43
    s_nop 0
    buffer_load_dwordx4 v6, s[4:7], s44 offen lds
    s_add_u32 s43, s43, 1024
    s_add_u32 s44, s44, 7168
    s_mov_b32 m0, s43
    s_nop 0
    buffer_load_dwordx4 v7, s[4:7], s44 offen lds
    s_mov_b32 s45, 0
    buffer_load_dwordx4 v[156:159], v12, s[8:11], s45 offen offset:1024
    buffer_load_dwordx4 v[160:163], v13, s[8:11], s45 offen offset:1024
    buffer_load_dwordx4 v[164:167], v14, s[8:11], s45 offen offset:1024
    s_add_u32 s43, s40, 8192
    s_add_u32 s44, s42, 57344
    s_mov_b32 m0, s43
    s_nop 0
    buffer_load_dwordx4 v4, s[4:7], s44 offen lds
    s_add_u32 s43, s43, 1024
    s_add_u32 s44, s44, 7168
    s_mov_b32 m0, s43
    s_nop 0
    buffer_load_dwordx4 v5, s[4:7], s44 offen lds
    s_add_u32 s43, s43, 1024
    s_add_u32 s44, s44, 7168
    s_mov_b32 m0, s43
    s_nop 0
    buffer_load_dwordx4 v6, s[4:7], s44 offen lds
    s_add_u32 s43, s43, 1024
    s_add_u32 s44, s44, 7168
    s_mov_b32 m0, s43
    s_nop 0
    buffer_load_dwordx4 v7, s[4:7], s44 offen lds
    s_mov_b32 s45, 0
    buffer_load_dwordx4 v[168:171], v12, s[8:11], s45 offen offset:2048
    buffer_load_dwordx4 v[172:175], v13, s[8:11], s45 offen offset:2048
    buffer_load_dwordx4 v[176:179], v14, s[8:11], s45 offen offset:2048
    s_add_u32 s43, s40, 12288
    s_add_u32 s44, s42, 86016
    s_mov_b32 m0, s43
    s_nop 0
    buffer_load_dwordx4 v4, s[4:7], s44 offen lds
    s_add_u32 s43, s43, 1024
    s_add_u32 s44, s44, 7168
    s_mov_b32 m0, s43
    s_nop 0
    buffer_load_dwordx4 v5, s[4:7], s44 offen lds
    s_add_u32 s43, s43, 1024
    s_add_u32 s44, s44, 7168
    s_mov_b32 m0, s43
    s_nop 0
    buffer_load_dwordx4 v6, s[4:7], s44 offen lds
    s_add_u32 s43, s43, 1024
    s_add_u32 s44, s44, 7168
    s_mov_b32 m0, s43
    s_nop 0
    buffer_load_dwordx4 v7, s[4:7], s44 offen lds
    s_mov_b32 s45, 0
    buffer_load_dwordx4 v[180:183], v12, s[8:11], s45 offen offset:3072
    buffer_load_dwordx4 v[184:187], v13, s[8:11], s45 offen offset:3072
    buffer_load_dwordx4 v[188:191], v14, s[8:11], s45 offen offset:3072
    s_add_u32 s43, s40, 16384
    s_add_u32 s44, s42, 114688
    s_mov_b32 m0, s43
    s_nop 0
    buffer_load_dwordx4 v4, s[4:7], s44 offen lds
    s_add_u32 s43, s43, 1024
    s_add_u32 s44, s44, 7168
    s_mov_b32 m0, s43
    s_nop 0
    buffer_load_dwordx4 v5, s[4:7], s44 offen lds
    s_add_u32 s43, s43, 1024
    s_add_u32 s44, s44, 7168
    s_mov_b32 m0, s43
    s_nop 0
    buffer_load_dwordx4 v6, s[4:7], s44 offen lds
    s_add_u32 s43, s43, 1024
    s_add_u32 s44, s44, 7168
    s_mov_b32 m0, s43
    s_nop 0
    buffer_load_dwordx4 v7, s[4:7], s44 offen lds
    s_mov_b32 s45, 4096
    buffer_load_dwordx4 v[192:195], v12, s[8:11], s45 offen offset:0
    buffer_load_dwordx4 v[196:199], v13, s[8:11], s45 offen offset:0
    buffer_load_dwordx4 v[200:203], v14, s[8:11], s45 offen offset:0
    s_add_u32 s43, s40, 20480
    s_add_u32 s44, s42, 143360
    s_mov_b32 m0, s43
    s_nop 0
    buffer_load_dwordx4 v4, s[4:7], s44 offen lds
    s_add_u32 s43, s43, 1024
    s_add_u32 s44, s44, 7168
    s_mov_b32 m0, s43
    s_nop 0
    buffer_load_dwordx4 v5, s[4:7], s44 offen lds
    s_add_u32 s43, s43, 1024
    s_add_u32 s44, s44, 7168
    s_mov_b32 m0, s43
    s_nop 0
    buffer_load_dwordx4 v6, s[4:7], s44 offen lds
    s_add_u32 s43, s43, 1024
    s_add_u32 s44, s44, 7168
    s_mov_b32 m0, s43
    s_nop 0
    buffer_load_dwordx4 v7, s[4:7], s44 offen lds
    s_mov_b32 s45, 4096
    buffer_load_dwordx4 v[204:207], v12, s[8:11], s45 offen offset:1024
    buffer_load_dwordx4 v[208:211], v13, s[8:11], s45 offen offset:1024
    buffer_load_dwordx4 v[212:215], v14, s[8:11], s45 offen offset:1024
    s_add_u32 s43, s40, 24576
    s_add_u32 s44, s42, 172032
    s_mov_b32 m0, s43
    s_nop 0
    buffer_load_dwordx4 v4, s[4:7], s44 offen lds
    s_add_u32 s43, s43, 1024
    s_add_u32 s44, s44, 7168
    s_mov_b32 m0, s43
    s_nop 0
    buffer_load_dwordx4 v5, s[4:7], s44 offen lds
    s_add_u32 s43, s43, 1024
    s_add_u32 s44, s44, 7168
    s_mov_b32 m0, s43
    s_nop 0
    buffer_load_dwordx4 v6, s[4:7], s44 offen lds
    s_add_u32 s43, s43, 1024
    s_add_u32 s44, s44, 7168
    s_mov_b32 m0, s43
    s_nop 0
    buffer_load_dwordx4 v7, s[4:7], s44 offen lds
    s_mov_b32 s45, 4096
    buffer_load_dwordx4 v[216:219], v12, s[8:11], s45 offen offset:2048
    buffer_load_dwordx4 v[220:223], v13, s[8:11], s45 offen offset:2048
    buffer_load_dwordx4 v[224:227], v14, s[8:11], s45 offen offset:2048
    s_add_u32 s43, s40, 28672
    s_add_u32 s44, s42, 200704
    s_mov_b32 m0, s43
    s_nop 0
    buffer_load_dwordx4 v4, s[4:7], s44 offen lds
    s_add_u32 s43, s43, 1024
    s_add_u32 s44, s44, 7168
    s_mov_b32 m0, s43
    s_nop 0
    buffer_load_dwordx4 v5, s[4:7], s44 offen lds
    s_add_u32 s43, s43, 1024
    s_add_u32 s44, s44, 7168
    s_mov_b32 m0, s43
    s_nop 0
    buffer_load_dwordx4 v6, s[4:7], s44 offen lds
    s_add_u32 s43, s43, 1024
    s_add_u32 s44, s44, 7168
    s_mov_b32 m0, s43
    s_nop 0
    buffer_load_dwordx4 v7, s[4:7], s44 offen lds
    s_mov_b32 s45, 4096
    buffer_load_dwordx4 v[228:231], v12, s[8:11], s45 offen offset:3072
    buffer_load_dwordx4 v[232:235], v13, s[8:11], s45 offen offset:3072
    buffer_load_dwordx4 v[236:239], v14, s[8:11], s45 offen offset:3072
    s_waitcnt vmcnt(49)
    ds_read_b64_tr_b16 v[112:113], v8 offset:0
    ds_read_b64_tr_b16 v[114:115], v8 offset:2048
    ds_read_b64_tr_b16 v[116:117], v9 offset:0
    ds_read_b64_tr_b16 v[118:119], v9 offset:2048
    ds_read_b64_tr_b16 v[120:121], v10 offset:0
    ds_read_b64_tr_b16 v[122:123], v10 offset:2048
    ds_read_b64_tr_b16 v[124:125], v11 offset:0
    ds_read_b64_tr_b16 v[126:127], v11 offset:2048
    s_waitcnt lgkmcnt(0)
    v_mfma_f32_16x16x32_bf16 v[64:67], v[112:115], v[144:147], v[64:67]
    v_mfma_f32_16x16x32_bf16 v[68:71], v[112:115], v[148:151], v[68:71]
    v_mfma_f32_16x16x32_bf16 v[72:75], v[112:115], v[152:155], v[72:75]
    v_mfma_f32_16x16x32_bf16 v[76:79], v[116:119], v[144:147], v[76:79]
    v_mfma_f32_16x16x32_bf16 v[80:83], v[116:119], v[148:151], v[80:83]
    v_mfma_f32_16x16x32_bf16 v[84:87], v[116:119], v[152:155], v[84:87]
    v_mfma_f32_16x16x32_bf16 v[88:91], v[120:123], v[144:147], v[88:91]
    v_mfma_f32_16x16x32_bf16 v[92:95], v[120:123], v[148:151], v[92:95]
    v_mfma_f32_16x16x32_bf16 v[96:99], v[120:123], v[152:155], v[96:99]
    v_mfma_f32_16x16x32_bf16 v[100:103], v[124:127], v[144:147], v[100:103]
    v_mfma_f32_16x16x32_bf16 v[104:107], v[124:127], v[148:151], v[104:107]
    v_mfma_f32_16x16x32_bf16 v[108:111], v[124:127], v[152:155], v[108:111]
    s_add_u32 s43, s40, 0
    s_add_u32 s44, s42, 229376
    s_mov_b32 m0, s43
    s_nop 0
    buffer_load_dwordx4 v4, s[4:7], s44 offen lds
    s_add_u32 s43, s43, 1024
    s_add_u32 s44, s44, 7168
    s_mov_b32 m0, s43
    s_nop 0
    buffer_load_dwordx4 v5, s[4:7], s44 offen lds
    s_add_u32 s43, s43, 1024
    s_add_u32 s44, s44, 7168
    s_mov_b32 m0, s43
    s_nop 0
    buffer_load_dwordx4 v6, s[4:7], s44 offen lds
    s_add_u32 s43, s43, 1024
    s_add_u32 s44, s44, 7168
    s_mov_b32 m0, s43
    s_nop 0
    buffer_load_dwordx4 v7, s[4:7], s44 offen lds
    s_mov_b32 s45, 8192
    buffer_load_dwordx4 v[144:147], v12, s[8:11], s45 offen offset:0
    buffer_load_dwordx4 v[148:151], v13, s[8:11], s45 offen offset:0
    buffer_load_dwordx4 v[152:155], v14, s[8:11], s45 offen offset:0
    s_waitcnt vmcnt(49)
    ds_read_b64_tr_b16 v[112:113], v8 offset:4096
    ds_read_b64_tr_b16 v[114:115], v8 offset:6144
    ds_read_b64_tr_b16 v[116:117], v9 offset:4096
    ds_read_b64_tr_b16 v[118:119], v9 offset:6144
    ds_read_b64_tr_b16 v[120:121], v10 offset:4096
    ds_read_b64_tr_b16 v[122:123], v10 offset:6144
    ds_read_b64_tr_b16 v[124:125], v11 offset:4096
    ds_read_b64_tr_b16 v[126:127], v11 offset:6144
    s_waitcnt lgkmcnt(0)
    v_mfma_f32_16x16x32_bf16 v[64:67], v[112:115], v[156:159], v[64:67]
    v_mfma_f32_16x16x32_bf16 v[68:71], v[112:115], v[160:163], v[68:71]
    v_mfma_f32_16x16x32_bf16 v[72:75], v[112:115], v[164:167], v[72:75]
    v_mfma_f32_16x16x32_bf16 v[76:79], v[116:119], v[156:159], v[76:79]
    v_mfma_f32_16x16x32_bf16 v[80:83], v[116:119], v[160:163], v[80:83]
    v_mfma_f32_16x16x32_bf16 v[84:87], v[116:119], v[164:167], v[84:87]
    v_mfma_f32_16x16x32_bf16 v[88:91], v[120:123], v[156:159], v[88:91]
    v_mfma_f32_16x16x32_bf16 v[92:95], v[120:123], v[160:163], v[92:95]
    v_mfma_f32_16x16x32_bf16 v[96:99], v[120:123], v[164:167], v[96:99]
    v_mfma_f32_16x16x32_bf16 v[100:103], v[124:127], v[156:159], v[100:103]
    v_mfma_f32_16x16x32_bf16 v[104:107], v[124:127], v[160:163], v[104:107]
    v_mfma_f32_16x16x32_bf16 v[108:111], v[124:127], v[164:167], v[108:111]
    s_add_u32 s43, s40, 4096
    s_add_u32 s44, s42, 258048
    s_mov_b32 m0, s43
    s_nop 0
    buffer_load_dwordx4 v4, s[4:7], s44 offen lds
    s_add_u32 s43, s43, 1024
    s_add_u32 s44, s44, 7168
    s_mov_b32 m0, s43
    s_nop 0
    buffer_load_dwordx4 v5, s[4:7], s44 offen lds
    s_add_u32 s43, s43, 1024
    s_add_u32 s44, s44, 7168
    s_mov_b32 m0, s43
    s_nop 0
    buffer_load_dwordx4 v6, s[4:7], s44 offen lds
    s_add_u32 s43, s43, 1024
    s_add_u32 s44, s44, 7168
    s_mov_b32 m0, s43
    s_nop 0
    buffer_load_dwordx4 v7, s[4:7], s44 offen lds
    s_mov_b32 s45, 8192
    buffer_load_dwordx4 v[156:159], v12, s[8:11], s45 offen offset:1024
    buffer_load_dwordx4 v[160:163], v13, s[8:11], s45 offen offset:1024
    buffer_load_dwordx4 v[164:167], v14, s[8:11], s45 offen offset:1024
    s_waitcnt vmcnt(49)
    ds_read_b64_tr_b16 v[112:113], v8 offset:8192
    ds_read_b64_tr_b16 v[114:115], v8 offset:10240
    ds_read_b64_tr_b16 v[116:117], v9 offset:8192
    ds_read_b64_tr_b16 v[118:119], v9 offset:10240
    ds_read_b64_tr_b16 v[120:121], v10 offset:8192
    ds_read_b64_tr_b16 v[122:123], v10 offset:10240
    ds_read_b64_tr_b16 v[124:125], v11 offset:8192
    ds_read_b64_tr_b16 v[126:127], v11 offset:10240
    s_waitcnt lgkmcnt(0)
    v_mfma_f32_16x16x32_bf16 v[64:67], v[112:115], v[168:171], v[64:67]
    v_mfma_f32_16x16x32_bf16 v[68:71], v[112:115], v[172:175], v[68:71]
    v_mfma_f32_16x16x32_bf16 v[72:75], v[112:115], v[176:179], v[72:75]
    v_mfma_f32_16x16x32_bf16 v[76:79], v[116:119], v[168:171], v[76:79]
    v_mfma_f32_16x16x32_bf16 v[80:83], v[116:119], v[172:175], v[80:83]
    v_mfma_f32_16x16x32_bf16 v[84:87], v[116:119], v[176:179], v[84:87]
    v_mfma_f32_16x16x32_bf16 v[88:91], v[120:123], v[168:171], v[88:91]
    v_mfma_f32_16x16x32_bf16 v[92:95], v[120:123], v[172:175], v[92:95]
    v_mfma_f32_16x16x32_bf16 v[96:99], v[120:123], v[176:179], v[96:99]
    v_mfma_f32_16x16x32_bf16 v[100:103], v[124:127], v[168:171], v[100:103]
    v_mfma_f32_16x16x32_bf16 v[104:107], v[124:127], v[172:175], v[104:107]
    v_mfma_f32_16x16x32_bf16 v[108:111], v[124:127], v[176:179], v[108:111]
    s_add_u32 s43, s40, 8192
    s_add_u32 s44, s42, 286720
    s_mov_b32 m0, s43
    s_nop 0
    buffer_load_dwordx4 v4, s[4:7], s44 offen lds
    s_add_u32 s43, s43, 1024
    s_add_u32 s44, s44, 7168
    s_mov_b32 m0, s43
    s_nop 0
    buffer_load_dwordx4 v5, s[4:7], s44 offen lds
    s_add_u32 s43, s43, 1024
    s_add_u32 s44, s44, 7168
    s_mov_b32 m0, s43
    s_nop 0
    buffer_load_dwordx4 v6, s[4:7], s44 offen lds
    s_add_u32 s43, s43, 1024
    s_add_u32 s44, s44, 7168
    s_mov_b32 m0, s43
    s_nop 0
    buffer_load_dwordx4 v7, s[4:7], s44 offen lds
    s_mov_b32 s45, 8192
    buffer_load_dwordx4 v[168:171], v12, s[8:11], s45 offen offset:2048
    buffer_load_dwordx4 v[172:175], v13, s[8:11], s45 offen offset:2048
    buffer_load_dwordx4 v[176:179], v14, s[8:11], s45 offen offset:2048
    s_waitcnt vmcnt(49)
    ds_read_b64_tr_b16 v[112:113], v8 offset:12288
    ds_read_b64_tr_b16 v[114:115], v8 offset:14336
    ds_read_b64_tr_b16 v[116:117], v9 offset:12288
    ds_read_b64_tr_b16 v[118:119], v9 offset:14336
    ds_read_b64_tr_b16 v[120:121], v10 offset:12288
    ds_read_b64_tr_b16 v[122:123], v10 offset:14336
    ds_read_b64_tr_b16 v[124:125], v11 offset:12288
    ds_read_b64_tr_b16 v[126:127], v11 offset:14336
    s_waitcnt lgkmcnt(0)
    v_mfma_f32_16x16x32_bf16 v[64:67], v[112:115], v[180:183], v[64:67]
    v_mfma_f32_16x16x32_bf16 v[68:71], v[112:115], v[184:187], v[68:71]
    v_mfma_f32_16x16x32_bf16 v[72:75], v[112:115], v[188:191], v[72:75]
    v_mfma_f32_16x16x32_bf16 v[76:79], v[116:119], v[180:183], v[76:79]
    v_mfma_f32_16x16x32_bf16 v[80:83], v[116:119], v[184:187], v[80:83]
    v_mfma_f32_16x16x32_bf16 v[84:87], v[116:119], v[188:191], v[84:87]
    v_mfma_f32_16x16x32_bf16 v[88:91], v[120:123], v[180:183], v[88:91]
    v_mfma_f32_16x16x32_bf16 v[92:95], v[120:123], v[184:187], v[92:95]
    v_mfma_f32_16x16x32_bf16 v[96:99], v[120:123], v[188:191], v[96:99]
    v_mfma_f32_16x16x32_bf16 v[100:103], v[124:127], v[180:183], v[100:103]
    v_mfma_f32_16x16x32_bf16 v[104:107], v[124:127], v[184:187], v[104:107]
    v_mfma_f32_16x16x32_bf16 v[108:111], v[124:127], v[188:191], v[108:111]
    s_add_u32 s43, s40, 12288
    s_add_u32 s44, s42, 315392
    s_mov_b32 m0, s43
    s_nop 0
    buffer_load_dwordx4 v4, s[4:7], s44 offen lds
    s_add_u32 s43, s43, 1024
    s_add_u32 s44, s44, 7168
    s_mov_b32 m0, s43
    s_nop 0
    buffer_load_dwordx4 v5, s[4:7], s44 offen lds
    s_add_u32 s43, s43, 1024
    s_add_u32 s44, s44, 7168
    s_mov_b32 m0, s43
    s_nop 0
    buffer_load_dwordx4 v6, s[4:7], s44 offen lds
    s_add_u32 s43, s43, 1024
    s_add_u32 s44, s44, 7168
    s_mov_b32 m0, s43
    s_nop 0
    buffer_load_dwordx4 v7, s[4:7], s44 offen lds
    s_mov_b32 s45, 8192
    buffer_load_dwordx4 v[180:183], v12, s[8:11], s45 offen offset:3072
    buffer_load_dwordx4 v[184:187], v13, s[8:11], s45 offen offset:3072
    buffer_load_dwordx4 v[188:191], v14, s[8:11], s45 offen offset:3072
    s_waitcnt vmcnt(49)
    ds_read_b64_tr_b16 v[112:113], v8 offset:16384
    ds_read_b64_tr_b16 v[114:115], v8 offset:18432
    ds_read_b64_tr_b16 v[116:117], v9 offset:16384
    ds_read_b64_tr_b16 v[118:119], v9 offset:18432
    ds_read_b64_tr_b16 v[120:121], v10 offset:16384
    ds_read_b64_tr_b16 v[122:123], v10 offset:18432
    ds_read_b64_tr_b16 v[124:125], v11 offset:16384
    ds_read_b64_tr_b16 v[126:127], v11 offset:18432
    s_waitcnt lgkmcnt(0)
    v_mfma_f32_16x16x32_bf16 v[64:67], v[112:115], v[192:195], v[64:67]
    v_mfma_f32_16x16x32_bf16 v[68:71], v[112:115], v[196:199], v[68:71]
    v_mfma_f32_16x16x32_bf16 v[72:75], v[112:115], v[200:203], v[72:75]
    v_mfma_f32_16x16x32_bf16 v[76:79], v[116:119], v[192:195], v[76:79]
    v_mfma_f32_16x16x32_bf16 v[80:83], v[116:119], v[196:199], v[80:83]
    v_mfma_f32_16x16x32_bf16 v[84:87], v[116:119], v[200:203], v[84:87]
    v_mfma_f32_16x16x32_bf16 v[88:91], v[120:123], v[192:195], v[88:91]
    v_mfma_f32_16x16x32_bf16 v[92:95], v[120:123], v[196:199], v[92:95]
    v_mfma_f32_16x16x32_bf16 v[96:99], v[120:123], v[200:203], v[96:99]
    v_mfma_f32_16x16x32_bf16 v[100:103], v[124:127], v[192:195], v[100:103]
    v_mfma_f32_16x16x32_bf16 v[104:107], v[124:127], v[196:199], v[104:107]
    v_mfma_f32_16x16x32_bf16 v[108:111], v[124:127], v[200:203], v[108:111]
    s_add_u32 s43, s40, 16384
    s_add_u32 s44, s42, 344064
    s_mov_b32 m0, s43
    s_nop 0
    buffer_load_dwordx4 v4, s[4:7], s44 offen lds
    s_add_u32 s43, s43, 1024
    s_add_u32 s44, s44, 7168
    s_mov_b32 m0, s43
    s_nop 0
    buffer_load_dwordx4 v5, s[4:7], s44 offen lds
    s_add_u32 s43, s43, 1024
    s_add_u32 s44, s44, 7168
    s_mov_b32 m0, s43
    s_nop 0
    buffer_load_dwordx4 v6, s[4:7], s44 offen lds
    s_add_u32 s43, s43, 1024
    s_add_u32 s44, s44, 7168
    s_mov_b32 m0, s43
    s_nop 0
    buffer_load_dwordx4 v7, s[4:7], s44 offen lds
    s_mov_b32 s45, 12288
    buffer_load_dwordx4 v[192:195], v12, s[8:11], s45 offen offset:0
    buffer_load_dwordx4 v[196:199], v13, s[8:11], s45 offen offset:0
    buffer_load_dwordx4 v[200:203], v14, s[8:11], s45 offen offset:0
    s_waitcnt vmcnt(49)
    ds_read_b64_tr_b16 v[112:113], v8 offset:20480
    ds_read_b64_tr_b16 v[114:115], v8 offset:22528
    ds_read_b64_tr_b16 v[116:117], v9 offset:20480
    ds_read_b64_tr_b16 v[118:119], v9 offset:22528
    ds_read_b64_tr_b16 v[120:121], v10 offset:20480
    ds_read_b64_tr_b16 v[122:123], v10 offset:22528
    ds_read_b64_tr_b16 v[124:125], v11 offset:20480
    ds_read_b64_tr_b16 v[126:127], v11 offset:22528
    s_waitcnt lgkmcnt(0)
    v_mfma_f32_16x16x32_bf16 v[64:67], v[112:115], v[204:207], v[64:67]
    v_mfma_f32_16x16x32_bf16 v[68:71], v[112:115], v[208:211], v[68:71]
    v_mfma_f32_16x16x32_bf16 v[72:75], v[112:115], v[212:215], v[72:75]
    v_mfma_f32_16x16x32_bf16 v[76:79], v[116:119], v[204:207], v[76:79]
    v_mfma_f32_16x16x32_bf16 v[80:83], v[116:119], v[208:211], v[80:83]
    v_mfma_f32_16x16x32_bf16 v[84:87], v[116:119], v[212:215], v[84:87]
    v_mfma_f32_16x16x32_bf16 v[88:91], v[120:123], v[204:207], v[88:91]
    v_mfma_f32_16x16x32_bf16 v[92:95], v[120:123], v[208:211], v[92:95]
    v_mfma_f32_16x16x32_bf16 v[96:99], v[120:123], v[212:215], v[96:99]
    v_mfma_f32_16x16x32_bf16 v[100:103], v[124:127], v[204:207], v[100:103]
    v_mfma_f32_16x16x32_bf16 v[104:107], v[124:127], v[208:211], v[104:107]
    v_mfma_f32_16x16x32_bf16 v[108:111], v[124:127], v[212:215], v[108:111]
    s_add_u32 s43, s40, 20480
    s_add_u32 s44, s42, 372736
    s_mov_b32 m0, s43
    s_nop 0
    buffer_load_dwordx4 v4, s[4:7], s44 offen lds
    s_add_u32 s43, s43, 1024
    s_add_u32 s44, s44, 7168
    s_mov_b32 m0, s43
    s_nop 0
    buffer_load_dwordx4 v5, s[4:7], s44 offen lds
    s_add_u32 s43, s43, 1024
    s_add_u32 s44, s44, 7168
    s_mov_b32 m0, s43
    s_nop 0
    buffer_load_dwordx4 v6, s[4:7], s44 offen lds
    s_add_u32 s43, s43, 1024
    s_add_u32 s44, s44, 7168
    s_mov_b32 m0, s43
    s_nop 0
    buffer_load_dwordx4 v7, s[4:7], s44 offen lds
    s_mov_b32 s45, 12288
    buffer_load_dwordx4 v[204:207], v12, s[8:11], s45 offen offset:1024
    buffer_load_dwordx4 v[208:211], v13, s[8:11], s45 offen offset:1024
    buffer_load_dwordx4 v[212:215], v14, s[8:11], s45 offen offset:1024
    s_waitcnt vmcnt(49)
    ds_read_b64_tr_b16 v[112:113], v8 offset:24576
    ds_read_b64_tr_b16 v[114:115], v8 offset:26624
    ds_read_b64_tr_b16 v[116:117], v9 offset:24576
    ds_read_b64_tr_b16 v[118:119], v9 offset:26624
    ds_read_b64_tr_b16 v[120:121], v10 offset:24576
    ds_read_b64_tr_b16 v[122:123], v10 offset:26624
    ds_read_b64_tr_b16 v[124:125], v11 offset:24576
    ds_read_b64_tr_b16 v[126:127], v11 offset:26624
    s_waitcnt lgkmcnt(0)
    v_mfma_f32_16x16x32_bf16 v[64:67], v[112:115], v[216:219], v[64:67]
    v_mfma_f32_16x16x32_bf16 v[68:71], v[112:115], v[220:223], v[68:71]
    v_mfma_f32_16x16x32_bf16 v[72:75], v[112:115], v[224:227], v[72:75]
    v_mfma_f32_16x16x32_bf16 v[76:79], v[116:119], v[216:219], v[76:79]
    v_mfma_f32_16x16x32_bf16 v[80:83], v[116:119], v[220:223], v[80:83]
    v_mfma_f32_16x16x32_bf16 v[84:87], v[116:119], v[224:227], v[84:87]
    v_mfma_f32_16x16x32_bf16 v[88:91], v[120:123], v[216:219], v[88:91]
    v_mfma_f32_16x16x32_bf16 v[92:95], v[120:123], v[220:223], v[92:95]
    v_mfma_f32_16x16x32_bf16 v[96:99], v[120:123], v[224:227], v[96:99]
    v_mfma_f32_16x16x32_bf16 v[100:103], v[124:127], v[216:219], v[100:103]
    v_mfma_f32_16x16x32_bf16 v[104:107], v[124:127], v[220:223], v[104:107]
    v_mfma_f32_16x16x32_bf16 v[108:111], v[124:127], v[224:227], v[108:111]
    s_add_u32 s43, s40, 24576
    s_add_u32 s44, s42, 401408
    s_mov_b32 m0, s43
    s_nop 0
    buffer_load_dwordx4 v4, s[4:7], s44 offen lds
    s_add_u32 s43, s43, 1024
    s_add_u32 s44, s44, 7168
    s_mov_b32 m0, s43
    s_nop 0
    buffer_load_dwordx4 v5, s[4:7], s44 offen lds
    s_add_u32 s43, s43, 1024
    s_add_u32 s44, s44, 7168
    s_mov_b32 m0, s43
    s_nop 0
    buffer_load_dwordx4 v6, s[4:7], s44 offen lds
    s_add_u32 s43, s43, 1024
    s_add_u32 s44, s44, 7168
    s_mov_b32 m0, s43
    s_nop 0
    buffer_load_dwordx4 v7, s[4:7], s44 offen lds
    s_mov_b32 s45, 12288
    buffer_load_dwordx4 v[216:219], v12, s[8:11], s45 offen offset:2048
    buffer_load_dwordx4 v[220:223], v13, s[8:11], s45 offen offset:2048
    buffer_load_dwordx4 v[224:227], v14, s[8:11], s45 offen offset:2048
    s_waitcnt vmcnt(49)
    ds_read_b64_tr_b16 v[112:113], v8 offset:28672
    ds_read_b64_tr_b16 v[114:115], v8 offset:30720
    ds_read_b64_tr_b16 v[116:117], v9 offset:28672
    ds_read_b64_tr_b16 v[118:119], v9 offset:30720
    ds_read_b64_tr_b16 v[120:121], v10 offset:28672
    ds_read_b64_tr_b16 v[122:123], v10 offset:30720
    ds_read_b64_tr_b16 v[124:125], v11 offset:28672
    ds_read_b64_tr_b16 v[126:127], v11 offset:30720
    s_waitcnt lgkmcnt(0)
    v_mfma_f32_16x16x32_bf16 v[64:67], v[112:115], v[228:231], v[64:67]
    v_mfma_f32_16x16x32_bf16 v[68:71], v[112:115], v[232:235], v[68:71]
    v_mfma_f32_16x16x32_bf16 v[72:75], v[112:115], v[236:239], v[72:75]
    v_mfma_f32_16x16x32_bf16 v[76:79], v[116:119], v[228:231], v[76:79]
    v_mfma_f32_16x16x32_bf16 v[80:83], v[116:119], v[232:235], v[80:83]
    v_mfma_f32_16x16x32_bf16 v[84:87], v[116:119], v[236:239], v[84:87]
    v_mfma_f32_16x16x32_bf16 v[88:91], v[120:123], v[228:231], v[88:91]
    v_mfma_f32_16x16x32_bf16 v[92:95], v[120:123], v[232:235], v[92:95]
    v_mfma_f32_16x16x32_bf16 v[96:99], v[120:123], v[236:239], v[96:99]
    v_mfma_f32_16x16x32_bf16 v[100:103], v[124:127], v[228:231], v[100:103]
    v_mfma_f32_16x16x32_bf16 v[104:107], v[124:127], v[232:235], v[104:107]
    v_mfma_f32_16x16x32_bf16 v[108:111], v[124:127], v[236:239], v[108:111]
    s_add_u32 s43, s40, 28672
    s_add_u32 s44, s42, 430080
    s_mov_b32 m0, s43
    s_nop 0
    buffer_load_dwordx4 v4, s[4:7], s44 offen lds
    s_add_u32 s43, s43, 1024
    s_add_u32 s44, s44, 7168
    s_mov_b32 m0, s43
    s_nop 0
    buffer_load_dwordx4 v5, s[4:7], s44 offen lds
    s_add_u32 s43, s43, 1024
    s_add_u32 s44, s44, 7168
    s_mov_b32 m0, s43
    s_nop 0
    buffer_load_dwordx4 v6, s[4:7], s44 offen lds
    s_add_u32 s43, s43, 1024
    s_add_u32 s44, s44, 7168
    s_mov_b32 m0, s43
    s_nop 0
    buffer_load_dwordx4 v7, s[4:7], s44 offen lds
    s_mov_b32 s45, 12288
    buffer_load_dwordx4 v[228:231], v12, s[8:11], s45 offen offset:3072
    buffer_load_dwordx4 v[232:235], v13, s[8:11], s45 offen offset:3072
    buffer_load_dwordx4 v[236:239], v14, s[8:11], s45 offen offset:3072
    s_waitcnt vmcnt(49)
    ds_read_b64_tr_b16 v[112:113], v8 offset:0
    ds_read_b64_tr_b16 v[114:115], v8 offset:2048
    ds_read_b64_tr_b16 v[116:117], v9 offset:0
    ds_read_b64_tr_b16 v[118:119], v9 offset:2048
    ds_read_b64_tr_b16 v[120:121], v10 offset:0
    ds_read_b64_tr_b16 v[122:123], v10 offset:2048
    ds_read_b64_tr_b16 v[124:125], v11 offset:0
    ds_read_b64_tr_b16 v[126:127], v11 offset:2048
    s_waitcnt lgkmcnt(0)
    v_mfma_f32_16x16x32_bf16 v[64:67], v[112:115], v[144:147], v[64:67]
    v_mfma_f32_16x16x32_bf16 v[68:71], v[112:115], v[148:151], v[68:71]
    v_mfma_f32_16x16x32_bf16 v[72:75], v[112:115], v[152:155], v[72:75]
    v_mfma_f32_16x16x32_bf16 v[76:79], v[116:119], v[144:147], v[76:79]
    v_mfma_f32_16x16x32_bf16 v[80:83], v[116:119], v[148:151], v[80:83]
    v_mfma_f32_16x16x32_bf16 v[84:87], v[116:119], v[152:155], v[84:87]
    v_mfma_f32_16x16x32_bf16 v[88:91], v[120:123], v[144:147], v[88:91]
    v_mfma_f32_16x16x32_bf16 v[92:95], v[120:123], v[148:151], v[92:95]
    v_mfma_f32_16x16x32_bf16 v[96:99], v[120:123], v[152:155], v[96:99]
    v_mfma_f32_16x16x32_bf16 v[100:103], v[124:127], v[144:147], v[100:103]
    v_mfma_f32_16x16x32_bf16 v[104:107], v[124:127], v[148:151], v[104:107]
    v_mfma_f32_16x16x32_bf16 v[108:111], v[124:127], v[152:155], v[108:111]
    s_add_u32 s43, s40, 0
    s_add_u32 s44, s42, 458752
    s_mov_b32 m0, s43
    s_nop 0
    buffer_load_dwordx4 v4, s[4:7], s44 offen lds
    s_add_u32 s43, s43, 1024
    s_add_u32 s44, s44, 7168
    s_mov_b32 m0, s43
    s_nop 0
    buffer_load_dwordx4 v5, s[4:7], s44 offen lds
    s_add_u32 s43, s43, 1024
    s_add_u32 s44, s44, 7168
    s_mov_b32 m0, s43
    s_nop 0
    buffer_load_dwordx4 v6, s[4:7], s44 offen lds
    s_add_u32 s43, s43, 1024
    s_add_u32 s44, s44, 7168
    s_mov_b32 m0, s43
    s_nop 0
    buffer_load_dwordx4 v7, s[4:7], s44 offen lds
    s_mov_b32 s45, 16384
    buffer_load_dwordx4 v[144:147], v12, s[8:11], s45 offen offset:0
    buffer_load_dwordx4 v[148:151], v13, s[8:11], s45 offen offset:0
    buffer_load_dwordx4 v[152:155], v14, s[8:11], s45 offen offset:0
    s_waitcnt vmcnt(49)
    ds_read_b64_tr_b16 v[112:113], v8 offset:4096
    ds_read_b64_tr_b16 v[114:115], v8 offset:6144
    ds_read_b64_tr_b16 v[116:117], v9 offset:4096
    ds_read_b64_tr_b16 v[118:119], v9 offset:6144
    ds_read_b64_tr_b16 v[120:121], v10 offset:4096
    ds_read_b64_tr_b16 v[122:123], v10 offset:6144
    ds_read_b64_tr_b16 v[124:125], v11 offset:4096
    ds_read_b64_tr_b16 v[126:127], v11 offset:6144
    s_waitcnt lgkmcnt(0)
    v_mfma_f32_16x16x32_bf16 v[64:67], v[112:115], v[156:159], v[64:67]
    v_mfma_f32_16x16x32_bf16 v[68:71], v[112:115], v[160:163], v[68:71]
    v_mfma_f32_16x16x32_bf16 v[72:75], v[112:115], v[164:167], v[72:75]
    v_mfma_f32_16x16x32_bf16 v[76:79], v[116:119], v[156:159], v[76:79]
    v_mfma_f32_16x16x32_bf16 v[80:83], v[116:119], v[160:163], v[80:83]
    v_mfma_f32_16x16x32_bf16 v[84:87], v[116:119], v[164:167], v[84:87]
    v_mfma_f32_16x16x32_bf16 v[88:91], v[120:123], v[156:159], v[88:91]
    v_mfma_f32_16x16x32_bf16 v[92:95], v[120:123], v[160:163], v[92:95]
    v_mfma_f32_16x16x32_bf16 v[96:99], v[120:123], v[164:167], v[96:99]
    v_mfma_f32_16x16x32_bf16 v[100:103], v[124:127], v[156:159], v[100:103]
    v_mfma_f32_16x16x32_bf16 v[104:107], v[124:127], v[160:163], v[104:107]
    v_mfma_f32_16x16x32_bf16 v[108:111], v[124:127], v[164:167], v[108:111]
    s_add_u32 s43, s40, 4096
    s_add_u32 s44, s42, 487424
    s_mov_b32 m0, s43
    s_nop 0
    buffer_load_dwordx4 v4, s[4:7], s44 offen lds
    s_add_u32 s43, s43, 1024
    s_add_u32 s44, s44, 7168
    s_mov_b32 m0, s43
    s_nop 0
    buffer_load_dwordx4 v5, s[4:7], s44 offen lds
    s_add_u32 s43, s43, 1024
    s_add_u32 s44, s44, 7168
    s_mov_b32 m0, s43
    s_nop 0
    buffer_load_dwordx4 v6, s[4:7], s44 offen lds
    s_add_u32 s43, s43, 1024
    s_add_u32 s44, s44, 7168
    s_mov_b32 m0, s43
    s_nop 0
    buffer_load_dwordx4 v7, s[4:7], s44 offen lds
    s_mov_b32 s45, 16384
    buffer_load_dwordx4 v[156:159], v12, s[8:11], s45 offen offset:1024
    buffer_load_dwordx4 v[160:163], v13, s[8:11], s45 offen offset:1024
    buffer_load_dwordx4 v[164:167], v14, s[8:11], s45 offen offset:1024
    s_waitcnt vmcnt(49)
    ds_read_b64_tr_b16 v[112:113], v8 offset:8192
    ds_read_b64_tr_b16 v[114:115], v8 offset:10240
    ds_read_b64_tr_b16 v[116:117], v9 offset:8192
    ds_read_b64_tr_b16 v[118:119], v9 offset:10240
    ds_read_b64_tr_b16 v[120:121], v10 offset:8192
    ds_read_b64_tr_b16 v[122:123], v10 offset:10240
    ds_read_b64_tr_b16 v[124:125], v11 offset:8192
    ds_read_b64_tr_b16 v[126:127], v11 offset:10240
    s_waitcnt lgkmcnt(0)
    v_mfma_f32_16x16x32_bf16 v[64:67], v[112:115], v[168:171], v[64:67]
    v_mfma_f32_16x16x32_bf16 v[68:71], v[112:115], v[172:175], v[68:71]
    v_mfma_f32_16x16x32_bf16 v[72:75], v[112:115], v[176:179], v[72:75]
    v_mfma_f32_16x16x32_bf16 v[76:79], v[116:119], v[168:171], v[76:79]
    v_mfma_f32_16x16x32_bf16 v[80:83], v[116:119], v[172:175], v[80:83]
    v_mfma_f32_16x16x32_bf16 v[84:87], v[116:119], v[176:179], v[84:87]
    v_mfma_f32_16x16x32_bf16 v[88:91], v[120:123], v[168:171], v[88:91]
    v_mfma_f32_16x16x32_bf16 v[92:95], v[120:123], v[172:175], v[92:95]
    v_mfma_f32_16x16x32_bf16 v[96:99], v[120:123], v[176:179], v[96:99]
    v_mfma_f32_16x16x32_bf16 v[100:103], v[124:127], v[168:171], v[100:103]
    v_mfma_f32_16x16x32_bf16 v[104:107], v[124:127], v[172:175], v[104:107]
    v_mfma_f32_16x16x32_bf16 v[108:111], v[124:127], v[176:179], v[108:111]
    s_add_u32 s43, s40, 8192
    s_add_u32 s44, s42, 516096
    s_mov_b32 m0, s43
    s_nop 0
    buffer_load_dwordx4 v4, s[4:7], s44 offen lds
    s_add_u32 s43, s43, 1024
    s_add_u32 s44, s44, 7168
    s_mov_b32 m0, s43
    s_nop 0
    buffer_load_dwordx4 v5, s[4:7], s44 offen lds
    s_add_u32 s43, s43, 1024
    s_add_u32 s44, s44, 7168
    s_mov_b32 m0, s43
    s_nop 0
    buffer_load_dwordx4 v6, s[4:7], s44 offen lds
    s_add_u32 s43, s43, 1024
    s_add_u32 s44, s44, 7168
    s_mov_b32 m0, s43
    s_nop 0
    buffer_load_dwordx4 v7, s[4:7], s44 offen lds
    s_mov_b32 s45, 16384
    buffer_load_dwordx4 v[168:171], v12, s[8:11], s45 offen offset:2048
    buffer_load_dwordx4 v[172:175], v13, s[8:11], s45 offen offset:2048
    buffer_load_dwordx4 v[176:179], v14, s[8:11], s45 offen offset:2048
    s_waitcnt vmcnt(49)
    ds_read_b64_tr_b16 v[112:113], v8 offset:12288
    ds_read_b64_tr_b16 v[114:115], v8 offset:14336
    ds_read_b64_tr_b16 v[116:117], v9 offset:12288
    ds_read_b64_tr_b16 v[118:119], v9 offset:14336
    ds_read_b64_tr_b16 v[120:121], v10 offset:12288
    ds_read_b64_tr_b16 v[122:123], v10 offset:14336
    ds_read_b64_tr_b16 v[124:125], v11 offset:12288
    ds_read_b64_tr_b16 v[126:127], v11 offset:14336
    s_waitcnt lgkmcnt(0)
    v_mfma_f32_16x16x32_bf16 v[64:67], v[112:115], v[180:183], v[64:67]
    v_mfma_f32_16x16x32_bf16 v[68:71], v[112:115], v[184:187], v[68:71]
    v_mfma_f32_16x16x32_bf16 v[72:75], v[112:115], v[188:191], v[72:75]
    v_mfma_f32_16x16x32_bf16 v[76:79], v[116:119], v[180:183], v[76:79]
    v_mfma_f32_16x16x32_bf16 v[80:83], v[116:119], v[184:187], v[80:83]
    v_mfma_f32_16x16x32_bf16 v[84:87], v[116:119], v[188:191], v[84:87]
    v_mfma_f32_16x16x32_bf16 v[88:91], v[120:123], v[180:183], v[88:91]
    v_mfma_f32_16x16x32_bf16 v[92:95], v[120:123], v[184:187], v[92:95]
    v_mfma_f32_16x16x32_bf16 v[96:99], v[120:123], v[188:191], v[96:99]
    v_mfma_f32_16x16x32_bf16 v[100:103], v[124:127], v[180:183], v[100:103]
    v_mfma_f32_16x16x32_bf16 v[104:107], v[124:127], v[184:187], v[104:107]
    v_mfma_f32_16x16x32_bf16 v[108:111], v[124:127], v[188:191], v[108:111]
    s_add_u32 s43, s40, 12288
    s_add_u32 s44, s42, 544768
    s_mov_b32 m0, s43
    s_nop 0
    buffer_load_dwordx4 v4, s[4:7], s44 offen lds
    s_add_u32 s43, s43, 1024
    s_add_u32 s44, s44, 7168
    s_mov_b32 m0, s43
    s_nop 0
    buffer_load_dwordx4 v5, s[4:7], s44 offen lds
    s_add_u32 s43, s43, 1024
    s_add_u32 s44, s44, 7168
    s_mov_b32 m0, s43
    s_nop 0
    buffer_load_dwordx4 v6, s[4:7], s44 offen lds
    s_add_u32 s43, s43, 1024
    s_add_u32 s44, s44, 7168
    s_mov_b32 m0, s43
    s_nop 0
    buffer_load_dwordx4 v7, s[4:7], s44 offen lds
    s_mov_b32 s45, 16384
    buffer_load_dwordx4 v[180:183], v12, s[8:11], s45 offen offset:3072
    buffer_load_dwordx4 v[184:187], v13, s[8:11], s45 offen offset:3072
    buffer_load_dwordx4 v[188:191], v14, s[8:11], s45 offen offset:3072
    s_waitcnt vmcnt(49)
    ds_read_b64_tr_b16 v[112:113], v8 offset:16384
    ds_read_b64_tr_b16 v[114:115], v8 offset:18432
    ds_read_b64_tr_b16 v[116:117], v9 offset:16384
    ds_read_b64_tr_b16 v[118:119], v9 offset:18432
    ds_read_b64_tr_b16 v[120:121], v10 offset:16384
    ds_read_b64_tr_b16 v[122:123], v10 offset:18432
    ds_read_b64_tr_b16 v[124:125], v11 offset:16384
    ds_read_b64_tr_b16 v[126:127], v11 offset:18432
    s_waitcnt lgkmcnt(0)
    v_mfma_f32_16x16x32_bf16 v[64:67], v[112:115], v[192:195], v[64:67]
    v_mfma_f32_16x16x32_bf16 v[68:71], v[112:115], v[196:199], v[68:71]
    v_mfma_f32_16x16x32_bf16 v[72:75], v[112:115], v[200:203], v[72:75]
    v_mfma_f32_16x16x32_bf16 v[76:79], v[116:119], v[192:195], v[76:79]
    v_mfma_f32_16x16x32_bf16 v[80:83], v[116:119], v[196:199], v[80:83]
    v_mfma_f32_16x16x32_bf16 v[84:87], v[116:119], v[200:203], v[84:87]
    v_mfma_f32_16x16x32_bf16 v[88:91], v[120:123], v[192:195], v[88:91]
    v_mfma_f32_16x16x32_bf16 v[92:95], v[120:123], v[196:199], v[92:95]
    v_mfma_f32_16x16x32_bf16 v[96:99], v[120:123], v[200:203], v[96:99]
    v_mfma_f32_16x16x32_bf16 v[100:103], v[124:127], v[192:195], v[100:103]
    v_mfma_f32_16x16x32_bf16 v[104:107], v[124:127], v[196:199], v[104:107]
    v_mfma_f32_16x16x32_bf16 v[108:111], v[124:127], v[200:203], v[108:111]
    s_add_u32 s43, s40, 16384
    s_add_u32 s44, s42, 573440
    s_mov_b32 m0, s43
    s_nop 0
    buffer_load_dwordx4 v4, s[4:7], s44 offen lds
    s_add_u32 s43, s43, 1024
    s_add_u32 s44, s44, 7168
    s_mov_b32 m0, s43
    s_nop 0
    buffer_load_dwordx4 v5, s[4:7], s44 offen lds
    s_add_u32 s43, s43, 1024
    s_add_u32 s44, s44, 7168
    s_mov_b32 m0, s43
    s_nop 0
    buffer_load_dwordx4 v6, s[4:7], s44 offen lds
    s_add_u32 s43, s43, 1024
    s_add_u32 s44, s44, 7168
    s_mov_b32 m0, s43
    s_nop 0
    buffer_load_dwordx4 v7, s[4:7], s44 offen lds
    s_mov_b32 s45, 20480
    buffer_load_dwordx4 v[192:195], v12, s[8:11], s45 offen offset:0
    buffer_load_dwordx4 v[196:199], v13, s[8:11], s45 offen offset:0
    buffer_load_dwordx4 v[200:203], v14, s[8:11], s45 offen offset:0
    s_waitcnt vmcnt(49)
    ds_read_b64_tr_b16 v[112:113], v8 offset:20480
    ds_read_b64_tr_b16 v[114:115], v8 offset:22528
    ds_read_b64_tr_b16 v[116:117], v9 offset:20480
    ds_read_b64_tr_b16 v[118:119], v9 offset:22528
    ds_read_b64_tr_b16 v[120:121], v10 offset:20480
    ds_read_b64_tr_b16 v[122:123], v10 offset:22528
    ds_read_b64_tr_b16 v[124:125], v11 offset:20480
    ds_read_b64_tr_b16 v[126:127], v11 offset:22528
    s_waitcnt lgkmcnt(0)
    v_mfma_f32_16x16x32_bf16 v[64:67], v[112:115], v[204:207], v[64:67]
    v_mfma_f32_16x16x32_bf16 v[68:71], v[112:115], v[208:211], v[68:71]
    v_mfma_f32_16x16x32_bf16 v[72:75], v[112:115], v[212:215], v[72:75]
    v_mfma_f32_16x16x32_bf16 v[76:79], v[116:119], v[204:207], v[76:79]
    v_mfma_f32_16x16x32_bf16 v[80:83], v[116:119], v[208:211], v[80:83]
    v_mfma_f32_16x16x32_bf16 v[84:87], v[116:119], v[212:215], v[84:87]
    v_mfma_f32_16x16x32_bf16 v[88:91], v[120:123], v[204:207], v[88:91]
    v_mfma_f32_16x16x32_bf16 v[92:95], v[120:123], v[208:211], v[92:95]
    v_mfma_f32_16x16x32_bf16 v[96:99], v[120:123], v[212:215], v[96:99]
    v_mfma_f32_16x16x32_bf16 v[100:103], v[124:127], v[204:207], v[100:103]
    v_mfma_f32_16x16x32_bf16 v[104:107], v[124:127], v[208:211], v[104:107]
    v_mfma_f32_16x16x32_bf16 v[108:111], v[124:127], v[212:215], v[108:111]
    s_add_u32 s43, s40, 20480
    s_add_u32 s44, s42, 602112
    s_mov_b32 m0, s43
    s_nop 0
    buffer_load_dwordx4 v4, s[4:7], s44 offen lds
    s_add_u32 s43, s43, 1024
    s_add_u32 s44, s44, 7168
    s_mov_b32 m0, s43
    s_nop 0
    buffer_load_dwordx4 v5, s[4:7], s44 offen lds
    s_add_u32 s43, s43, 1024
    s_add_u32 s44, s44, 7168
    s_mov_b32 m0, s43
    s_nop 0
    buffer_load_dwordx4 v6, s[4:7], s44 offen lds
    s_add_u32 s43, s43, 1024
    s_add_u32 s44, s44, 7168
    s_mov_b32 m0, s43
    s_nop 0
    buffer_load_dwordx4 v7, s[4:7], s44 offen lds
    s_mov_b32 s45, 20480
    buffer_load_dwordx4 v[204:207], v12, s[8:11], s45 offen offset:1024
    buffer_load_dwordx4 v[208:211], v13, s[8:11], s45 offen offset:1024
    buffer_load_dwordx4 v[212:215], v14, s[8:11], s45 offen offset:1024
    s_waitcnt vmcnt(49)
    ds_read_b64_tr_b16 v[112:113], v8 offset:24576
    ds_read_b64_tr_b16 v[114:115], v8 offset:26624
    ds_read_b64_tr_b16 v[116:117], v9 offset:24576
    ds_read_b64_tr_b16 v[118:119], v9 offset:26624
    ds_read_b64_tr_b16 v[120:121], v10 offset:24576
    ds_read_b64_tr_b16 v[122:123], v10 offset:26624
    ds_read_b64_tr_b16 v[124:125], v11 offset:24576
    ds_read_b64_tr_b16 v[126:127], v11 offset:26624
    s_waitcnt lgkmcnt(0)
    v_mfma_f32_16x16x32_bf16 v[64:67], v[112:115], v[216:219], v[64:67]
    v_mfma_f32_16x16x32_bf16 v[68:71], v[112:115], v[220:223], v[68:71]
    v_mfma_f32_16x16x32_bf16 v[72:75], v[112:115], v[224:227], v[72:75]
    v_mfma_f32_16x16x32_bf16 v[76:79], v[116:119], v[216:219], v[76:79]
    v_mfma_f32_16x16x32_bf16 v[80:83], v[116:119], v[220:223], v[80:83]
    v_mfma_f32_16x16x32_bf16 v[84:87], v[116:119], v[224:227], v[84:87]
    v_mfma_f32_16x16x32_bf16 v[88:91], v[120:123], v[216:219], v[88:91]
    v_mfma_f32_16x16x32_bf16 v[92:95], v[120:123], v[220:223], v[92:95]
    v_mfma_f32_16x16x32_bf16 v[96:99], v[120:123], v[224:227], v[96:99]
    v_mfma_f32_16x16x32_bf16 v[100:103], v[124:127], v[216:219], v[100:103]
    v_mfma_f32_16x16x32_bf16 v[104:107], v[124:127], v[220:223], v[104:107]
    v_mfma_f32_16x16x32_bf16 v[108:111], v[124:127], v[224:227], v[108:111]
    s_add_u32 s43, s40, 24576
    s_add_u32 s44, s42, 630784
    s_mov_b32 m0, s43
    s_nop 0
    buffer_load_dwordx4 v4, s[4:7], s44 offen lds
    s_add_u32 s43, s43, 1024
    s_add_u32 s44, s44, 7168
    s_mov_b32 m0, s43
    s_nop 0
    buffer_load_dwordx4 v5, s[4:7], s44 offen lds
    s_add_u32 s43, s43, 1024
    s_add_u32 s44, s44, 7168
    s_mov_b32 m0, s43
    s_nop 0
    buffer_load_dwordx4 v6, s[4:7], s44 offen lds
    s_add_u32 s43, s43, 1024
    s_add_u32 s44, s44, 7168
    s_mov_b32 m0, s43
    s_nop 0
    buffer_load_dwordx4 v7, s[4:7], s44 offen lds
    s_mov_b32 s45, 20480
    buffer_load_dwordx4 v[216:219], v12, s[8:11], s45 offen offset:2048
    buffer_load_dwordx4 v[220:223], v13, s[8:11], s45 offen offset:2048
    buffer_load_dwordx4 v[224:227], v14, s[8:11], s45 offen offset:2048
    s_waitcnt vmcnt(49)
    ds_read_b64_tr_b16 v[112:113], v8 offset:28672
    ds_read_b64_tr_b16 v[114:115], v8 offset:30720
    ds_read_b64_tr_b16 v[116:117], v9 offset:28672
    ds_read_b64_tr_b16 v[118:119], v9 offset:30720
    ds_read_b64_tr_b16 v[120:121], v10 offset:28672
    ds_read_b64_tr_b16 v[122:123], v10 offset:30720
    ds_read_b64_tr_b16 v[124:125], v11 offset:28672
    ds_read_b64_tr_b16 v[126:127], v11 offset:30720
    s_waitcnt lgkmcnt(0)
    v_mfma_f32_16x16x32_bf16 v[64:67], v[112:115], v[228:231], v[64:67]
    v_mfma_f32_16x16x32_bf16 v[68:71], v[112:115], v[232:235], v[68:71]
    v_mfma_f32_16x16x32_bf16 v[72:75], v[112:115], v[236:239], v[72:75]
    v_mfma_f32_16x16x32_bf16 v[76:79], v[116:119], v[228:231], v[76:79]
    v_mfma_f32_16x16x32_bf16 v[80:83], v[116:119], v[232:235], v[80:83]
    v_mfma_f32_16x16x32_bf16 v[84:87], v[116:119], v[236:239], v[84:87]
    v_mfma_f32_16x16x32_bf16 v[88:91], v[120:123], v[228:231], v[88:91]
    v_mfma_f32_16x16x32_bf16 v[92:95], v[120:123], v[232:235], v[92:95]
    v_mfma_f32_16x16x32_bf16 v[96:99], v[120:123], v[236:239], v[96:99]
    v_mfma_f32_16x16x32_bf16 v[100:103], v[124:127], v[228:231], v[100:103]
    v_mfma_f32_16x16x32_bf16 v[104:107], v[124:127], v[232:235], v[104:107]
    v_mfma_f32_16x16x32_bf16 v[108:111], v[124:127], v[236:239], v[108:111]
    s_add_u32 s43, s40, 28672
    s_add_u32 s44, s42, 659456
    s_mov_b32 m0, s43
    s_nop 0
    buffer_load_dwordx4 v4, s[4:7], s44 offen lds
    s_add_u32 s43, s43, 1024
    s_add_u32 s44, s44, 7168
    s_mov_b32 m0, s43
    s_nop 0
    buffer_load_dwordx4 v5, s[4:7], s44 offen lds
    s_add_u32 s43, s43, 1024
    s_add_u32 s44, s44, 7168
    s_mov_b32 m0, s43
    s_nop 0
    buffer_load_dwordx4 v6, s[4:7], s44 offen lds
    s_add_u32 s43, s43, 1024
    s_add_u32 s44, s44, 7168
    s_mov_b32 m0, s43
    s_nop 0
    buffer_load_dwordx4 v7, s[4:7], s44 offen lds
    s_mov_b32 s45, 20480
    buffer_load_dwordx4 v[228:231], v12, s[8:11], s45 offen offset:3072
    buffer_load_dwordx4 v[232:235], v13, s[8:11], s45 offen offset:3072
    buffer_load_dwordx4 v[236:239], v14, s[8:11], s45 offen offset:3072
    s_waitcnt vmcnt(49)
    ds_read_b64_tr_b16 v[112:113], v8 offset:0
    ds_read_b64_tr_b16 v[114:115], v8 offset:2048
    ds_read_b64_tr_b16 v[116:117], v9 offset:0
    ds_read_b64_tr_b16 v[118:119], v9 offset:2048
    ds_read_b64_tr_b16 v[120:121], v10 offset:0
    ds_read_b64_tr_b16 v[122:123], v10 offset:2048
    ds_read_b64_tr_b16 v[124:125], v11 offset:0
    ds_read_b64_tr_b16 v[126:127], v11 offset:2048
    s_waitcnt lgkmcnt(0)
    v_mfma_f32_16x16x32_bf16 v[64:67], v[112:115], v[144:147], v[64:67]
    v_mfma_f32_16x16x32_bf16 v[68:71], v[112:115], v[148:151], v[68:71]
    v_mfma_f32_16x16x32_bf16 v[72:75], v[112:115], v[152:155], v[72:75]
    v_mfma_f32_16x16x32_bf16 v[76:79], v[116:119], v[144:147], v[76:79]
    v_mfma_f32_16x16x32_bf16 v[80:83], v[116:119], v[148:151], v[80:83]
    v_mfma_f32_16x16x32_bf16 v[84:87], v[116:119], v[152:155], v[84:87]
    v_mfma_f32_16x16x32_bf16 v[88:91], v[120:123], v[144:147], v[88:91]
    v_mfma_f32_16x16x32_bf16 v[92:95], v[120:123], v[148:151], v[92:95]
    v_mfma_f32_16x16x32_bf16 v[96:99], v[120:123], v[152:155], v[96:99]
    v_mfma_f32_16x16x32_bf16 v[100:103], v[124:127], v[144:147], v[100:103]
    v_mfma_f32_16x16x32_bf16 v[104:107], v[124:127], v[148:151], v[104:107]
    v_mfma_f32_16x16x32_bf16 v[108:111], v[124:127], v[152:155], v[108:111]
    s_add_u32 s43, s40, 0
    s_add_u32 s44, s42, 688128
    s_mov_b32 m0, s43
    s_nop 0
    buffer_load_dwordx4 v4, s[4:7], s44 offen lds
    s_add_u32 s43, s43, 1024
    s_add_u32 s44, s44, 7168
    s_mov_b32 m0, s43
    s_nop 0
    buffer_load_dwordx4 v5, s[4:7], s44 offen lds
    s_add_u32 s43, s43, 1024
    s_add_u32 s44, s44, 7168
    s_mov_b32 m0, s43
    s_nop 0
    buffer_load_dwordx4 v6, s[4:7], s44 offen lds
    s_add_u32 s43, s43, 1024
    s_add_u32 s44, s44, 7168
    s_mov_b32 m0, s43
    s_nop 0
    buffer_load_dwordx4 v7, s[4:7], s44 offen lds
    s_mov_b32 s45, 24576
    buffer_load_dwordx4 v[144:147], v12, s[8:11], s45 offen offset:0
    buffer_load_dwordx4 v[148:151], v13, s[8:11], s45 offen offset:0
    buffer_load_dwordx4 v[152:155], v14, s[8:11], s45 offen offset:0
    s_waitcnt vmcnt(49)
    ds_read_b64_tr_b16 v[112:113], v8 offset:4096
    ds_read_b64_tr_b16 v[114:115], v8 offset:6144
    ds_read_b64_tr_b16 v[116:117], v9 offset:4096
    ds_read_b64_tr_b16 v[118:119], v9 offset:6144
    ds_read_b64_tr_b16 v[120:121], v10 offset:4096
    ds_read_b64_tr_b16 v[122:123], v10 offset:6144
    ds_read_b64_tr_b16 v[124:125], v11 offset:4096
    ds_read_b64_tr_b16 v[126:127], v11 offset:6144
    s_waitcnt lgkmcnt(0)
    v_mfma_f32_16x16x32_bf16 v[64:67], v[112:115], v[156:159], v[64:67]
    v_mfma_f32_16x16x32_bf16 v[68:71], v[112:115], v[160:163], v[68:71]
    v_mfma_f32_16x16x32_bf16 v[72:75], v[112:115], v[164:167], v[72:75]
    v_mfma_f32_16x16x32_bf16 v[76:79], v[116:119], v[156:159], v[76:79]
    v_mfma_f32_16x16x32_bf16 v[80:83], v[116:119], v[160:163], v[80:83]
    v_mfma_f32_16x16x32_bf16 v[84:87], v[116:119], v[164:167], v[84:87]
    v_mfma_f32_16x16x32_bf16 v[88:91], v[120:123], v[156:159], v[88:91]
    v_mfma_f32_16x16x32_bf16 v[92:95], v[120:123], v[160:163], v[92:95]
    v_mfma_f32_16x16x32_bf16 v[96:99], v[120:123], v[164:167], v[96:99]
    v_mfma_f32_16x16x32_bf16 v[100:103], v[124:127], v[156:159], v[100:103]
    v_mfma_f32_16x16x32_bf16 v[104:107], v[124:127], v[160:163], v[104:107]
    v_mfma_f32_16x16x32_bf16 v[108:111], v[124:127], v[164:167], v[108:111]
    s_add_u32 s43, s40, 4096
    s_add_u32 s44, s42, 716800
    s_mov_b32 m0, s43
    s_nop 0
    buffer_load_dwordx4 v4, s[4:7], s44 offen lds
    s_add_u32 s43, s43, 1024
    s_add_u32 s44, s44, 7168
    s_mov_b32 m0, s43
    s_nop 0
    buffer_load_dwordx4 v5, s[4:7], s44 offen lds
    s_add_u32 s43, s43, 1024
    s_add_u32 s44, s44, 7168
    s_mov_b32 m0, s43
    s_nop 0
    buffer_load_dwordx4 v6, s[4:7], s44 offen lds
    s_add_u32 s43, s43, 1024
    s_add_u32 s44, s44, 7168
    s_mov_b32 m0, s43
    s_nop 0
    buffer_load_dwordx4 v7, s[4:7], s44 offen lds
    s_mov_b32 s45, 24576
    buffer_load_dwordx4 v[156:159], v12, s[8:11], s45 offen offset:1024
    buffer_load_dwordx4 v[160:163], v13, s[8:11], s45 offen offset:1024
    buffer_load_dwordx4 v[164:167], v14, s[8:11], s45 offen offset:1024
    s_waitcnt vmcnt(49)
    ds_read_b64_tr_b16 v[112:113], v8 offset:8192
    ds_read_b64_tr_b16 v[114:115], v8 offset:10240
    ds_read_b64_tr_b16 v[116:117], v9 offset:8192
    ds_read_b64_tr_b16 v[118:119], v9 offset:10240
    ds_read_b64_tr_b16 v[120:121], v10 offset:8192
    ds_read_b64_tr_b16 v[122:123], v10 offset:10240
    ds_read_b64_tr_b16 v[124:125], v11 offset:8192
    ds_read_b64_tr_b16 v[126:127], v11 offset:10240
    s_waitcnt lgkmcnt(0)
    v_mfma_f32_16x16x32_bf16 v[64:67], v[112:115], v[168:171], v[64:67]
    v_mfma_f32_16x16x32_bf16 v[68:71], v[112:115], v[172:175], v[68:71]
    v_mfma_f32_16x16x32_bf16 v[72:75], v[112:115], v[176:179], v[72:75]
    v_mfma_f32_16x16x32_bf16 v[76:79], v[116:119], v[168:171], v[76:79]
    v_mfma_f32_16x16x32_bf16 v[80:83], v[116:119], v[172:175], v[80:83]
    v_mfma_f32_16x16x32_bf16 v[84:87], v[116:119], v[176:179], v[84:87]
    v_mfma_f32_16x16x32_bf16 v[88:91], v[120:123], v[168:171], v[88:91]
    v_mfma_f32_16x16x32_bf16 v[92:95], v[120:123], v[172:175], v[92:95]
    v_mfma_f32_16x16x32_bf16 v[96:99], v[120:123], v[176:179], v[96:99]
    v_mfma_f32_16x16x32_bf16 v[100:103], v[124:127], v[168:171], v[100:103]
    v_mfma_f32_16x16x32_bf16 v[104:107], v[124:127], v[172:175], v[104:107]
    v_mfma_f32_16x16x32_bf16 v[108:111], v[124:127], v[176:179], v[108:111]
    s_add_u32 s43, s40, 8192
    s_add_u32 s44, s42, 745472
    s_mov_b32 m0, s43
    s_nop 0
    buffer_load_dwordx4 v4, s[4:7], s44 offen lds
    s_add_u32 s43, s43, 1024
    s_add_u32 s44, s44, 7168
    s_mov_b32 m0, s43
    s_nop 0
    buffer_load_dwordx4 v5, s[4:7], s44 offen lds
    s_add_u32 s43, s43, 1024
    s_add_u32 s44, s44, 7168
    s_mov_b32 m0, s43
    s_nop 0
    buffer_load_dwordx4 v6, s[4:7], s44 offen lds
    s_add_u32 s43, s43, 1024
    s_add_u32 s44, s44, 7168
    s_mov_b32 m0, s43
    s_nop 0
    buffer_load_dwordx4 v7, s[4:7], s44 offen lds
    s_mov_b32 s45, 24576
    buffer_load_dwordx4 v[168:171], v12, s[8:11], s45 offen offset:2048
    buffer_load_dwordx4 v[172:175], v13, s[8:11], s45 offen offset:2048
    buffer_load_dwordx4 v[176:179], v14, s[8:11], s45 offen offset:2048
    s_waitcnt vmcnt(49)
    ds_read_b64_tr_b16 v[112:113], v8 offset:12288
    ds_read_b64_tr_b16 v[114:115], v8 offset:14336
    ds_read_b64_tr_b16 v[116:117], v9 offset:12288
    ds_read_b64_tr_b16 v[118:119], v9 offset:14336
    ds_read_b64_tr_b16 v[120:121], v10 offset:12288
    ds_read_b64_tr_b16 v[122:123], v10 offset:14336
    ds_read_b64_tr_b16 v[124:125], v11 offset:12288
    ds_read_b64_tr_b16 v[126:127], v11 offset:14336
    s_waitcnt lgkmcnt(0)
    v_mfma_f32_16x16x32_bf16 v[64:67], v[112:115], v[180:183], v[64:67]
    v_mfma_f32_16x16x32_bf16 v[68:71], v[112:115], v[184:187], v[68:71]
    v_mfma_f32_16x16x32_bf16 v[72:75], v[112:115], v[188:191], v[72:75]
    v_mfma_f32_16x16x32_bf16 v[76:79], v[116:119], v[180:183], v[76:79]
    v_mfma_f32_16x16x32_bf16 v[80:83], v[116:119], v[184:187], v[80:83]
    v_mfma_f32_16x16x32_bf16 v[84:87], v[116:119], v[188:191], v[84:87]
    v_mfma_f32_16x16x32_bf16 v[88:91], v[120:123], v[180:183], v[88:91]
    v_mfma_f32_16x16x32_bf16 v[92:95], v[120:123], v[184:187], v[92:95]
    v_mfma_f32_16x16x32_bf16 v[96:99], v[120:123], v[188:191], v[96:99]
    v_mfma_f32_16x16x32_bf16 v[100:103], v[124:127], v[180:183], v[100:103]
    v_mfma_f32_16x16x32_bf16 v[104:107], v[124:127], v[184:187], v[104:107]
    v_mfma_f32_16x16x32_bf16 v[108:111], v[124:127], v[188:191], v[108:111]
    s_add_u32 s43, s40, 12288
    s_add_u32 s44, s42, 774144
    s_mov_b32 m0, s43
    s_nop 0
    buffer_load_dwordx4 v4, s[4:7], s44 offen lds
    s_add_u32 s43, s43, 1024
    s_add_u32 s44, s44, 7168
    s_mov_b32 m0, s43
    s_nop 0
    buffer_load_dwordx4 v5, s[4:7], s44 offen lds
    s_add_u32 s43, s43, 1024
    s_add_u32 s44, s44, 7168
    s_mov_b32 m0, s43
    s_nop 0
    buffer_load_dwordx4 v6, s[4:7], s44 offen lds
    s_add_u32 s43, s43, 1024
    s_add_u32 s44, s44, 7168
    s_mov_b32 m0, s43
    s_nop 0
    buffer_load_dwordx4 v7, s[4:7], s44 offen lds
    s_mov_b32 s45, 24576
    buffer_load_dwordx4 v[180:183], v12, s[8:11], s45 offen offset:3072
    buffer_load_dwordx4 v[184:187], v13, s[8:11], s45 offen offset:3072
    buffer_load_dwordx4 v[188:191], v14, s[8:11], s45 offen offset:3072
    s_waitcnt vmcnt(49)
    ds_read_b64_tr_b16 v[112:113], v8 offset:16384
    ds_read_b64_tr_b16 v[114:115], v8 offset:18432
    ds_read_b64_tr_b16 v[116:117], v9 offset:16384
    ds_read_b64_tr_b16 v[118:119], v9 offset:18432
    ds_read_b64_tr_b16 v[120:121], v10 offset:16384
    ds_read_b64_tr_b16 v[122:123], v10 offset:18432
    ds_read_b64_tr_b16 v[124:125], v11 offset:16384
    ds_read_b64_tr_b16 v[126:127], v11 offset:18432
    s_waitcnt lgkmcnt(0)
    v_mfma_f32_16x16x32_bf16 v[64:67], v[112:115], v[192:195], v[64:67]
    v_mfma_f32_16x16x32_bf16 v[68:71], v[112:115], v[196:199], v[68:71]
    v_mfma_f32_16x16x32_bf16 v[72:75], v[112:115], v[200:203], v[72:75]
    v_mfma_f32_16x16x32_bf16 v[76:79], v[116:119], v[192:195], v[76:79]
    v_mfma_f32_16x16x32_bf16 v[80:83], v[116:119], v[196:199], v[80:83]
    v_mfma_f32_16x16x32_bf16 v[84:87], v[116:119], v[200:203], v[84:87]
    v_mfma_f32_16x16x32_bf16 v[88:91], v[120:123], v[192:195], v[88:91]
    v_mfma_f32_16x16x32_bf16 v[92:95], v[120:123], v[196:199], v[92:95]
    v_mfma_f32_16x16x32_bf16 v[96:99], v[120:123], v[200:203], v[96:99]
    v_mfma_f32_16x16x32_bf16 v[100:103], v[124:127], v[192:195], v[100:103]
    v_mfma_f32_16x16x32_bf16 v[104:107], v[124:127], v[196:199], v[104:107]
    v_mfma_f32_16x16x32_bf16 v[108:111], v[124:127], v[200:203], v[108:111]
    s_add_u32 s43, s40, 16384
    s_add_u32 s44, s42, 802816
    s_mov_b32 m0, s43
    s_nop 0
    buffer_load_dwordx4 v4, s[4:7], s44 offen lds
    s_add_u32 s43, s43, 1024
    s_add_u32 s44, s44, 7168
    s_mov_b32 m0, s43
    s_nop 0
    buffer_load_dwordx4 v5, s[4:7], s44 offen lds
    s_add_u32 s43, s43, 1024
    s_add_u32 s44, s44, 7168
    s_mov_b32 m0, s43
    s_nop 0
    buffer_load_dwordx4 v6, s[4:7], s44 offen lds
    s_add_u32 s43, s43, 1024
    s_add_u32 s44, s44, 7168
    s_mov_b32 m0, s43
    s_nop 0
    buffer_load_dwordx4 v7, s[4:7], s44 offen lds
    s_mov_b32 s45, 28672
    buffer_load_dwordx4 v[192:195], v12, s[8:11], s45 offen offset:0
    buffer_load_dwordx4 v[196:199], v13, s[8:11], s45 offen offset:0
    buffer_load_dwordx4 v[200:203], v14, s[8:11], s45 offen offset:0
    s_waitcnt vmcnt(49)
    ds_read_b64_tr_b16 v[112:113], v8 offset:20480
    ds_read_b64_tr_b16 v[114:115], v8 offset:22528
    ds_read_b64_tr_b16 v[116:117], v9 offset:20480
    ds_read_b64_tr_b16 v[118:119], v9 offset:22528
    ds_read_b64_tr_b16 v[120:121], v10 offset:20480
    ds_read_b64_tr_b16 v[122:123], v10 offset:22528
    ds_read_b64_tr_b16 v[124:125], v11 offset:20480
    ds_read_b64_tr_b16 v[126:127], v11 offset:22528
    s_waitcnt lgkmcnt(0)
    v_mfma_f32_16x16x32_bf16 v[64:67], v[112:115], v[204:207], v[64:67]
    v_mfma_f32_16x16x32_bf16 v[68:71], v[112:115], v[208:211], v[68:71]
    v_mfma_f32_16x16x32_bf16 v[72:75], v[112:115], v[212:215], v[72:75]
    v_mfma_f32_16x16x32_bf16 v[76:79], v[116:119], v[204:207], v[76:79]
    v_mfma_f32_16x16x32_bf16 v[80:83], v[116:119], v[208:211], v[80:83]
    v_mfma_f32_16x16x32_bf16 v[84:87], v[116:119], v[212:215], v[84:87]
    v_mfma_f32_16x16x32_bf16 v[88:91], v[120:123], v[204:207], v[88:91]
    v_mfma_f32_16x16x32_bf16 v[92:95], v[120:123], v[208:211], v[92:95]
    v_mfma_f32_16x16x32_bf16 v[96:99], v[120:123], v[212:215], v[96:99]
    v_mfma_f32_16x16x32_bf16 v[100:103], v[124:127], v[204:207], v[100:103]
    v_mfma_f32_16x16x32_bf16 v[104:107], v[124:127], v[208:211], v[104:107]
    v_mfma_f32_16x16x32_bf16 v[108:111], v[124:127], v[212:215], v[108:111]
    s_add_u32 s43, s40, 20480
    s_add_u32 s44, s42, 831488
    s_mov_b32 m0, s43
    s_nop 0
    buffer_load_dwordx4 v4, s[4:7], s44 offen lds
    s_add_u32 s43, s43, 1024
    s_add_u32 s44, s44, 7168
    s_mov_b32 m0, s43
    s_nop 0
    buffer_load_dwordx4 v5, s[4:7], s44 offen lds
    s_add_u32 s43, s43, 1024
    s_add_u32 s44, s44, 7168
    s_mov_b32 m0, s43
    s_nop 0
    buffer_load_dwordx4 v6, s[4:7], s44 offen lds
    s_add_u32 s43, s43, 1024
    s_add_u32 s44, s44, 7168
    s_mov_b32 m0, s43
    s_nop 0
    buffer_load_dwordx4 v7, s[4:7], s44 offen lds
    s_mov_b32 s45, 28672
    buffer_load_dwordx4 v[204:207], v12, s[8:11], s45 offen offset:1024
    buffer_load_dwordx4 v[208:211], v13, s[8:11], s45 offen offset:1024
    buffer_load_dwordx4 v[212:215], v14, s[8:11], s45 offen offset:1024
    s_waitcnt vmcnt(49)
    ds_read_b64_tr_b16 v[112:113], v8 offset:24576
    ds_read_b64_tr_b16 v[114:115], v8 offset:26624
    ds_read_b64_tr_b16 v[116:117], v9 offset:24576
    ds_read_b64_tr_b16 v[118:119], v9 offset:26624
    ds_read_b64_tr_b16 v[120:121], v10 offset:24576
    ds_read_b64_tr_b16 v[122:123], v10 offset:26624
    ds_read_b64_tr_b16 v[124:125], v11 offset:24576
    ds_read_b64_tr_b16 v[126:127], v11 offset:26624
    s_waitcnt lgkmcnt(0)
    v_mfma_f32_16x16x32_bf16 v[64:67], v[112:115], v[216:219], v[64:67]
    v_mfma_f32_16x16x32_bf16 v[68:71], v[112:115], v[220:223], v[68:71]
    v_mfma_f32_16x16x32_bf16 v[72:75], v[112:115], v[224:227], v[72:75]
    v_mfma_f32_16x16x32_bf16 v[76:79], v[116:119], v[216:219], v[76:79]
    v_mfma_f32_16x16x32_bf16 v[80:83], v[116:119], v[220:223], v[80:83]
    v_mfma_f32_16x16x32_bf16 v[84:87], v[116:119], v[224:227], v[84:87]
    v_mfma_f32_16x16x32_bf16 v[88:91], v[120:123], v[216:219], v[88:91]
    v_mfma_f32_16x16x32_bf16 v[92:95], v[120:123], v[220:223], v[92:95]
    v_mfma_f32_16x16x32_bf16 v[96:99], v[120:123], v[224:227], v[96:99]
    v_mfma_f32_16x16x32_bf16 v[100:103], v[124:127], v[216:219], v[100:103]
    v_mfma_f32_16x16x32_bf16 v[104:107], v[124:127], v[220:223], v[104:107]
    v_mfma_f32_16x16x32_bf16 v[108:111], v[124:127], v[224:227], v[108:111]
    s_add_u32 s43, s40, 24576
    s_add_u32 s44, s42, 860160
    s_mov_b32 m0, s43
    s_nop 0
    buffer_load_dwordx4 v4, s[4:7], s44 offen lds
    s_add_u32 s43, s43, 1024
    s_add_u32 s44, s44, 7168
    s_mov_b32 m0, s43
    s_nop 0
    buffer_load_dwordx4 v5, s[4:7], s44 offen lds
    s_add_u32 s43, s43, 1024
    s_add_u32 s44, s44, 7168
    s_mov_b32 m0, s43
    s_nop 0
    buffer_load_dwordx4 v6, s[4:7], s44 offen lds
    s_add_u32 s43, s43, 1024
    s_add_u32 s44, s44, 7168
    s_mov_b32 m0, s43
    s_nop 0
    buffer_load_dwordx4 v7, s[4:7], s44 offen lds
    s_mov_b32 s45, 28672
    buffer_load_dwordx4 v[216:219], v12, s[8:11], s45 offen offset:2048
    buffer_load_dwordx4 v[220:223], v13, s[8:11], s45 offen offset:2048
    buffer_load_dwordx4 v[224:227], v14, s[8:11], s45 offen offset:2048
    s_waitcnt vmcnt(49)
    ds_read_b64_tr_b16 v[112:113], v8 offset:28672
    ds_read_b64_tr_b16 v[114:115], v8 offset:30720
    ds_read_b64_tr_b16 v[116:117], v9 offset:28672
    ds_read_b64_tr_b16 v[118:119], v9 offset:30720
    ds_read_b64_tr_b16 v[120:121], v10 offset:28672
    ds_read_b64_tr_b16 v[122:123], v10 offset:30720
    ds_read_b64_tr_b16 v[124:125], v11 offset:28672
    ds_read_b64_tr_b16 v[126:127], v11 offset:30720
    s_waitcnt lgkmcnt(0)
    v_mfma_f32_16x16x32_bf16 v[64:67], v[112:115], v[228:231], v[64:67]
    v_mfma_f32_16x16x32_bf16 v[68:71], v[112:115], v[232:235], v[68:71]
    v_mfma_f32_16x16x32_bf16 v[72:75], v[112:115], v[236:239], v[72:75]
    v_mfma_f32_16x16x32_bf16 v[76:79], v[116:119], v[228:231], v[76:79]
    v_mfma_f32_16x16x32_bf16 v[80:83], v[116:119], v[232:235], v[80:83]
    v_mfma_f32_16x16x32_bf16 v[84:87], v[116:119], v[236:239], v[84:87]
    v_mfma_f32_16x16x32_bf16 v[88:91], v[120:123], v[228:231], v[88:91]
    v_mfma_f32_16x16x32_bf16 v[92:95], v[120:123], v[232:235], v[92:95]
    v_mfma_f32_16x16x32_bf16 v[96:99], v[120:123], v[236:239], v[96:99]
    v_mfma_f32_16x16x32_bf16 v[100:103], v[124:127], v[228:231], v[100:103]
    v_mfma_f32_16x16x32_bf16 v[104:107], v[124:127], v[232:235], v[104:107]
    v_mfma_f32_16x16x32_bf16 v[108:111], v[124:127], v[236:239], v[108:111]
    s_add_u32 s43, s40, 28672
    s_add_u32 s44, s42, 888832
    s_mov_b32 m0, s43
    s_nop 0
    buffer_load_dwordx4 v4, s[4:7], s44 offen lds
    s_add_u32 s43, s43, 1024
    s_add_u32 s44, s44, 7168
    s_mov_b32 m0, s43
    s_nop 0
    buffer_load_dwordx4 v5, s[4:7], s44 offen lds
    s_add_u32 s43, s43, 1024
    s_add_u32 s44, s44, 7168
    s_mov_b32 m0, s43
    s_nop 0
    buffer_load_dwordx4 v6, s[4:7], s44 offen lds
    s_add_u32 s43, s43, 1024
    s_add_u32 s44, s44, 7168
    s_mov_b32 m0, s43
    s_nop 0
    buffer_load_dwordx4 v7, s[4:7], s44 offen lds
    s_mov_b32 s45, 28672
    buffer_load_dwordx4 v[228:231], v12, s[8:11], s45 offen offset:3072
    buffer_load_dwordx4 v[232:235], v13, s[8:11], s45 offen offset:3072
    buffer_load_dwordx4 v[236:239], v14, s[8:11], s45 offen offset:3072
    s_waitcnt vmcnt(49)
    ds_read_b64_tr_b16 v[112:113], v8 offset:0
    ds_read_b64_tr_b16 v[114:115], v8 offset:2048
    ds_read_b64_tr_b16 v[116:117], v9 offset:0
    ds_read_b64_tr_b16 v[118:119], v9 offset:2048
    ds_read_b64_tr_b16 v[120:121], v10 offset:0
    ds_read_b64_tr_b16 v[122:123], v10 offset:2048
    ds_read_b64_tr_b16 v[124:125], v11 offset:0
    ds_read_b64_tr_b16 v[126:127], v11 offset:2048
    s_waitcnt lgkmcnt(0)
    v_mfma_f32_16x16x32_bf16 v[64:67], v[112:115], v[144:147], v[64:67]
    v_mfma_f32_16x16x32_bf16 v[68:71], v[112:115], v[148:151], v[68:71]
    v_mfma_f32_16x16x32_bf16 v[72:75], v[112:115], v[152:155], v[72:75]
    v_mfma_f32_16x16x32_bf16 v[76:79], v[116:119], v[144:147], v[76:79]
    v_mfma_f32_16x16x32_bf16 v[80:83], v[116:119], v[148:151], v[80:83]
    v_mfma_f32_16x16x32_bf16 v[84:87], v[116:119], v[152:155], v[84:87]
    v_mfma_f32_16x16x32_bf16 v[88:91], v[120:123], v[144:147], v[88:91]
    v_mfma_f32_16x16x32_bf16 v[92:95], v[120:123], v[148:151], v[92:95]
    v_mfma_f32_16x16x32_bf16 v[96:99], v[120:123], v[152:155], v[96:99]
    v_mfma_f32_16x16x32_bf16 v[100:103], v[124:127], v[144:147], v[100:103]
    v_mfma_f32_16x16x32_bf16 v[104:107], v[124:127], v[148:151], v[104:107]
    v_mfma_f32_16x16x32_bf16 v[108:111], v[124:127], v[152:155], v[108:111]
    s_waitcnt vmcnt(42)
    ds_read_b64_tr_b16 v[112:113], v8 offset:4096
    ds_read_b64_tr_b16 v[114:115], v8 offset:6144
    ds_read_b64_tr_b16 v[116:117], v9 offset:4096
    ds_read_b64_tr_b16 v[118:119], v9 offset:6144
    ds_read_b64_tr_b16 v[120:121], v10 offset:4096
    ds_read_b64_tr_b16 v[122:123], v10 offset:6144
    ds_read_b64_tr_b16 v[124:125], v11 offset:4096
    ds_read_b64_tr_b16 v[126:127], v11 offset:6144
    s_waitcnt lgkmcnt(0)
    v_mfma_f32_16x16x32_bf16 v[64:67], v[112:115], v[156:159], v[64:67]
    v_mfma_f32_16x16x32_bf16 v[68:71], v[112:115], v[160:163], v[68:71]
    v_mfma_f32_16x16x32_bf16 v[72:75], v[112:115], v[164:167], v[72:75]
    v_mfma_f32_16x16x32_bf16 v[76:79], v[116:119], v[156:159], v[76:79]
    v_mfma_f32_16x16x32_bf16 v[80:83], v[116:119], v[160:163], v[80:83]
    v_mfma_f32_16x16x32_bf16 v[84:87], v[116:119], v[164:167], v[84:87]
    v_mfma_f32_16x16x32_bf16 v[88:91], v[120:123], v[156:159], v[88:91]
    v_mfma_f32_16x16x32_bf16 v[92:95], v[120:123], v[160:163], v[92:95]
    v_mfma_f32_16x16x32_bf16 v[96:99], v[120:123], v[164:167], v[96:99]
    v_mfma_f32_16x16x32_bf16 v[100:103], v[124:127], v[156:159], v[100:103]
    v_mfma_f32_16x16x32_bf16 v[104:107], v[124:127], v[160:163], v[104:107]
    v_mfma_f32_16x16x32_bf16 v[108:111], v[124:127], v[164:167], v[108:111]
    s_waitcnt vmcnt(35)
    ds_read_b64_tr_b16 v[112:113], v8 offset:8192
    ds_read_b64_tr_b16 v[114:115], v8 offset:10240
    ds_read_b64_tr_b16 v[116:117], v9 offset:8192
    ds_read_b64_tr_b16 v[118:119], v9 offset:10240
    ds_read_b64_tr_b16 v[120:121], v10 offset:8192
    ds_read_b64_tr_b16 v[122:123], v10 offset:10240
    ds_read_b64_tr_b16 v[124:125], v11 offset:8192
    ds_read_b64_tr_b16 v[126:127], v11 offset:10240
    s_waitcnt lgkmcnt(0)
    v_mfma_f32_16x16x32_bf16 v[64:67], v[112:115], v[168:171], v[64:67]
    v_mfma_f32_16x16x32_bf16 v[68:71], v[112:115], v[172:175], v[68:71]
    v_mfma_f32_16x16x32_bf16 v[72:75], v[112:115], v[176:179], v[72:75]
    v_mfma_f32_16x16x32_bf16 v[76:79], v[116:119], v[168:171], v[76:79]
    v_mfma_f32_16x16x32_bf16 v[80:83], v[116:119], v[172:175], v[80:83]
    v_mfma_f32_16x16x32_bf16 v[84:87], v[116:119], v[176:179], v[84:87]
    v_mfma_f32_16x16x32_bf16 v[88:91], v[120:123], v[168:171], v[88:91]
    v_mfma_f32_16x16x32_bf16 v[92:95], v[120:123], v[172:175], v[92:95]
    v_mfma_f32_16x16x32_bf16 v[96:99], v[120:123], v[176:179], v[96:99]
    v_mfma_f32_16x16x32_bf16 v[100:103], v[124:127], v[168:171], v[100:103]
    v_mfma_f32_16x16x32_bf16 v[104:107], v[124:127], v[172:175], v[104:107]
    v_mfma_f32_16x16x32_bf16 v[108:111], v[124:127], v[176:179], v[108:111]
    s_waitcnt vmcnt(28)
    ds_read_b64_tr_b16 v[112:113], v8 offset:12288
    ds_read_b64_tr_b16 v[114:115], v8 offset:14336
    ds_read_b64_tr_b16 v[116:117], v9 offset:12288
    ds_read_b64_tr_b16 v[118:119], v9 offset:14336
    ds_read_b64_tr_b16 v[120:121], v10 offset:12288
    ds_read_b64_tr_b16 v[122:123], v10 offset:14336
    ds_read_b64_tr_b16 v[124:125], v11 offset:12288
    ds_read_b64_tr_b16 v[126:127], v11 offset:14336
    s_waitcnt lgkmcnt(0)
    v_mfma_f32_16x16x32_bf16 v[64:67], v[112:115], v[180:183], v[64:67]
    v_mfma_f32_16x16x32_bf16 v[68:71], v[112:115], v[184:187], v[68:71]
    v_mfma_f32_16x16x32_bf16 v[72:75], v[112:115], v[188:191], v[72:75]
    v_mfma_f32_16x16x32_bf16 v[76:79], v[116:119], v[180:183], v[76:79]
    v_mfma_f32_16x16x32_bf16 v[80:83], v[116:119], v[184:187], v[80:83]
    v_mfma_f32_16x16x32_bf16 v[84:87], v[116:119], v[188:191], v[84:87]
    v_mfma_f32_16x16x32_bf16 v[88:91], v[120:123], v[180:183], v[88:91]
    v_mfma_f32_16x16x32_bf16 v[92:95], v[120:123], v[184:187], v[92:95]
    v_mfma_f32_16x16x32_bf16 v[96:99], v[120:123], v[188:191], v[96:99]
    v_mfma_f32_16x16x32_bf16 v[100:103], v[124:127], v[180:183], v[100:103]
    v_mfma_f32_16x16x32_bf16 v[104:107], v[124:127], v[184:187], v[104:107]
    v_mfma_f32_16x16x32_bf16 v[108:111], v[124:127], v[188:191], v[108:111]
    s_waitcnt vmcnt(21)
    ds_read_b64_tr_b16 v[112:113], v8 offset:16384
    ds_read_b64_tr_b16 v[114:115], v8 offset:18432
    ds_read_b64_tr_b16 v[116:117], v9 offset:16384
    ds_read_b64_tr_b16 v[118:119], v9 offset:18432
    ds_read_b64_tr_b16 v[120:121], v10 offset:16384
    ds_read_b64_tr_b16 v[122:123], v10 offset:18432
    ds_read_b64_tr_b16 v[124:125], v11 offset:16384
    ds_read_b64_tr_b16 v[126:127], v11 offset:18432
    s_waitcnt lgkmcnt(0)
    v_mfma_f32_16x16x32_bf16 v[64:67], v[112:115], v[192:195], v[64:67]
    v_mfma_f32_16x16x32_bf16 v[68:71], v[112:115], v[196:199], v[68:71]
    v_mfma_f32_16x16x32_bf16 v[72:75], v[112:115], v[200:203], v[72:75]
    v_mfma_f32_16x16x32_bf16 v[76:79], v[116:119], v[192:195], v[76:79]
    v_mfma_f32_16x16x32_bf16 v[80:83], v[116:119], v[196:199], v[80:83]
    v_mfma_f32_16x16x32_bf16 v[84:87], v[116:119], v[200:203], v[84:87]
    v_mfma_f32_16x16x32_bf16 v[88:91], v[120:123], v[192:195], v[88:91]
    v_mfma_f32_16x16x32_bf16 v[92:95], v[120:123], v[196:199], v[92:95]
    v_mfma_f32_16x16x32_bf16 v[96:99], v[120:123], v[200:203], v[96:99]
    v_mfma_f32_16x16x32_bf16 v[100:103], v[124:127], v[192:195], v[100:103]
    v_mfma_f32_16x16x32_bf16 v[104:107], v[124:127], v[196:199], v[104:107]
    v_mfma_f32_16x16x32_bf16 v[108:111], v[124:127], v[200:203], v[108:111]
    s_waitcnt vmcnt(14)
    ds_read_b64_tr_b16 v[112:113], v8 offset:20480
    ds_read_b64_tr_b16 v[114:115], v8 offset:22528
    ds_read_b64_tr_b16 v[116:117], v9 offset:20480
    ds_read_b64_tr_b16 v[118:119], v9 offset:22528
    ds_read_b64_tr_b16 v[120:121], v10 offset:20480
    ds_read_b64_tr_b16 v[122:123], v10 offset:22528
    ds_read_b64_tr_b16 v[124:125], v11 offset:20480
    ds_read_b64_tr_b16 v[126:127], v11 offset:22528
    s_waitcnt lgkmcnt(0)
    v_mfma_f32_16x16x32_bf16 v[64:67], v[112:115], v[204:207], v[64:67]
    v_mfma_f32_16x16x32_bf16 v[68:71], v[112:115], v[208:211], v[68:71]
    v_mfma_f32_16x16x32_bf16 v[72:75], v[112:115], v[212:215], v[72:75]
    v_mfma_f32_16x16x32_bf16 v[76:79], v[116:119], v[204:207], v[76:79]
    v_mfma_f32_16x16x32_bf16 v[80:83], v[116:119], v[208:211], v[80:83]
    v_mfma_f32_16x16x32_bf16 v[84:87], v[116:119], v[212:215], v[84:87]
    v_mfma_f32_16x16x32_bf16 v[88:91], v[120:123], v[204:207], v[88:91]
    v_mfma_f32_16x16x32_bf16 v[92:95], v[120:123], v[208:211], v[92:95]
    v_mfma_f32_16x16x32_bf16 v[96:99], v[120:123], v[212:215], v[96:99]
    v_mfma_f32_16x16x32_bf16 v[100:103], v[124:127], v[204:207], v[100:103]
    v_mfma_f32_16x16x32_bf16 v[104:107], v[124:127], v[208:211], v[104:107]
    v_mfma_f32_16x16x32_bf16 v[108:111], v[124:127], v[212:215], v[108:111]
    s_waitcnt vmcnt(7)
    ds_read_b64_tr_b16 v[112:113], v8 offset:24576
    ds_read_b64_tr_b16 v[114:115], v8 offset:26624
    ds_read_b64_tr_b16 v[116:117], v9 offset:24576
    ds_read_b64_tr_b16 v[118:119], v9 offset:26624
    ds_read_b64_tr_b16 v[120:121], v10 offset:24576
    ds_read_b64_tr_b16 v[122:123], v10 offset:26624
    ds_read_b64_tr_b16 v[124:125], v11 offset:24576
    ds_read_b64_tr_b16 v[126:127], v11 offset:26624
    s_waitcnt lgkmcnt(0)
    v_mfma_f32_16x16x32_bf16 v[64:67], v[112:115], v[216:219], v[64:67]
    v_mfma_f32_16x16x32_bf16 v[68:71], v[112:115], v[220:223], v[68:71]
    v_mfma_f32_16x16x32_bf16 v[72:75], v[112:115], v[224:227], v[72:75]
    v_mfma_f32_16x16x32_bf16 v[76:79], v[116:119], v[216:219], v[76:79]
    v_mfma_f32_16x16x32_bf16 v[80:83], v[116:119], v[220:223], v[80:83]
    v_mfma_f32_16x16x32_bf16 v[84:87], v[116:119], v[224:227], v[84:87]
    v_mfma_f32_16x16x32_bf16 v[88:91], v[120:123], v[216:219], v[88:91]
    v_mfma_f32_16x16x32_bf16 v[92:95], v[120:123], v[220:223], v[92:95]
    v_mfma_f32_16x16x32_bf16 v[96:99], v[120:123], v[224:227], v[96:99]
    v_mfma_f32_16x16x32_bf16 v[100:103], v[124:127], v[216:219], v[100:103]
    v_mfma_f32_16x16x32_bf16 v[104:107], v[124:127], v[220:223], v[104:107]
    v_mfma_f32_16x16x32_bf16 v[108:111], v[124:127], v[224:227], v[108:111]
    s_waitcnt vmcnt(0)
    ds_read_b64_tr_b16 v[112:113], v8 offset:28672
    ds_read_b64_tr_b16 v[114:115], v8 offset:30720
    ds_read_b64_tr_b16 v[116:117], v9 offset:28672
    ds_read_b64_tr_b16 v[118:119], v9 offset:30720
    ds_read_b64_tr_b16 v[120:121], v10 offset:28672
    ds_read_b64_tr_b16 v[122:123], v10 offset:30720
    ds_read_b64_tr_b16 v[124:125], v11 offset:28672
    ds_read_b64_tr_b16 v[126:127], v11 offset:30720
    s_waitcnt lgkmcnt(0)
    v_mfma_f32_16x16x32_bf16 v[64:67], v[112:115], v[228:231], v[64:67]
    v_mfma_f32_16x16x32_bf16 v[68:71], v[112:115], v[232:235], v[68:71]
    v_mfma_f32_16x16x32_bf16 v[72:75], v[112:115], v[236:239], v[72:75]
    v_mfma_f32_16x16x32_bf16 v[76:79], v[116:119], v[228:231], v[76:79]
    v_mfma_f32_16x16x32_bf16 v[80:83], v[116:119], v[232:235], v[80:83]
    v_mfma_f32_16x16x32_bf16 v[84:87], v[116:119], v[236:239], v[84:87]
    v_mfma_f32_16x16x32_bf16 v[88:91], v[120:123], v[228:231], v[88:91]
    v_mfma_f32_16x16x32_bf16 v[92:95], v[120:123], v[232:235], v[92:95]
    v_mfma_f32_16x16x32_bf16 v[96:99], v[120:123], v[236:239], v[96:99]
    v_mfma_f32_16x16x32_bf16 v[100:103], v[124:127], v[228:231], v[100:103]
    v_mfma_f32_16x16x32_bf16 v[104:107], v[124:127], v[232:235], v[104:107]
    v_mfma_f32_16x16x32_bf16 v[108:111], v[124:127], v[236:239], v[108:111]
    s_nop 7
    s_nop 7
    s_barrier
    v_lshlrev_b32 v29, 4, v1
    s_mul_i32 s43, s34, 12288
    v_add_u32 v32, s43, v29
    ds_write_b128 v32, v[64:67] offset:0
    ds_write_b128 v32, v[68:71] offset:1024
    ds_write_b128 v32, v[72:75] offset:2048
    ds_write_b128 v32, v[76:79] offset:3072
    ds_write_b128 v32, v[80:83] offset:4096
    ds_write_b128 v32, v[84:87] offset:5120
    ds_write_b128 v32, v[88:91] offset:6144
    ds_write_b128 v32, v[92:95] offset:7168
    ds_write_b128 v32, v[96:99] offset:8192
    ds_write_b128 v32, v[100:103] offset:9216
    ds_write_b128 v32, v[104:107] offset:10240
    ds_write_b128 v32, v[108:111] offset:11264
    s_waitcnt lgkmcnt(0)
    s_barrier
    s_mul_i32 s43, s34, 3072
    v_add_u32 v32, s43, v29
    ds_read_b128 v[112:115], v32 offset:0
    ds_read_b128 v[116:119], v32 offset:12288
    ds_read_b128 v[120:123], v32 offset:24576
    ds_read_b128 v[124:127], v32 offset:36864
    s_waitcnt lgkmcnt(0)
    v_add_f32 v112, v112, v116
    v_add_f32 v120, v120, v124
    v_add_f32 v112, v112, v120
    v_add_f32 v113, v113, v117
    v_add_f32 v121, v121, v125
    v_add_f32 v113, v113, v121
    v_add_f32 v114, v114, v118
    v_add_f32 v122, v122, v126
    v_add_f32 v114, v114, v122
    v_add_f32 v115, v115, v119
    v_add_f32 v123, v123, v127
    v_add_f32 v115, v115, v123
    v_cvt_pk_bf16_f32 v144, v112, v113
    v_cvt_pk_bf16_f32 v145, v114, v115
    ds_read_b128 v[112:115], v32 offset:1024
    ds_read_b128 v[116:119], v32 offset:13312
    ds_read_b128 v[120:123], v32 offset:25600
    ds_read_b128 v[124:127], v32 offset:37888
    s_waitcnt lgkmcnt(0)
    v_add_f32 v112, v112, v116
    v_add_f32 v120, v120, v124
    v_add_f32 v112, v112, v120
    v_add_f32 v113, v113, v117
    v_add_f32 v121, v121, v125
    v_add_f32 v113, v113, v121
    v_add_f32 v114, v114, v118
    v_add_f32 v122, v122, v126
    v_add_f32 v114, v114, v122
    v_add_f32 v115, v115, v119
    v_add_f32 v123, v123, v127
    v_add_f32 v115, v115, v123
    v_cvt_pk_bf16_f32 v146, v112, v113
    v_cvt_pk_bf16_f32 v147, v114, v115
    ds_read_b128 v[112:115], v32 offset:2048
    ds_read_b128 v[116:119], v32 offset:14336
    ds_read_b128 v[120:123], v32 offset:26624
    ds_read_b128 v[124:127], v32 offset:38912
    s_waitcnt lgkmcnt(0)
    v_add_f32 v112, v112, v116
    v_add_f32 v120, v120, v124
    v_add_f32 v112, v112, v120
    v_add_f32 v113, v113, v117
    v_add_f32 v121, v121, v125
    v_add_f32 v113, v113, v121
    v_add_f32 v114, v114, v118
    v_add_f32 v122, v122, v126
    v_add_f32 v114, v114, v122
    v_add_f32 v115, v115, v119
    v_add_f32 v123, v123, v127
    v_add_f32 v115, v115, v123
    v_cvt_pk_bf16_f32 v148, v112, v113
    v_cvt_pk_bf16_f32 v149, v114, v115
    v_mul_u32_u24 v33, 1792, v2
    v_lshl_add_u32 v33, v3, 3, v33
    s_lshl_b32 s43, s34, 5
    v_add_u32 v33, s43, v33
    buffer_store_dwordx2 v[144:145], v33, s[12:15], 0 offen
    v_add_u32 v33, 28672, v33
    buffer_store_dwordx2 v[146:147], v33, s[12:15], 0 offen
    v_add_u32 v33, 28672, v33
    buffer_store_dwordx2 v[148:149], v33, s[12:15], 0 offen
    s_waitcnt vmcnt(0)
L_op_end:
    s_endpgm
.section .rodata,"a"
.p2align 6
.amdhsa_kernel oproj_kernel
  .amdhsa_next_free_vgpr 256
  .amdhsa_next_free_sgpr 102
  .amdhsa_accum_offset 256
  .amdhsa_group_segment_fixed_size 0
  .amdhsa_kernarg_size 104
  .amdhsa_user_sgpr_count 2
  .amdhsa_user_sgpr_kernarg_segment_ptr 1
  .amdhsa_system_sgpr_workgroup_id_x 1
.end_amdhsa_kernel
```
